```python
import torch

def _softmax(x, axis=-1):
    return torch.softmax(x, dim=axis)
def _gelu(x):
    return torch.nn.functional.gelu(x, approximate="tanh")
def _silu(x):
    return torch.nn.functional.silu(x)
def _sigmoid(x):
    return torch.sigmoid(x)
def _layernorm(x, axis=-1, eps=1e-5):
    m = x.mean(dim=axis, keepdim=True)
    v = x.var(dim=axis, keepdim=True, unbiased=False)
    return (x - m) / torch.sqrt(v + eps)
def _scatter_add(tgt, idx, src, axis=0):
    return tgt.clone().index_add_(axis, idx, src)
def _segment_sum(src, seg, n):
    out = torch.zeros((n,) + src.shape[1:], dtype=src.dtype)
    return out.index_add_(0, seg, src)
def _pad(x, pw):
    flat = tuple(v for pair in reversed(pw) for v in pair)
    return torch.nn.functional.pad(x, flat)

kernel_name = 'sequential_preLN__softmax_full_mha__swiglu_ffn__prompt'

def setup_inputs():

    _w = (lambda a: (lambda t: t.to(torch.bfloat16) if t.is_floating_point() else t)(torch.as_tensor(a)))
    def _A_setup():
        B, S, D = 1, 2048, 640
        return {
            "x": _w((lambda *s: torch.randn(*s, dtype=torch.bfloat16) * 0.05)(B, S, D)),
            "wqkv": _w((lambda *s: torch.randn(*s, dtype=torch.bfloat16) * 0.05)(D, 3 * D)),
            "wo": _w((lambda *s: torch.randn(*s, dtype=torch.bfloat16) * 0.05)(D, D)),
        }
    _A_in = _A_setup()

    def _B_setup():
        B, S, D, F = 1, 2048, 640, 1536
        return {
            "x": _w((lambda *s: torch.randn(*s, dtype=torch.bfloat16) * 0.05)(B, S, D)),
            "w_gate": _w((lambda *s: torch.randn(*s, dtype=torch.bfloat16) * 0.05)(D, F)),
            "w_up": _w((lambda *s: torch.randn(*s, dtype=torch.bfloat16) * 0.05)(D, F)),
            "w_down": _w((lambda *s: torch.randn(*s, dtype=torch.bfloat16) * 0.05)(F, D)),
        }
    _B_in = _B_setup()

    return {
        "A_x": _A_in["x"],
        "A_wqkv": _A_in["wqkv"],
        "A_wo": _A_in["wo"],
        "B_x": _B_in["x"],
        "B_w_gate": _B_in["w_gate"],
        "B_w_up": _B_in["w_up"],
        "B_w_down": _B_in["w_down"],
    }

def reference(A_x, A_wqkv, A_wo, B_x, B_w_gate, B_w_up, B_w_down):
    def _A_ref(x, wqkv, wo):
        B, S, D = x.shape
        H = 32; Dh = D // H
        qkv = (lambda x, *d: x.permute(*d))((x @ wqkv).reshape(B, S, 3, H, Dh), 2, 0, 3, 1, 4)
        q, k, v = qkv[0], qkv[1], qkv[2]
        scale = Dh ** -0.5
        scores = torch.einsum("bhqd,bhkd->bhqk", q, k) * scale
        p = _softmax(scores, axis=-1)
        o = torch.einsum("bhqk,bhkd->bhqd", p, v)
        return (lambda x, *d: x.permute(*d))(o, 0, 2, 1, 3).reshape(B, S, D) @ wo

    def _B_ref(x, w_gate, w_up, w_down):
        g = _silu(x @ w_gate)
        u = x @ w_up
        return (g * u) @ w_down

    x = A_x
    h = x + _A_ref(_layernorm(x, axis=-1), A_wqkv, A_wo)
    h2 = h + _B_ref(_layernorm(h, axis=-1), B_w_gate, B_w_up, B_w_down)
    return h2
```

```asm
; @launch grid=(256,1,1) block=(512,1,1) lds=163840
.amdgcn_target "amdgcn-amd-amdhsa--gfx950"
.text
.globl sequential_preLN__softmax_full_mha__swiglu_ffn__prompt_kernel
.p2align 8
.type sequential_preLN__softmax_full_mha__swiglu_ffn__prompt_kernel,@function
sequential_preLN__softmax_full_mha__swiglu_ffn__prompt_kernel:
    s_load_dwordx2 s[8:9], s[0:1], 0
    s_load_dwordx2 s[12:13], s[0:1], 8
    s_load_dwordx2 s[4:5], s[0:1], 72
    s_load_dwordx2 s[16:17], s[0:1], 64
    v_lshrrev_b32 v3, 6, v0
    v_and_b32 v1, 63, v0
    v_readfirstlane_b32 s3, v3
    v_lshlrev_b32 v2, 4, v1
    s_mov_b32 s90, -1
    s_mov_b32 s91, 0
    s_mov_b32 s92, 0xfffff
    s_mov_b32 s93, 0xfffff
    s_cmp_ge_u32 s2, 240
    s_cbranch_scc1 L_spare
L_qkv:
    s_and_b32 s20, s2, 7
    s_lshr_b32 s21, s2, 3
    s_lshr_b32 s22, s20, 1
    s_and_b32 s23, s20, 1
    s_lshl_b32 s30, s22, 2
    s_lshr_b32 s31, s21, 2
    s_lshl_b32 s24, s23, 3
    s_add_u32 s31, s31, s24
    s_and_b32 s24, s21, 3
    s_lshl_b32 s25, s23, 1
    s_add_u32 s25, s25, s24
    s_cmp_ge_u32 s21, 28
    s_cselect_b32 s31, 7, s31
    s_cselect_b32 s24, s25, s24
    s_add_u32 s30, s30, s24
    s_mov_b32 s54, 0x55432210
    s_mov_b32 s55, 0x98987676
    s_lshl_b32 s25, s30, 2
    s_lshr_b64 s[54:55], s[54:55], s25
    s_and_b32 s29, s54, 15
    s_mov_b32 s54, 0x21043210
    s_mov_b32 s55, 0x6598765
    s_lshl_b32 s25, s31, 2
    s_lshr_b64 s[54:55], s[54:55], s25
    s_and_b32 s24, s54, 15
    s_add_u32 s29, s29, s24
    s_sub_u32 s24, s29, 10
    s_cmp_ge_u32 s29, 10
    s_cselect_b32 s29, s24, s29
    s_cmp_lt_u32 s3, 4
    s_cbranch_scc1 qkv_compute
    s_cmp_ge_u32 s3, 6
    s_cbranch_scc1 qkv_service
    v_lshrrev_b32 v4, 4, v1
    s_cmp_eq_u32 s3, 5
    s_cbranch_scc1 qkv_ldw
    v_lshrrev_b32 v3, 3, v1
    v_and_b32 v5, 7, v1
    v_mul_u32_u24 v6, 1280, v3
    v_xor_b32 v7, v5, v4
    v_lshl_add_u32 v24, v7, 4, v6
    v_xor_b32 v7, 64, v24
    v_add_u32 v25, 9216, v7
    v_add_u32 v26, 18432, v24
    v_add_u32 v27, 27648, v7
    s_mul_i32 s33, s30, 163840
    s_mov_b32 s34, 128
    s_mov_b32 s35, 40960
    s_mov_b32 s36, 0
    s_waitcnt lgkmcnt(0)
    s_and_b32 s9, s9, 0xffff
    s_mov_b32 s10, 0x280000
    s_mov_b32 s11, 0x20000
    s_branch qkv_ld
qkv_ldw:
    v_and_b32 v5, 15, v1
    v_lshlrev_b32 v7, 2, v4
    v_xor_b32 v5, v5, v7
    v_mul_u32_u24 v6, 3840, v4
    v_lshl_add_u32 v24, v5, 4, v6
    v_add_u32 v25, 14336, v24
    v_xor_b32 v7, 32, v24
    v_add_u32 v26, 28672, v7
    v_add_u32 v27, 43008, v7
    s_lshl_b32 s33, s31, 8
    s_mov_b32 s34, 245760
    s_mov_b32 s35, 61440
    s_mov_b32 s36, 16384
    s_waitcnt lgkmcnt(0)
    s_mov_b32 s8, s12
    s_and_b32 s9, s13, 0xffff
    s_mov_b32 s10, 0x258000
    s_mov_b32 s11, 0x20000
qkv_ld:
    s_mul_i32 s37, s29, s34
    s_mul_i32 s38, s34, 10
    s_mov_b32 s40, 0
qkv_ld_loop:
    s_add_u32 s39, s37, s33
    s_mov_b32 m0, s36
    s_add_u32 s36, s36, 4096
    buffer_load_dwordx4 v24, s[8:11], s39 offen offset:0 lds
    buffer_load_dwordx4 v25, s[8:11], s39 offen offset:1024 lds
    buffer_load_dwordx4 v26, s[8:11], s39 offen offset:2048 lds
    buffer_load_dwordx4 v27, s[8:11], s39 offen offset:3072 lds
    s_add_u32 s39, s39, s35
    s_mov_b32 m0, s36
    s_add_u32 s36, s36, 4096
    buffer_load_dwordx4 v24, s[8:11], s39 offen offset:0 lds
    buffer_load_dwordx4 v25, s[8:11], s39 offen offset:1024 lds
    buffer_load_dwordx4 v26, s[8:11], s39 offen offset:2048 lds
    buffer_load_dwordx4 v27, s[8:11], s39 offen offset:3072 lds
    s_add_u32 s39, s39, s35
    s_mov_b32 m0, s36
    s_add_u32 s36, s36, 4096
    buffer_load_dwordx4 v24, s[8:11], s39 offen offset:0 lds
    buffer_load_dwordx4 v25, s[8:11], s39 offen offset:1024 lds
    buffer_load_dwordx4 v26, s[8:11], s39 offen offset:2048 lds
    buffer_load_dwordx4 v27, s[8:11], s39 offen offset:3072 lds
    s_add_u32 s39, s39, s35
    s_mov_b32 m0, s36
    s_add_u32 s36, s36, 4096
    buffer_load_dwordx4 v24, s[8:11], s39 offen offset:0 lds
    buffer_load_dwordx4 v25, s[8:11], s39 offen offset:1024 lds
    buffer_load_dwordx4 v26, s[8:11], s39 offen offset:2048 lds
    buffer_load_dwordx4 v27, s[8:11], s39 offen offset:3072 lds
    s_add_u32 s36, s36, 16384
    s_and_b32 s36, s36, 0x1ffff
    s_add_u32 s37, s37, s34
    s_cmp_eq_u32 s37, s38
    s_cselect_b32 s37, 0, s37
    s_add_u32 s40, s40, 1
    s_cmp_lt_u32 s40, 3
    s_cbranch_scc1 qkv_ld_loop
    s_waitcnt vmcnt(32)
    s_barrier
    s_cmp_lt_u32 s40, 10
    s_cbranch_scc1 qkv_ld_loop
    s_waitcnt vmcnt(16)
    s_barrier
    s_waitcnt vmcnt(0)
    s_barrier
    s_barrier
    s_barrier
    s_setprio 0
    s_waitcnt lgkmcnt(0)
    s_and_b32 s5, s5, 0xffff
    s_mov_b32 s6, 0x2000000
    s_mov_b32 s7, 0x20000
    s_and_b32 s9, s9, 0xffff
    s_mov_b32 s10, 0x280000
    s_mov_b32 s11, 0x20000
    s_and_b32 s13, s13, 0xffff
    s_mov_b32 s14, 0x258000
    s_mov_b32 s15, 0x20000
    s_and_b32 s17, s17, 0xffff
    s_mov_b32 s18, 0x100
    s_mov_b32 s19, 0x20000
    s_branch L_h1
qkv_service:
    s_waitcnt lgkmcnt(0)
    s_and_b32 s5, s5, 0xffff
    s_mov_b32 s6, 0x2000000
    s_mov_b32 s7, 0x20000
    s_and_b32 s9, s9, 0xffff
    s_mov_b32 s10, 0x280000
    s_mov_b32 s11, 0x20000
    s_and_b32 s13, s13, 0xffff
    s_mov_b32 s14, 0x258000
    s_mov_b32 s15, 0x20000
    s_and_b32 s17, s17, 0xffff
    s_mov_b32 s18, 0x100
    s_mov_b32 s19, 0x20000
    s_cmp_eq_u32 s3, 6
    s_cbranch_scc1 qkv_stats
    s_barrier
    s_barrier
    s_barrier
    v_mov_b32 v3, 0
    buffer_load_dword v4, v3, s[16:19], 0 offen sc1
    s_barrier
    s_barrier
    s_barrier
    s_barrier
    s_barrier
    s_barrier
    s_barrier
    s_barrier
    s_barrier
    s_waitcnt vmcnt(0)
    v_mov_b32 v3, 0
    s_mov_b64 exec, 1
    v_cmp_ne_u32 vcc, 1, v4
    s_nop 4
    s_cbranch_vccz L_spun_2
    s_mov_b32 s88, 1048576
L_spin_1:
    buffer_load_dword v4, v3, s[16:19], 0 offen sc1
    s_waitcnt vmcnt(0)
    v_cmp_ne_u32 vcc, 1, v4
    s_sub_u32 s88, s88, 1
    s_cbranch_scc1 L_spun_2
    s_nop 2
    s_cbranch_vccnz L_spin_1
L_spun_2:
    s_mov_b64 exec, -1
    s_branch L_h1
qkv_stats:
    s_setprio 3
    v_mov_b32 v6, 0
    s_add_u32 s40, s30, 72
    s_add_u32 s41, s31, 88
    s_sub_u32 s41, s41, s40
    v_mul_lo_u32 v25, v1, s41
    v_add_u32 v25, s40, v25
    v_lshlrev_b32 v25, 7, v25
    v_add_u32 v25, 26738688, v25
    v_mov_b32 v26, 1
    s_mul_i32 s44, s30, 10240
    s_add_u32 s44, s44, 26345472
    s_lshl_b32 s52, s29, 10
    s_add_u32 s52, s52, s44
    s_mov_b32 s54, 0x1f1f
    s_bitcmp1_b32 s54, s31
    s_cselect_b32 s42, 1, 0
    s_cselect_b32 s52, s52, 33554432
    s_mul_i32 s45, s31, 5120
    s_add_u32 s45, s45, 26542080
    s_lshl_b32 s53, s29, 9
    s_add_u32 s53, s53, s45
    s_mov_b32 s54, 0x3377
    s_bitcmp1_b32 s54, s30
    s_cselect_b32 s43, 2, 0
    s_cselect_b32 s53, s53, 33554432
    s_or_b32 s42, s42, s43
    s_mov_b32 s43, 0
    v_lshlrev_b32 v3, 3, v1
    v_add_u32 v4, 131072, v2
    v_add_u32 v5, 132096, v3
    s_barrier
    s_barrier
    ds_read_b128 v[28:31], v4 offset:2048
    ds_read_b64 v[32:33], v5 offset:2048
    s_waitcnt lgkmcnt(0)
    buffer_store_dwordx4 v[28:31], v2, s[4:7], s52 offen sc1
    buffer_store_dwordx2 v[32:33], v3, s[4:7], s53 offen sc1
    buffer_load_dword v27, v6, s[16:19], 0 offen sc1
    s_mov_b32 s48, 2
svc1:
    s_barrier
    s_add_u32 s48, s48, 1
    s_cmp_ge_u32 s48, 5
    s_cbranch_scc1 svc1x
    s_getreg_b32 s49, hwreg(HW_REG_IB_STS)
    s_and_b32 s49, s49, 0xc0000f
    s_cbranch_scc1 svc1
svc1x:
    s_waitcnt vmcnt(0)
    v_mov_b32 v6, 0
    s_mov_b64 exec, 1
    v_cmp_ne_u32 vcc, 1, v27
    s_nop 4
    s_cbranch_vccz L_spun_4
    s_mov_b32 s88, 1048576
L_spin_3:
    buffer_load_dword v27, v6, s[16:19], 0 offen sc1
    s_waitcnt vmcnt(0)
    v_cmp_ne_u32 vcc, 1, v27
    s_sub_u32 s88, s88, 1
    s_cbranch_scc1 L_spun_4
    s_nop 2
    s_cbranch_vccnz L_spin_3
L_spun_4:
    s_mov_b64 exec, -1
    s_cmp_eq_u32 s42, 0
    s_cbranch_scc1 L_nosig_5
    s_mov_b64 exec, s[42:43]
    buffer_atomic_add v26, v25, s[4:7], 0 offen sc1
    s_mov_b64 exec, -1
L_nosig_5:
svc1b:
    s_barrier
    s_add_u32 s48, s48, 1
    s_cmp_lt_u32 s48, 7
    s_cbranch_scc1 svc1b
svc2a:
    s_mov_b64 exec, 3
    buffer_load_dword v24, v25, s[4:7], 0 offen sc1
    s_mov_b64 exec, -1
svc2:
    s_barrier
    s_add_u32 s48, s48, 1
    s_cmp_ge_u32 s48, 9
    s_cbranch_scc1 svc2x
    s_getreg_b32 s49, hwreg(HW_REG_IB_STS)
    s_and_b32 s49, s49, 0xc0000f
    s_cbranch_scc1 svc2
    s_waitcnt vmcnt(0)
    s_mov_b64 exec, 3
    v_cmp_ne_u32 vcc, 10, v24
    s_mov_b64 exec, -1
    s_nop 3
    s_cbranch_vccnz svc2a
svc2x:
    s_waitcnt vmcnt(0)
    s_mov_b64 exec, 3
    v_cmp_ne_u32 vcc, 10, v24
    s_nop 4
    s_cbranch_vccz L_spun_7
    s_mov_b32 s88, 1048576
L_spin_6:
    buffer_load_dword v24, v25, s[4:7], 0 offen sc1
    s_waitcnt vmcnt(0)
    v_cmp_ne_u32 vcc, 10, v24
    s_sub_u32 s88, s88, 1
    s_cbranch_scc1 L_spun_7
    s_nop 2
    s_cbranch_vccnz L_spin_6
L_spun_7:
    s_mov_b64 exec, -1
    buffer_load_dwordx4 v[28:31], v2, s[4:7], s44 offen offset:0 sc1
    buffer_load_dwordx4 v[32:35], v2, s[4:7], s44 offen offset:1024 sc1
    buffer_load_dwordx4 v[36:39], v2, s[4:7], s44 offen offset:2048 sc1
    buffer_load_dwordx4 v[40:43], v2, s[4:7], s44 offen offset:3072 sc1
    s_add_u32 s44, s44, 4096
    buffer_load_dwordx4 v[44:47], v2, s[4:7], s44 offen offset:0 sc1
    buffer_load_dwordx4 v[48:51], v2, s[4:7], s44 offen offset:1024 sc1
    buffer_load_dwordx4 v[52:55], v2, s[4:7], s44 offen offset:2048 sc1
    buffer_load_dwordx4 v[56:59], v2, s[4:7], s44 offen offset:3072 sc1
    s_add_u32 s44, s44, 4096
    buffer_load_dwordx4 v[60:63], v2, s[4:7], s44 offen offset:0 sc1
    buffer_load_dwordx4 v[64:67], v2, s[4:7], s44 offen offset:1024 sc1
    buffer_load_dwordx2 v[68:69], v3, s[4:7], s45 offen offset:0 sc1
    buffer_load_dwordx2 v[70:71], v3, s[4:7], s45 offen offset:512 sc1
    buffer_load_dwordx2 v[72:73], v3, s[4:7], s45 offen offset:1024 sc1
    buffer_load_dwordx2 v[74:75], v3, s[4:7], s45 offen offset:1536 sc1
    buffer_load_dwordx2 v[76:77], v3, s[4:7], s45 offen offset:2048 sc1
    buffer_load_dwordx2 v[78:79], v3, s[4:7], s45 offen offset:2560 sc1
    buffer_load_dwordx2 v[80:81], v3, s[4:7], s45 offen offset:3072 sc1
    buffer_load_dwordx2 v[82:83], v3, s[4:7], s45 offen offset:3584 sc1
    s_add_u32 s45, s45, 4096
    buffer_load_dwordx2 v[84:85], v3, s[4:7], s45 offen offset:0 sc1
    buffer_load_dwordx2 v[86:87], v3, s[4:7], s45 offen offset:512 sc1
svc3:
    s_cmp_ge_u32 s48, 11
    s_cbranch_scc1 svc3x
    s_barrier
    s_add_u32 s48, s48, 1
    s_getreg_b32 s49, hwreg(HW_REG_IB_STS)
    s_and_b32 s49, s49, 0xc0000f
    s_cbranch_scc1 svc3
svc3x:
    s_waitcnt vmcnt(0)
    v_pk_add_f32 v[28:29], v[28:29], v[32:33]
    v_pk_add_f32 v[30:31], v[30:31], v[34:35]
    v_pk_add_f32 v[68:69], v[68:69], v[70:71]
    v_pk_add_f32 v[28:29], v[28:29], v[36:37]
    v_pk_add_f32 v[30:31], v[30:31], v[38:39]
    v_pk_add_f32 v[68:69], v[68:69], v[72:73]
    v_pk_add_f32 v[28:29], v[28:29], v[40:41]
    v_pk_add_f32 v[30:31], v[30:31], v[42:43]
    v_pk_add_f32 v[68:69], v[68:69], v[74:75]
    v_pk_add_f32 v[28:29], v[28:29], v[44:45]
    v_pk_add_f32 v[30:31], v[30:31], v[46:47]
    v_pk_add_f32 v[68:69], v[68:69], v[76:77]
    v_pk_add_f32 v[28:29], v[28:29], v[48:49]
    v_pk_add_f32 v[30:31], v[30:31], v[50:51]
    v_pk_add_f32 v[68:69], v[68:69], v[78:79]
    v_pk_add_f32 v[28:29], v[28:29], v[52:53]
    v_pk_add_f32 v[30:31], v[30:31], v[54:55]
    v_pk_add_f32 v[68:69], v[68:69], v[80:81]
    v_pk_add_f32 v[28:29], v[28:29], v[56:57]
    v_pk_add_f32 v[30:31], v[30:31], v[58:59]
    v_pk_add_f32 v[68:69], v[68:69], v[82:83]
    v_pk_add_f32 v[28:29], v[28:29], v[60:61]
    v_pk_add_f32 v[30:31], v[30:31], v[62:63]
    v_pk_add_f32 v[68:69], v[68:69], v[84:85]
    v_pk_add_f32 v[28:29], v[28:29], v[64:65]
    v_pk_add_f32 v[30:31], v[30:31], v[66:67]
    v_pk_add_f32 v[68:69], v[68:69], v[86:87]
    v_mul_f32 v32, 0x3acccccd, v28
    v_mul_f32 v36, v32, v32
    v_mul_f32 v33, 0x3acccccd, v29
    v_sub_f32 v33, v33, v36
    v_max_f32 v33, 0, v33
    v_add_f32 v33, 0x3727c5ac, v33
    v_rsq_f32 v33, v33
    v_mul_f32 v34, 0x3acccccd, v30
    v_mul_f32 v36, v34, v34
    v_mul_f32 v35, 0x3acccccd, v31
    v_sub_f32 v35, v35, v36
    v_max_f32 v35, 0, v35
    v_add_f32 v35, 0x3727c5ac, v35
    v_rsq_f32 v35, v35
    s_nop 0
    ds_write_b128 v4, v[32:35]
    ds_write_b64 v5, v[68:69]
    s_waitcnt lgkmcnt(0)
svc4:
    s_barrier
    s_add_u32 s48, s48, 1
    s_cmp_lt_u32 s48, 12
    s_cbranch_scc1 svc4
    s_setprio 0
    s_branch L_h1
qkv_compute:
    s_and_b32 s32, s3, 1
    s_lshr_b32 s33, s3, 1
    v_and_b32 v3, 15, v1
    v_lshrrev_b32 v4, 4, v1
    s_lshl_b32 s34, s32, 1
    s_add_u32 s44, s34, s33
    s_xor_b32 s45, s44, 1
    s_lshl_b32 s34, s33, 1
    s_add_u32 s46, s34, s32
    s_xor_b32 s47, s46, 1
    v_lshrrev_b32 v5, 1, v3
    v_xor_b32 v5, v4, v5
    v_lshlrev_b32 v5, 4, v5
    v_lshl_add_u32 v5, v3, 7, v5
    s_lshl_b32 s34, s44, 12
    v_add_u32 v24, s34, v5
    v_xor_b32 v25, 64, v24
    s_lshl_b32 s34, s45, 12
    v_add_u32 v26, s34, v5
    v_xor_b32 v27, 64, v26
    v_bfe_u32 v5, v1, 2, 2
    v_lshl_add_u32 v6, v4, 3, v5
    v_lshlrev_b32 v6, 8, v6
    v_and_b32 v7, 3, v1
    v_lshl_add_u32 v6, v7, 3, v6
    v_add_u32 v6, 16384, v6
    v_and_b32 v7, 1, v4
    v_lshl_add_u32 v5, v5, 1, v7
    s_lshl_b32 s34, s46, 1
    v_xor_b32 v7, s34, v5
    v_lshl_add_u32 v28, v7, 5, v6
    v_xor_b32 v29, 32, v28
    s_lshl_b32 s34, s47, 1
    v_xor_b32 v7, s34, v5
    v_lshl_add_u32 v30, v7, 5, v6
    v_xor_b32 v31, 32, v30
    v_mov_b32 v40, 0
    v_mov_b32 v41, 0
    v_mov_b32 v42, 0
    v_mov_b32 v43, 0
    v_mov_b32 v44, 0
    v_mov_b32 v45, 0
    v_mov_b32 v46, 0x3f803f80
    v_mov_b32 v180, 0
    v_mov_b32 v181, 0
    v_mov_b32 v182, 0
    v_mov_b32 v183, 0
    v_mov_b32 v184, 0
    v_mov_b32 v185, 0
    v_mov_b32 v186, 0
    v_mov_b32 v187, 0
    v_mov_b32 v188, 0
    v_mov_b32 v189, 0
    v_mov_b32 v190, 0
    v_mov_b32 v191, 0
    v_mov_b32 v192, 0
    v_mov_b32 v193, 0
    v_mov_b32 v194, 0
    v_mov_b32 v195, 0
    v_mov_b32 v196, 0
    v_mov_b32 v197, 0
    v_mov_b32 v198, 0
    v_mov_b32 v199, 0
    v_mov_b32 v200, 0
    v_mov_b32 v201, 0
    v_mov_b32 v202, 0
    v_mov_b32 v203, 0
    v_mov_b32 v204, 0
    v_mov_b32 v205, 0
    v_mov_b32 v206, 0
    v_mov_b32 v207, 0
    v_mov_b32 v208, 0
    v_mov_b32 v209, 0
    v_mov_b32 v210, 0
    v_mov_b32 v211, 0
    v_mov_b32 v212, 0
    v_mov_b32 v213, 0
    v_mov_b32 v214, 0
    v_mov_b32 v215, 0
    v_mov_b32 v216, 0
    v_mov_b32 v217, 0
    v_mov_b32 v218, 0
    v_mov_b32 v219, 0
    v_mov_b32 v220, 0
    v_mov_b32 v221, 0
    v_mov_b32 v222, 0
    v_mov_b32 v223, 0
    v_mov_b32 v224, 0
    v_mov_b32 v225, 0
    v_mov_b32 v226, 0
    v_mov_b32 v227, 0
    v_mov_b32 v228, 0
    v_mov_b32 v229, 0
    v_mov_b32 v230, 0
    v_mov_b32 v231, 0
    v_mov_b32 v232, 0
    v_mov_b32 v233, 0
    v_mov_b32 v234, 0
    v_mov_b32 v235, 0
    v_mov_b32 v236, 0
    v_mov_b32 v237, 0
    v_mov_b32 v238, 0
    v_mov_b32 v239, 0
    v_mov_b32 v240, 0
    v_mov_b32 v241, 0
    v_mov_b32 v242, 0
    v_mov_b32 v243, 0
    s_lshl_b32 s42, s30, 2
    s_mov_b32 s52, 0xffff
    s_mov_b32 s53, 0
    s_lshl_b32 s34, s44, 8
    s_add_u32 s34, s34, 131072
    v_lshl_add_u32 v47, v3, 3, s34
    s_lshl_b32 s34, s45, 8
    s_add_u32 s34, s34, 131072
    v_lshl_add_u32 v48, v3, 3, s34
    s_lshl_b32 s34, s46, 7
    s_add_u32 s34, s34, 132096
    v_lshl_add_u32 v49, v3, 2, s34
    s_lshl_b32 s34, s47, 7
    s_add_u32 s34, s34, 132096
    v_lshl_add_u32 v50, v3, 2, s34
    s_waitcnt lgkmcnt(0)
    s_and_b32 s5, s5, 0xffff
    s_mov_b32 s6, 0x2000000
    s_mov_b32 s7, 0x20000
    s_and_b32 s9, s9, 0xffff
    s_mov_b32 s10, 0x280000
    s_mov_b32 s11, 0x20000
    s_and_b32 s13, s13, 0xffff
    s_mov_b32 s14, 0x258000
    s_mov_b32 s15, 0x20000
    s_and_b32 s17, s17, 0xffff
    s_mov_b32 s18, 0x100
    s_mov_b32 s19, 0x20000
    s_cmp_ge_u32 s31, 10
    s_cbranch_scc1 qkv_vpath
    s_cmp_ge_u32 s31, 5
    s_cselect_b32 s34, 5, 0
    s_mov_b32 s35, 81920
    s_cmov_b32 s35, 163840
    s_mov_b32 s36, 1280
    s_cmov_b32 s36, 2560
    s_cselect_b32 s37, 2621440, 0
    s_cselect_b32 s49, 0x3f800000, 0x3ea52b5c
    s_sub_u32 s34, s31, s34
    s_lshl_b32 s34, s34, 5
    v_and_b32 v5, 1, v4
    v_lshlrev_b32 v5, 3, v5
    v_lshl_add_u32 v52, v3, 4, v5
    v_lshlrev_b32 v5, 3, v3
    v_add_u32 v53, 1024, v5
    v_mov_b32 v54, 128
    s_lshl_b32 s38, s46, 3
    s_add_u32 s38, s38, s34
    v_add_u32 v5, 0, v4
    v_add_u32 v5, s38, v5
    v_mul_u32_u24 v6, 205, v5
    v_lshrrev_b32 v6, 10, v6
    v_mul_u32_u24 v7, 5, v6
    v_sub_u32 v5, v5, v7
    v_and_b32 v7, 1, v6
    v_sub_u32 v5, v5, v7
    v_cmp_gt_u32 vcc, 4, v5
    v_mul_lo_u32 v6, v6, s35
    v_lshrrev_b32 v5, 1, v5
    v_lshl_add_u32 v5, v5, 9, v52
    v_cndmask_b32 v5, v53, v5, vcc
    v_add_u32 v32, v5, v6
    v_cndmask_b32 v7, 0, v54, vcc
    v_add3_u32 v33, v32, v7, v54
    s_lshl_b32 s38, s46, 3
    s_add_u32 s38, s38, s34
    v_add_u32 v5, 4, v4
    v_add_u32 v5, s38, v5
    v_mul_u32_u24 v6, 205, v5
    v_lshrrev_b32 v6, 10, v6
    v_mul_u32_u24 v7, 5, v6
    v_sub_u32 v5, v5, v7
    v_and_b32 v7, 1, v6
    v_sub_u32 v5, v5, v7
    v_cmp_gt_u32 vcc, 4, v5
    v_mul_lo_u32 v6, v6, s35
    v_lshrrev_b32 v5, 1, v5
    v_lshl_add_u32 v5, v5, 9, v52
    v_cndmask_b32 v5, v53, v5, vcc
    v_add_u32 v34, v5, v6
    v_cndmask_b32 v7, 0, v54, vcc
    v_add3_u32 v35, v34, v7, v54
    s_lshl_b32 s38, s47, 3
    s_add_u32 s38, s38, s34
    v_add_u32 v5, 0, v4
    v_add_u32 v5, s38, v5
    v_mul_u32_u24 v6, 205, v5
    v_lshrrev_b32 v6, 10, v6
    v_mul_u32_u24 v7, 5, v6
    v_sub_u32 v5, v5, v7
    v_and_b32 v7, 1, v6
    v_sub_u32 v5, v5, v7
    v_cmp_gt_u32 vcc, 4, v5
    v_mul_lo_u32 v6, v6, s35
    v_lshrrev_b32 v5, 1, v5
    v_lshl_add_u32 v5, v5, 9, v52
    v_cndmask_b32 v5, v53, v5, vcc
    v_add_u32 v36, v5, v6
    v_cndmask_b32 v7, 0, v54, vcc
    v_add3_u32 v37, v36, v7, v54
    s_lshl_b32 s38, s47, 3
    s_add_u32 s38, s38, s34
    v_add_u32 v5, 4, v4
    v_add_u32 v5, s38, v5
    v_mul_u32_u24 v6, 205, v5
    v_lshrrev_b32 v6, 10, v6
    v_mul_u32_u24 v7, 5, v6
    v_sub_u32 v5, v5, v7
    v_and_b32 v7, 1, v6
    v_sub_u32 v5, v5, v7
    v_cmp_gt_u32 vcc, 4, v5
    v_mul_lo_u32 v6, v6, s35
    v_lshrrev_b32 v5, 1, v5
    v_lshl_add_u32 v5, v5, 9, v52
    v_cndmask_b32 v5, v53, v5, vcc
    v_add_u32 v38, v5, v6
    v_cndmask_b32 v7, 0, v54, vcc
    v_add3_u32 v39, v38, v7, v54
    s_add_u32 s38, s42, s44
    s_mul_i32 s38, s38, s36
    s_add_u32 s50, s38, s37
    s_add_u32 s38, s42, s45
    s_mul_i32 s38, s38, s36
    s_add_u32 s51, s38, s37
    s_barrier
    ds_read_b64_tr_b16 v[116:117], v28 offset:0
    ds_read_b64_tr_b16 v[118:119], v28 offset:1024
    ds_read_b128 v[52:55], v24 offset:0
    ds_read_b128 v[56:59], v24 offset:2048
    ds_read_b128 v[60:63], v26 offset:0
    ds_read_b128 v[64:67], v26 offset:2048
    ds_read_b64_tr_b16 v[120:121], v29 offset:0
    ds_read_b64_tr_b16 v[122:123], v29 offset:1024
    ds_read_b64_tr_b16 v[124:125], v30 offset:0
    ds_read_b64_tr_b16 v[126:127], v30 offset:1024
    ds_read_b64_tr_b16 v[128:129], v31 offset:0
    ds_read_b64_tr_b16 v[130:131], v31 offset:1024
    s_waitcnt lgkmcnt(3)
    ds_read_b64_tr_b16 v[132:133], v28 offset:8192
    ds_read_b64_tr_b16 v[134:135], v28 offset:9216
    ds_read_b128 v[68:71], v25 offset:0
    ds_read_b128 v[72:75], v25 offset:2048
    ds_read_b128 v[76:79], v27 offset:0
    ds_read_b128 v[80:83], v27 offset:2048
    ds_read_b64_tr_b16 v[136:137], v29 offset:8192
    ds_read_b64_tr_b16 v[138:139], v29 offset:9216
    ds_read_b64_tr_b16 v[140:141], v30 offset:8192
    ds_read_b64_tr_b16 v[142:143], v30 offset:9216
    ds_read_b64_tr_b16 v[144:145], v31 offset:8192
    ds_read_b64_tr_b16 v[146:147], v31 offset:9216
    s_waitcnt lgkmcnt(12)
    v_dot2_f32_bf16 v40, v52, v46, v40
    v_dot2_f32_bf16 v41, v52, v52, v41
    v_dot2_f32_bf16 v44, v116, v46, v44
    v_dot2_f32_bf16 v40, v53, v46, v40
    v_dot2_f32_bf16 v41, v53, v53, v41
    v_dot2_f32_bf16 v44, v117, v46, v44
    v_dot2_f32_bf16 v40, v54, v46, v40
    v_dot2_f32_bf16 v41, v54, v54, v41
    v_dot2_f32_bf16 v44, v118, v46, v44
    v_dot2_f32_bf16 v40, v55, v46, v40
    v_dot2_f32_bf16 v41, v55, v55, v41
    v_dot2_f32_bf16 v44, v119, v46, v44
    v_dot2_f32_bf16 v42, v56, v46, v42
    v_dot2_f32_bf16 v43, v56, v56, v43
    v_dot2_f32_bf16 v45, v120, v46, v45
    v_dot2_f32_bf16 v42, v57, v46, v42
    v_dot2_f32_bf16 v43, v57, v57, v43
    v_dot2_f32_bf16 v45, v121, v46, v45
    v_dot2_f32_bf16 v42, v58, v46, v42
    v_dot2_f32_bf16 v43, v58, v58, v43
    v_dot2_f32_bf16 v45, v122, v46, v45
    v_dot2_f32_bf16 v42, v59, v46, v42
    v_dot2_f32_bf16 v43, v59, v59, v43
    v_dot2_f32_bf16 v45, v123, v46, v45
    s_waitcnt lgkmcnt(0)
    v_dot2_f32_bf16 v40, v68, v46, v40
    v_dot2_f32_bf16 v41, v68, v68, v41
    v_dot2_f32_bf16 v44, v132, v46, v44
    v_dot2_f32_bf16 v40, v69, v46, v40
    v_dot2_f32_bf16 v41, v69, v69, v41
    v_dot2_f32_bf16 v44, v133, v46, v44
    v_dot2_f32_bf16 v40, v70, v46, v40
    v_dot2_f32_bf16 v41, v70, v70, v41
    v_dot2_f32_bf16 v44, v134, v46, v44
    v_dot2_f32_bf16 v40, v71, v46, v40
    v_dot2_f32_bf16 v41, v71, v71, v41
    v_dot2_f32_bf16 v44, v135, v46, v44
    v_dot2_f32_bf16 v42, v72, v46, v42
    v_dot2_f32_bf16 v43, v72, v72, v43
    v_dot2_f32_bf16 v45, v136, v46, v45
    v_dot2_f32_bf16 v42, v73, v46, v42
    v_dot2_f32_bf16 v43, v73, v73, v43
    v_dot2_f32_bf16 v45, v137, v46, v45
    v_dot2_f32_bf16 v42, v74, v46, v42
    v_dot2_f32_bf16 v43, v74, v74, v43
    v_dot2_f32_bf16 v45, v138, v46, v45
    v_dot2_f32_bf16 v42, v75, v46, v42
    v_dot2_f32_bf16 v43, v75, v75, v43
    v_dot2_f32_bf16 v45, v139, v46, v45
    v_and_b32 v5, 31, v1
    v_lshrrev_b32 v6, 5, v1
    s_lshl_b32 s34, s44, 8
    v_permlane32_swap_b32 v40, v41
    v_permlane32_swap_b32 v42, v43
    v_permlane16_swap_b32 v44, v45
    v_add_f32 v40, v40, v41
    v_add_f32 v42, v42, v43
    v_add_f32 v44, v44, v45
    s_add_u32 s34, s34, 133120
    v_mov_b32 v45, v44
    v_permlane16_swap_b32 v40, v42
    v_lshl_add_u32 v7, v5, 3, s34
    v_permlane32_swap_b32 v44, v45
    v_lshl_add_u32 v7, v6, 2, v7
    s_lshl_b32 s34, s46, 7
    s_add_u32 s34, s34, 134144
    v_add_f32 v40, v40, v42
    v_add_f32 v44, v44, v45
    v_lshl_add_u32 v5, v5, 2, s34
    ds_write_b32 v7, v40
    ds_write_b32 v5, v44
    s_waitcnt lgkmcnt(12)
    v_mfma_f32_16x16x32_bf16 v[180:183], v[116:119], v[52:55], v[180:183]
    v_mfma_f32_16x16x32_bf16 v[184:187], v[116:119], v[56:59], v[184:187]
    v_mfma_f32_16x16x32_bf16 v[188:191], v[116:119], v[60:63], v[188:191]
    v_mfma_f32_16x16x32_bf16 v[192:195], v[116:119], v[64:67], v[192:195]
    s_waitcnt lgkmcnt(0)
    s_barrier
    v_mfma_f32_16x16x32_bf16 v[196:199], v[120:123], v[52:55], v[196:199]
    ds_read_b64_tr_b16 v[148:149], v28 offset:32768
    v_mfma_f32_16x16x32_bf16 v[200:203], v[120:123], v[56:59], v[200:203]
    ds_read_b64_tr_b16 v[150:151], v28 offset:33792
    v_mfma_f32_16x16x32_bf16 v[204:207], v[120:123], v[60:63], v[204:207]
    ds_read_b128 v[84:87], v24 offset:32768
    v_mfma_f32_16x16x32_bf16 v[208:211], v[120:123], v[64:67], v[208:211]
    ds_read_b128 v[88:91], v24 offset:34816
    v_mfma_f32_16x16x32_bf16 v[212:215], v[124:127], v[52:55], v[212:215]
    ds_read_b128 v[92:95], v26 offset:32768
    v_mfma_f32_16x16x32_bf16 v[216:219], v[124:127], v[56:59], v[216:219]
    ds_read_b128 v[96:99], v26 offset:34816
    v_mfma_f32_16x16x32_bf16 v[220:223], v[124:127], v[60:63], v[220:223]
    ds_read_b64_tr_b16 v[152:153], v29 offset:32768
    v_mfma_f32_16x16x32_bf16 v[224:227], v[124:127], v[64:67], v[224:227]
    ds_read_b64_tr_b16 v[154:155], v29 offset:33792
    v_mfma_f32_16x16x32_bf16 v[228:231], v[128:131], v[52:55], v[228:231]
    ds_read_b64_tr_b16 v[156:157], v30 offset:32768
    v_mfma_f32_16x16x32_bf16 v[232:235], v[128:131], v[56:59], v[232:235]
    ds_read_b64_tr_b16 v[158:159], v30 offset:33792
    v_mfma_f32_16x16x32_bf16 v[236:239], v[128:131], v[60:63], v[236:239]
    ds_read_b64_tr_b16 v[160:161], v31 offset:32768
    v_mfma_f32_16x16x32_bf16 v[240:243], v[128:131], v[64:67], v[240:243]
    ds_read_b64_tr_b16 v[162:163], v31 offset:33792
    v_mfma_f32_16x16x32_bf16 v[180:183], v[132:135], v[68:71], v[180:183]
    ds_read_b64_tr_b16 v[164:165], v28 offset:40960
    v_mfma_f32_16x16x32_bf16 v[184:187], v[132:135], v[72:75], v[184:187]
    ds_read_b64_tr_b16 v[166:167], v28 offset:41984
    v_mfma_f32_16x16x32_bf16 v[188:191], v[132:135], v[76:79], v[188:191]
    ds_read_b128 v[100:103], v25 offset:32768
    v_mfma_f32_16x16x32_bf16 v[192:195], v[132:135], v[80:83], v[192:195]
    s_waitcnt lgkmcnt(9)
    v_mfma_f32_16x16x32_bf16 v[196:199], v[136:139], v[68:71], v[196:199]
    ds_read_b128 v[104:107], v25 offset:34816
    v_mfma_f32_16x16x32_bf16 v[200:203], v[136:139], v[72:75], v[200:203]
    ds_read_b128 v[108:111], v27 offset:32768
    v_mfma_f32_16x16x32_bf16 v[204:207], v[136:139], v[76:79], v[204:207]
    ds_read_b128 v[112:115], v27 offset:34816
    v_mfma_f32_16x16x32_bf16 v[208:211], v[136:139], v[80:83], v[208:211]
    ds_read_b64_tr_b16 v[168:169], v29 offset:40960
    v_mfma_f32_16x16x32_bf16 v[212:215], v[140:143], v[68:71], v[212:215]
    ds_read_b64_tr_b16 v[170:171], v29 offset:41984
    v_mfma_f32_16x16x32_bf16 v[216:219], v[140:143], v[72:75], v[216:219]
    ds_read_b64_tr_b16 v[172:173], v30 offset:40960
    v_mfma_f32_16x16x32_bf16 v[220:223], v[140:143], v[76:79], v[220:223]
    s_waitcnt lgkmcnt(9)
    v_mfma_f32_16x16x32_bf16 v[224:227], v[140:143], v[80:83], v[224:227]
    ds_read_b64_tr_b16 v[174:175], v30 offset:41984
    v_mfma_f32_16x16x32_bf16 v[228:231], v[144:147], v[68:71], v[228:231]
    ds_read_b64_tr_b16 v[176:177], v31 offset:40960
    v_mfma_f32_16x16x32_bf16 v[232:235], v[144:147], v[72:75], v[232:235]
    ds_read_b64_tr_b16 v[178:179], v31 offset:41984
    v_mfma_f32_16x16x32_bf16 v[236:239], v[144:147], v[76:79], v[236:239]
    v_mfma_f32_16x16x32_bf16 v[240:243], v[144:147], v[80:83], v[240:243]
    s_mov_b32 s48, 4
.p2align 3
    s_nop 0
qkv_loop_qk:
    s_waitcnt lgkmcnt(12)
    v_mfma_f32_16x16x32_bf16 v[180:183], v[148:151], v[84:87], v[180:183]
    v_xor_b32 v24, 0x10000, v24
    v_xor_b32 v26, 0x10000, v26
    v_mfma_f32_16x16x32_bf16 v[184:187], v[148:151], v[88:91], v[184:187]
    v_xor_b32 v28, 0x10000, v28
    v_mfma_f32_16x16x32_bf16 v[188:191], v[148:151], v[92:95], v[188:191]
    v_xor_b32 v29, 0x10000, v29
    v_xor_b32 v30, 0x10000, v30
    v_mfma_f32_16x16x32_bf16 v[192:195], v[148:151], v[96:99], v[192:195]
    v_xor_b32 v31, 0x10000, v31
    s_waitcnt lgkmcnt(0)
    s_barrier
    v_mfma_f32_16x16x32_bf16 v[196:199], v[152:155], v[84:87], v[196:199]
    ds_read_b64_tr_b16 v[116:117], v28 offset:0
    ds_read_b64_tr_b16 v[118:119], v28 offset:1024
    v_mfma_f32_16x16x32_bf16 v[200:203], v[152:155], v[88:91], v[200:203]
    ds_read_b128 v[52:55], v24 offset:0
    v_mfma_f32_16x16x32_bf16 v[204:207], v[152:155], v[92:95], v[204:207]
    ds_read_b128 v[56:59], v24 offset:2048
    v_mfma_f32_16x16x32_bf16 v[208:211], v[152:155], v[96:99], v[208:211]
    ds_read_b128 v[60:63], v26 offset:0
    v_mfma_f32_16x16x32_bf16 v[212:215], v[156:159], v[84:87], v[212:215]
    ds_read_b128 v[64:67], v26 offset:2048
    v_mfma_f32_16x16x32_bf16 v[216:219], v[156:159], v[88:91], v[216:219]
    ds_read_b64_tr_b16 v[120:121], v29 offset:0
    v_mfma_f32_16x16x32_bf16 v[220:223], v[156:159], v[92:95], v[220:223]
    ds_read_b64_tr_b16 v[122:123], v29 offset:1024
    v_mfma_f32_16x16x32_bf16 v[224:227], v[156:159], v[96:99], v[224:227]
    ds_read_b64_tr_b16 v[124:125], v30 offset:0
    v_mfma_f32_16x16x32_bf16 v[228:231], v[160:163], v[84:87], v[228:231]
    ds_read_b64_tr_b16 v[126:127], v30 offset:1024
    v_mfma_f32_16x16x32_bf16 v[232:235], v[160:163], v[88:91], v[232:235]
    ds_read_b64_tr_b16 v[128:129], v31 offset:0
    v_mfma_f32_16x16x32_bf16 v[236:239], v[160:163], v[92:95], v[236:239]
    ds_read_b64_tr_b16 v[130:131], v31 offset:1024
    v_mfma_f32_16x16x32_bf16 v[240:243], v[160:163], v[96:99], v[240:243]
    v_xor_b32 v25, 0x10000, v25
    v_mfma_f32_16x16x32_bf16 v[180:183], v[164:167], v[100:103], v[180:183]
    v_xor_b32 v27, 0x10000, v27
    v_mfma_f32_16x16x32_bf16 v[184:187], v[164:167], v[104:107], v[184:187]
    ds_read_b64_tr_b16 v[132:133], v28 offset:8192
    ds_read_b64_tr_b16 v[134:135], v28 offset:9216
    v_mfma_f32_16x16x32_bf16 v[188:191], v[164:167], v[108:111], v[188:191]
    ds_read_b128 v[68:71], v25 offset:0
    v_mfma_f32_16x16x32_bf16 v[192:195], v[164:167], v[112:115], v[192:195]
    s_waitcnt lgkmcnt(9)
    v_mfma_f32_16x16x32_bf16 v[196:199], v[168:171], v[100:103], v[196:199]
    ds_read_b128 v[72:75], v25 offset:2048
    v_mfma_f32_16x16x32_bf16 v[200:203], v[168:171], v[104:107], v[200:203]
    ds_read_b128 v[76:79], v27 offset:0
    v_mfma_f32_16x16x32_bf16 v[204:207], v[168:171], v[108:111], v[204:207]
    ds_read_b128 v[80:83], v27 offset:2048
    v_mfma_f32_16x16x32_bf16 v[208:211], v[168:171], v[112:115], v[208:211]
    ds_read_b64_tr_b16 v[136:137], v29 offset:8192
    v_mfma_f32_16x16x32_bf16 v[212:215], v[172:175], v[100:103], v[212:215]
    ds_read_b64_tr_b16 v[138:139], v29 offset:9216
    v_mfma_f32_16x16x32_bf16 v[216:219], v[172:175], v[104:107], v[216:219]
    ds_read_b64_tr_b16 v[140:141], v30 offset:8192
    v_mfma_f32_16x16x32_bf16 v[220:223], v[172:175], v[108:111], v[220:223]
    s_waitcnt lgkmcnt(9)
    v_mfma_f32_16x16x32_bf16 v[224:227], v[172:175], v[112:115], v[224:227]
    ds_read_b64_tr_b16 v[142:143], v30 offset:9216
    v_mfma_f32_16x16x32_bf16 v[228:231], v[176:179], v[100:103], v[228:231]
    ds_read_b64_tr_b16 v[144:145], v31 offset:8192
    v_mfma_f32_16x16x32_bf16 v[232:235], v[176:179], v[104:107], v[232:235]
    ds_read_b64_tr_b16 v[146:147], v31 offset:9216
    v_mfma_f32_16x16x32_bf16 v[236:239], v[176:179], v[108:111], v[236:239]
    v_mfma_f32_16x16x32_bf16 v[240:243], v[176:179], v[112:115], v[240:243]
    s_waitcnt lgkmcnt(12)
    v_mfma_f32_16x16x32_bf16 v[180:183], v[116:119], v[52:55], v[180:183]
    v_mfma_f32_16x16x32_bf16 v[184:187], v[116:119], v[56:59], v[184:187]
    v_mfma_f32_16x16x32_bf16 v[188:191], v[116:119], v[60:63], v[188:191]
    v_mfma_f32_16x16x32_bf16 v[192:195], v[116:119], v[64:67], v[192:195]
    s_waitcnt lgkmcnt(0)
    s_barrier
    v_mfma_f32_16x16x32_bf16 v[196:199], v[120:123], v[52:55], v[196:199]
    ds_read_b64_tr_b16 v[148:149], v28 offset:32768
    v_mfma_f32_16x16x32_bf16 v[200:203], v[120:123], v[56:59], v[200:203]
    ds_read_b64_tr_b16 v[150:151], v28 offset:33792
    v_mfma_f32_16x16x32_bf16 v[204:207], v[120:123], v[60:63], v[204:207]
    ds_read_b128 v[84:87], v24 offset:32768
    v_mfma_f32_16x16x32_bf16 v[208:211], v[120:123], v[64:67], v[208:211]
    ds_read_b128 v[88:91], v24 offset:34816
    v_mfma_f32_16x16x32_bf16 v[212:215], v[124:127], v[52:55], v[212:215]
    ds_read_b128 v[92:95], v26 offset:32768
    v_mfma_f32_16x16x32_bf16 v[216:219], v[124:127], v[56:59], v[216:219]
    ds_read_b128 v[96:99], v26 offset:34816
    v_mfma_f32_16x16x32_bf16 v[220:223], v[124:127], v[60:63], v[220:223]
    ds_read_b64_tr_b16 v[152:153], v29 offset:32768
    v_mfma_f32_16x16x32_bf16 v[224:227], v[124:127], v[64:67], v[224:227]
    ds_read_b64_tr_b16 v[154:155], v29 offset:33792
    v_mfma_f32_16x16x32_bf16 v[228:231], v[128:131], v[52:55], v[228:231]
    ds_read_b64_tr_b16 v[156:157], v30 offset:32768
    v_mfma_f32_16x16x32_bf16 v[232:235], v[128:131], v[56:59], v[232:235]
    ds_read_b64_tr_b16 v[158:159], v30 offset:33792
    v_mfma_f32_16x16x32_bf16 v[236:239], v[128:131], v[60:63], v[236:239]
    ds_read_b64_tr_b16 v[160:161], v31 offset:32768
    v_mfma_f32_16x16x32_bf16 v[240:243], v[128:131], v[64:67], v[240:243]
    ds_read_b64_tr_b16 v[162:163], v31 offset:33792
    v_mfma_f32_16x16x32_bf16 v[180:183], v[132:135], v[68:71], v[180:183]
    ds_read_b64_tr_b16 v[164:165], v28 offset:40960
    v_mfma_f32_16x16x32_bf16 v[184:187], v[132:135], v[72:75], v[184:187]
    ds_read_b64_tr_b16 v[166:167], v28 offset:41984
    v_mfma_f32_16x16x32_bf16 v[188:191], v[132:135], v[76:79], v[188:191]
    ds_read_b128 v[100:103], v25 offset:32768
    v_mfma_f32_16x16x32_bf16 v[192:195], v[132:135], v[80:83], v[192:195]
    s_waitcnt lgkmcnt(9)
    v_mfma_f32_16x16x32_bf16 v[196:199], v[136:139], v[68:71], v[196:199]
    ds_read_b128 v[104:107], v25 offset:34816
    v_mfma_f32_16x16x32_bf16 v[200:203], v[136:139], v[72:75], v[200:203]
    ds_read_b128 v[108:111], v27 offset:32768
    v_mfma_f32_16x16x32_bf16 v[204:207], v[136:139], v[76:79], v[204:207]
    ds_read_b128 v[112:115], v27 offset:34816
    v_mfma_f32_16x16x32_bf16 v[208:211], v[136:139], v[80:83], v[208:211]
    ds_read_b64_tr_b16 v[168:169], v29 offset:40960
    v_mfma_f32_16x16x32_bf16 v[212:215], v[140:143], v[68:71], v[212:215]
    ds_read_b64_tr_b16 v[170:171], v29 offset:41984
    v_mfma_f32_16x16x32_bf16 v[216:219], v[140:143], v[72:75], v[216:219]
    ds_read_b64_tr_b16 v[172:173], v30 offset:40960
    v_mfma_f32_16x16x32_bf16 v[220:223], v[140:143], v[76:79], v[220:223]
    s_waitcnt lgkmcnt(9)
    v_mfma_f32_16x16x32_bf16 v[224:227], v[140:143], v[80:83], v[224:227]
    ds_read_b64_tr_b16 v[174:175], v30 offset:41984
    v_mfma_f32_16x16x32_bf16 v[228:231], v[144:147], v[68:71], v[228:231]
    ds_read_b64_tr_b16 v[176:177], v31 offset:40960
    v_mfma_f32_16x16x32_bf16 v[232:235], v[144:147], v[72:75], v[232:235]
    ds_read_b64_tr_b16 v[178:179], v31 offset:41984
    v_mfma_f32_16x16x32_bf16 v[236:239], v[144:147], v[76:79], v[236:239]
    v_mfma_f32_16x16x32_bf16 v[240:243], v[144:147], v[80:83], v[240:243]
    s_sub_u32 s48, s48, 1
    s_cmp_lg_u32 s48, 0
    s_cbranch_scc1 qkv_loop_qk
    s_waitcnt lgkmcnt(12)
    v_mfma_f32_16x16x32_bf16 v[180:183], v[148:151], v[84:87], v[180:183]
    v_mfma_f32_16x16x32_bf16 v[184:187], v[148:151], v[88:91], v[184:187]
    v_mfma_f32_16x16x32_bf16 v[188:191], v[148:151], v[92:95], v[188:191]
    v_mfma_f32_16x16x32_bf16 v[192:195], v[148:151], v[96:99], v[192:195]
    s_waitcnt lgkmcnt(0)
    s_barrier
    v_mfma_f32_16x16x32_bf16 v[196:199], v[152:155], v[84:87], v[196:199]
    v_mfma_f32_16x16x32_bf16 v[200:203], v[152:155], v[88:91], v[200:203]
    v_mfma_f32_16x16x32_bf16 v[204:207], v[152:155], v[92:95], v[204:207]
    v_mfma_f32_16x16x32_bf16 v[208:211], v[152:155], v[96:99], v[208:211]
    v_mfma_f32_16x16x32_bf16 v[212:215], v[156:159], v[84:87], v[212:215]
    v_mfma_f32_16x16x32_bf16 v[216:219], v[156:159], v[88:91], v[216:219]
    v_mfma_f32_16x16x32_bf16 v[220:223], v[156:159], v[92:95], v[220:223]
    v_mfma_f32_16x16x32_bf16 v[224:227], v[156:159], v[96:99], v[224:227]
    v_mfma_f32_16x16x32_bf16 v[228:231], v[160:163], v[84:87], v[228:231]
    v_mfma_f32_16x16x32_bf16 v[232:235], v[160:163], v[88:91], v[232:235]
    v_mfma_f32_16x16x32_bf16 v[236:239], v[160:163], v[92:95], v[236:239]
    v_mfma_f32_16x16x32_bf16 v[240:243], v[160:163], v[96:99], v[240:243]
    s_barrier
    v_mfma_f32_16x16x32_bf16 v[180:183], v[164:167], v[100:103], v[180:183]
    ds_read_b64 v[116:117], v47 offset:0
    ds_read_b64 v[118:119], v47 offset:128
    ds_read_b64 v[120:121], v48 offset:0
    v_mfma_f32_16x16x32_bf16 v[184:187], v[164:167], v[104:107], v[184:187]
    ds_read_b64 v[122:123], v48 offset:128
    ds_read_b32 v124, v49 offset:0
    ds_read_b32 v125, v49 offset:64
    v_mfma_f32_16x16x32_bf16 v[188:191], v[164:167], v[108:111], v[188:191]
    ds_read_b32 v126, v50 offset:0
    ds_read_b32 v127, v50 offset:64
    v_mfma_f32_16x16x32_bf16 v[192:195], v[164:167], v[112:115], v[192:195]
    v_mfma_f32_16x16x32_bf16 v[196:199], v[168:171], v[100:103], v[196:199]
    v_mfma_f32_16x16x32_bf16 v[200:203], v[168:171], v[104:107], v[200:203]
    s_waitcnt lgkmcnt(0)
    v_mfma_f32_16x16x32_bf16 v[204:207], v[168:171], v[108:111], v[204:207]
    v_sub_f32 v144, 0, v116
    v_cndmask_b32_e64 v144, 0, v144, s[52:53]
    v_and_b32 v145, 0xffff0000, v144
    v_sub_f32 v144, v144, v145
    v_mfma_f32_16x16x32_bf16 v[208:211], v[168:171], v[112:115], v[208:211]
    v_cvt_pk_bf16_f32 v128, v145, v145
    v_cvt_pk_bf16_f32 v129, v144, v144
    v_sub_f32 v144, 0, v118
    v_cndmask_b32_e64 v144, 0, v144, s[52:53]
    v_mfma_f32_16x16x32_bf16 v[212:215], v[172:175], v[100:103], v[212:215]
    v_and_b32 v145, 0xffff0000, v144
    v_sub_f32 v144, v144, v145
    v_cvt_pk_bf16_f32 v130, v145, v145
    v_cvt_pk_bf16_f32 v131, v144, v144
    v_mfma_f32_16x16x32_bf16 v[216:219], v[172:175], v[104:107], v[216:219]
    v_sub_f32 v144, 0, v120
    v_cndmask_b32_e64 v144, 0, v144, s[52:53]
    v_and_b32 v145, 0xffff0000, v144
    v_sub_f32 v144, v144, v145
    v_mfma_f32_16x16x32_bf16 v[220:223], v[172:175], v[108:111], v[220:223]
    v_cvt_pk_bf16_f32 v132, v145, v145
    v_cvt_pk_bf16_f32 v133, v144, v144
    v_sub_f32 v144, 0, v122
    v_cndmask_b32_e64 v144, 0, v144, s[52:53]
    v_mfma_f32_16x16x32_bf16 v[224:227], v[172:175], v[112:115], v[224:227]
    v_and_b32 v145, 0xffff0000, v144
    v_sub_f32 v144, v144, v145
    v_cvt_pk_bf16_f32 v134, v145, v145
    v_cvt_pk_bf16_f32 v135, v144, v144
    v_mfma_f32_16x16x32_bf16 v[228:231], v[176:179], v[100:103], v[228:231]
    v_and_b32 v145, 0xffff0000, v124
    v_sub_f32 v144, v124, v145
    v_cvt_pk_bf16_f32 v136, v145, v144
    v_mov_b32 v137, v136
    v_mfma_f32_16x16x32_bf16 v[232:235], v[176:179], v[104:107], v[232:235]
    v_and_b32 v145, 0xffff0000, v125
    v_sub_f32 v144, v125, v145
    v_cvt_pk_bf16_f32 v138, v145, v144
    v_mov_b32 v139, v138
    v_mfma_f32_16x16x32_bf16 v[236:239], v[176:179], v[108:111], v[236:239]
    v_and_b32 v145, 0xffff0000, v126
    v_sub_f32 v144, v126, v145
    v_cvt_pk_bf16_f32 v140, v145, v144
    v_mov_b32 v141, v140
    v_mfma_f32_16x16x32_bf16 v[240:243], v[176:179], v[112:115], v[240:243]
    v_and_b32 v145, 0xffff0000, v127
    v_sub_f32 v144, v127, v145
    v_cvt_pk_bf16_f32 v142, v145, v144
    v_mov_b32 v143, v142
    s_nop 0
    v_mfma_f32_16x16x16bf16_1k v[180:183], v[136:137], v[128:129], v[180:183]
    v_mfma_f32_16x16x16bf16_1k v[196:199], v[138:139], v[128:129], v[196:199]
    v_mfma_f32_16x16x16bf16_1k v[212:215], v[140:141], v[128:129], v[212:215]
    v_mfma_f32_16x16x16bf16_1k v[228:231], v[142:143], v[128:129], v[228:231]
    v_mul_f32 v117, s49, v117
    v_mul_f32 v119, s49, v119
    v_mul_f32 v121, s49, v121
    v_mul_f32 v123, s49, v123
    s_nop 1
    v_pk_mul_f32 v[180:181], v[180:181], v[116:117] op_sel:[0,1] op_sel_hi:[1,1]
    v_pk_mul_f32 v[182:183], v[182:183], v[116:117] op_sel:[0,1] op_sel_hi:[1,1]
    v_mfma_f32_16x16x16bf16_1k v[184:187], v[136:137], v[130:131], v[184:187]
    v_cvt_pk_bf16_f32 v52, v180, v181
    v_cvt_pk_bf16_f32 v53, v182, v183
    buffer_store_dwordx2 v[52:53], v32, s[4:7], s50 offen sc1
    v_pk_mul_f32 v[196:197], v[196:197], v[116:117] op_sel:[0,1] op_sel_hi:[1,1]
    v_pk_mul_f32 v[198:199], v[198:199], v[116:117] op_sel:[0,1] op_sel_hi:[1,1]
    v_mfma_f32_16x16x16bf16_1k v[200:203], v[138:139], v[130:131], v[200:203]
    v_cvt_pk_bf16_f32 v54, v196, v197
    v_cvt_pk_bf16_f32 v55, v198, v199
    buffer_store_dwordx2 v[54:55], v34, s[4:7], s50 offen sc1
    v_pk_mul_f32 v[212:213], v[212:213], v[116:117] op_sel:[0,1] op_sel_hi:[1,1]
    v_pk_mul_f32 v[214:215], v[214:215], v[116:117] op_sel:[0,1] op_sel_hi:[1,1]
    v_mfma_f32_16x16x16bf16_1k v[216:219], v[140:141], v[130:131], v[216:219]
    v_cvt_pk_bf16_f32 v56, v212, v213
    v_cvt_pk_bf16_f32 v57, v214, v215
    buffer_store_dwordx2 v[56:57], v36, s[4:7], s50 offen sc1
    v_pk_mul_f32 v[228:229], v[228:229], v[116:117] op_sel:[0,1] op_sel_hi:[1,1]
    v_pk_mul_f32 v[230:231], v[230:231], v[116:117] op_sel:[0,1] op_sel_hi:[1,1]
    v_mfma_f32_16x16x16bf16_1k v[232:235], v[142:143], v[130:131], v[232:235]
    v_cvt_pk_bf16_f32 v58, v228, v229
    v_cvt_pk_bf16_f32 v59, v230, v231
    buffer_store_dwordx2 v[58:59], v38, s[4:7], s50 offen sc1
    v_pk_mul_f32 v[184:185], v[184:185], v[118:119] op_sel:[0,1] op_sel_hi:[1,1]
    v_pk_mul_f32 v[186:187], v[186:187], v[118:119] op_sel:[0,1] op_sel_hi:[1,1]
    v_mfma_f32_16x16x16bf16_1k v[188:191], v[136:137], v[132:133], v[188:191]
    v_cvt_pk_bf16_f32 v60, v184, v185
    v_cvt_pk_bf16_f32 v61, v186, v187
    buffer_store_dwordx2 v[60:61], v33, s[4:7], s50 offen sc1
    v_pk_mul_f32 v[200:201], v[200:201], v[118:119] op_sel:[0,1] op_sel_hi:[1,1]
    v_pk_mul_f32 v[202:203], v[202:203], v[118:119] op_sel:[0,1] op_sel_hi:[1,1]
    v_mfma_f32_16x16x16bf16_1k v[204:207], v[138:139], v[132:133], v[204:207]
    v_cvt_pk_bf16_f32 v62, v200, v201
    v_cvt_pk_bf16_f32 v63, v202, v203
    buffer_store_dwordx2 v[62:63], v35, s[4:7], s50 offen sc1
    v_pk_mul_f32 v[216:217], v[216:217], v[118:119] op_sel:[0,1] op_sel_hi:[1,1]
    v_pk_mul_f32 v[218:219], v[218:219], v[118:119] op_sel:[0,1] op_sel_hi:[1,1]
    v_mfma_f32_16x16x16bf16_1k v[220:223], v[140:141], v[132:133], v[220:223]
    v_cvt_pk_bf16_f32 v64, v216, v217
    v_cvt_pk_bf16_f32 v65, v218, v219
    buffer_store_dwordx2 v[64:65], v37, s[4:7], s50 offen sc1
    v_pk_mul_f32 v[232:233], v[232:233], v[118:119] op_sel:[0,1] op_sel_hi:[1,1]
    v_pk_mul_f32 v[234:235], v[234:235], v[118:119] op_sel:[0,1] op_sel_hi:[1,1]
    v_mfma_f32_16x16x16bf16_1k v[236:239], v[142:143], v[132:133], v[236:239]
    v_cvt_pk_bf16_f32 v66, v232, v233
    v_cvt_pk_bf16_f32 v67, v234, v235
    buffer_store_dwordx2 v[66:67], v39, s[4:7], s50 offen sc1
    v_pk_mul_f32 v[188:189], v[188:189], v[120:121] op_sel:[0,1] op_sel_hi:[1,1]
    v_pk_mul_f32 v[190:191], v[190:191], v[120:121] op_sel:[0,1] op_sel_hi:[1,1]
    v_mfma_f32_16x16x16bf16_1k v[192:195], v[136:137], v[134:135], v[192:195]
    v_cvt_pk_bf16_f32 v52, v188, v189
    v_cvt_pk_bf16_f32 v53, v190, v191
    buffer_store_dwordx2 v[52:53], v32, s[4:7], s51 offen sc1
    v_pk_mul_f32 v[204:205], v[204:205], v[120:121] op_sel:[0,1] op_sel_hi:[1,1]
    v_pk_mul_f32 v[206:207], v[206:207], v[120:121] op_sel:[0,1] op_sel_hi:[1,1]
    v_mfma_f32_16x16x16bf16_1k v[208:211], v[138:139], v[134:135], v[208:211]
    v_cvt_pk_bf16_f32 v54, v204, v205
    v_cvt_pk_bf16_f32 v55, v206, v207
    buffer_store_dwordx2 v[54:55], v34, s[4:7], s51 offen sc1
    v_pk_mul_f32 v[220:221], v[220:221], v[120:121] op_sel:[0,1] op_sel_hi:[1,1]
    v_pk_mul_f32 v[222:223], v[222:223], v[120:121] op_sel:[0,1] op_sel_hi:[1,1]
    v_mfma_f32_16x16x16bf16_1k v[224:227], v[140:141], v[134:135], v[224:227]
    v_cvt_pk_bf16_f32 v56, v220, v221
    v_cvt_pk_bf16_f32 v57, v222, v223
    buffer_store_dwordx2 v[56:57], v36, s[4:7], s51 offen sc1
    v_pk_mul_f32 v[236:237], v[236:237], v[120:121] op_sel:[0,1] op_sel_hi:[1,1]
    v_pk_mul_f32 v[238:239], v[238:239], v[120:121] op_sel:[0,1] op_sel_hi:[1,1]
    v_mfma_f32_16x16x16bf16_1k v[240:243], v[142:143], v[134:135], v[240:243]
    v_cvt_pk_bf16_f32 v58, v236, v237
    v_cvt_pk_bf16_f32 v59, v238, v239
    buffer_store_dwordx2 v[58:59], v38, s[4:7], s51 offen sc1
    v_pk_mul_f32 v[192:193], v[192:193], v[122:123] op_sel:[0,1] op_sel_hi:[1,1]
    v_pk_mul_f32 v[194:195], v[194:195], v[122:123] op_sel:[0,1] op_sel_hi:[1,1]
    v_cvt_pk_bf16_f32 v60, v192, v193
    v_cvt_pk_bf16_f32 v61, v194, v195
    buffer_store_dwordx2 v[60:61], v33, s[4:7], s51 offen sc1
    v_pk_mul_f32 v[208:209], v[208:209], v[122:123] op_sel:[0,1] op_sel_hi:[1,1]
    v_pk_mul_f32 v[210:211], v[210:211], v[122:123] op_sel:[0,1] op_sel_hi:[1,1]
    v_cvt_pk_bf16_f32 v62, v208, v209
    v_cvt_pk_bf16_f32 v63, v210, v211
    buffer_store_dwordx2 v[62:63], v35, s[4:7], s51 offen sc1
    v_pk_mul_f32 v[224:225], v[224:225], v[122:123] op_sel:[0,1] op_sel_hi:[1,1]
    v_pk_mul_f32 v[226:227], v[226:227], v[122:123] op_sel:[0,1] op_sel_hi:[1,1]
    v_cvt_pk_bf16_f32 v64, v224, v225
    v_cvt_pk_bf16_f32 v65, v226, v227
    buffer_store_dwordx2 v[64:65], v37, s[4:7], s51 offen sc1
    v_pk_mul_f32 v[240:241], v[240:241], v[122:123] op_sel:[0,1] op_sel_hi:[1,1]
    v_pk_mul_f32 v[242:243], v[242:243], v[122:123] op_sel:[0,1] op_sel_hi:[1,1]
    v_cvt_pk_bf16_f32 v66, v240, v241
    v_cvt_pk_bf16_f32 v67, v242, v243
    buffer_store_dwordx2 v[66:67], v39, s[4:7], s51 offen sc1
    s_branch qkv_out
qkv_vpath:
    s_sub_u32 s34, s31, 10
    s_lshl_b32 s34, s34, 7
    s_mov_b32 s35, 163840
    s_lshl_b32 s38, s46, 5
    s_add_u32 s38, s38, s34
    v_lshrrev_b32 v5, 1, v4
    v_lshl_add_u32 v5, v5, 4, v3
    v_add_u32 v5, s38, v5
    v_mul_u32_u24 v6, 3277, v5
    v_lshrrev_b32 v6, 16, v6
    v_mul_u32_u24 v7, 20, v6
    v_sub_u32 v5, v5, v7
    v_mul_lo_u32 v6, v6, s35
    v_lshl_add_u32 v6, v5, 4, v6
    v_and_b32 v7, 1, v4
    v_mul_u32_u24 v7, 320, v7
    v_add_u32 v32, v6, v7
    s_lshl_b32 s38, s47, 5
    s_add_u32 s38, s38, s34
    v_lshrrev_b32 v5, 1, v4
    v_lshl_add_u32 v5, v5, 4, v3
    v_add_u32 v5, s38, v5
    v_mul_u32_u24 v6, 3277, v5
    v_lshrrev_b32 v6, 16, v6
    v_mul_u32_u24 v7, 20, v6
    v_sub_u32 v5, v5, v7
    v_mul_lo_u32 v6, v6, s35
    v_lshl_add_u32 v6, v5, 4, v6
    v_and_b32 v7, 1, v4
    v_mul_u32_u24 v7, 320, v7
    v_add_u32 v33, v6, v7
    s_add_u32 s38, s42, s44
    s_mul_i32 s38, s38, 2560
    s_add_u32 s50, s38, 2622720
    s_lshl_b32 s34, s44, 8
    s_add_u32 s34, s34, 131072
    v_lshl_add_u32 v34, v4, 5, s34
    s_add_u32 s38, s42, s45
    s_mul_i32 s38, s38, 2560
    s_add_u32 s51, s38, 2622720
    s_lshl_b32 s34, s45, 8
    s_add_u32 s34, s34, 131072
    v_lshl_add_u32 v35, v4, 5, s34
    s_barrier
    ds_read_b64_tr_b16 v[116:117], v28 offset:0
    ds_read_b64_tr_b16 v[118:119], v28 offset:1024
    ds_read_b128 v[52:55], v24 offset:0
    ds_read_b128 v[56:59], v24 offset:2048
    ds_read_b128 v[60:63], v26 offset:0
    ds_read_b128 v[64:67], v26 offset:2048
    ds_read_b64_tr_b16 v[120:121], v29 offset:0
    ds_read_b64_tr_b16 v[122:123], v29 offset:1024
    ds_read_b64_tr_b16 v[124:125], v30 offset:0
    ds_read_b64_tr_b16 v[126:127], v30 offset:1024
    ds_read_b64_tr_b16 v[128:129], v31 offset:0
    ds_read_b64_tr_b16 v[130:131], v31 offset:1024
    s_waitcnt lgkmcnt(3)
    ds_read_b64_tr_b16 v[132:133], v28 offset:8192
    ds_read_b64_tr_b16 v[134:135], v28 offset:9216
    ds_read_b128 v[68:71], v25 offset:0
    ds_read_b128 v[72:75], v25 offset:2048
    ds_read_b128 v[76:79], v27 offset:0
    ds_read_b128 v[80:83], v27 offset:2048
    ds_read_b64_tr_b16 v[136:137], v29 offset:8192
    ds_read_b64_tr_b16 v[138:139], v29 offset:9216
    ds_read_b64_tr_b16 v[140:141], v30 offset:8192
    ds_read_b64_tr_b16 v[142:143], v30 offset:9216
    ds_read_b64_tr_b16 v[144:145], v31 offset:8192
    ds_read_b64_tr_b16 v[146:147], v31 offset:9216
    s_waitcnt lgkmcnt(12)
    v_dot2_f32_bf16 v40, v52, v46, v40
    v_dot2_f32_bf16 v41, v52, v52, v41
    v_dot2_f32_bf16 v44, v116, v46, v44
    v_dot2_f32_bf16 v40, v53, v46, v40
    v_dot2_f32_bf16 v41, v53, v53, v41
    v_dot2_f32_bf16 v44, v117, v46, v44
    v_dot2_f32_bf16 v40, v54, v46, v40
    v_dot2_f32_bf16 v41, v54, v54, v41
    v_dot2_f32_bf16 v44, v118, v46, v44
    v_dot2_f32_bf16 v40, v55, v46, v40
    v_dot2_f32_bf16 v41, v55, v55, v41
    v_dot2_f32_bf16 v44, v119, v46, v44
    v_dot2_f32_bf16 v42, v56, v46, v42
    v_dot2_f32_bf16 v43, v56, v56, v43
    v_dot2_f32_bf16 v45, v120, v46, v45
    v_dot2_f32_bf16 v42, v57, v46, v42
    v_dot2_f32_bf16 v43, v57, v57, v43
    v_dot2_f32_bf16 v45, v121, v46, v45
    v_dot2_f32_bf16 v42, v58, v46, v42
    v_dot2_f32_bf16 v43, v58, v58, v43
    v_dot2_f32_bf16 v45, v122, v46, v45
    v_dot2_f32_bf16 v42, v59, v46, v42
    v_dot2_f32_bf16 v43, v59, v59, v43
    v_dot2_f32_bf16 v45, v123, v46, v45
    s_waitcnt lgkmcnt(0)
    v_dot2_f32_bf16 v40, v68, v46, v40
    v_dot2_f32_bf16 v41, v68, v68, v41
    v_dot2_f32_bf16 v44, v132, v46, v44
    v_dot2_f32_bf16 v40, v69, v46, v40
    v_dot2_f32_bf16 v41, v69, v69, v41
    v_dot2_f32_bf16 v44, v133, v46, v44
    v_dot2_f32_bf16 v40, v70, v46, v40
    v_dot2_f32_bf16 v41, v70, v70, v41
    v_dot2_f32_bf16 v44, v134, v46, v44
    v_dot2_f32_bf16 v40, v71, v46, v40
    v_dot2_f32_bf16 v41, v71, v71, v41
    v_dot2_f32_bf16 v44, v135, v46, v44
    v_dot2_f32_bf16 v42, v72, v46, v42
    v_dot2_f32_bf16 v43, v72, v72, v43
    v_dot2_f32_bf16 v45, v136, v46, v45
    v_dot2_f32_bf16 v42, v73, v46, v42
    v_dot2_f32_bf16 v43, v73, v73, v43
    v_dot2_f32_bf16 v45, v137, v46, v45
    v_dot2_f32_bf16 v42, v74, v46, v42
    v_dot2_f32_bf16 v43, v74, v74, v43
    v_dot2_f32_bf16 v45, v138, v46, v45
    v_dot2_f32_bf16 v42, v75, v46, v42
    v_dot2_f32_bf16 v43, v75, v75, v43
    v_dot2_f32_bf16 v45, v139, v46, v45
    v_and_b32 v5, 31, v1
    v_lshrrev_b32 v6, 5, v1
    s_lshl_b32 s34, s44, 8
    v_permlane32_swap_b32 v40, v41
    v_permlane32_swap_b32 v42, v43
    v_permlane16_swap_b32 v44, v45
    v_add_f32 v40, v40, v41
    v_add_f32 v42, v42, v43
    v_add_f32 v44, v44, v45
    s_add_u32 s34, s34, 133120
    v_mov_b32 v45, v44
    v_permlane16_swap_b32 v40, v42
    v_lshl_add_u32 v7, v5, 3, s34
    v_permlane32_swap_b32 v44, v45
    v_lshl_add_u32 v7, v6, 2, v7
    s_lshl_b32 s34, s46, 7
    s_add_u32 s34, s34, 134144
    v_add_f32 v40, v40, v42
    v_add_f32 v44, v44, v45
    v_lshl_add_u32 v5, v5, 2, s34
    ds_write_b32 v7, v40
    ds_write_b32 v5, v44
    s_waitcnt lgkmcnt(12)
    v_mfma_f32_16x16x32_bf16 v[180:183], v[52:55], v[116:119], v[180:183]
    v_mfma_f32_16x16x32_bf16 v[184:187], v[56:59], v[116:119], v[184:187]
    v_mfma_f32_16x16x32_bf16 v[188:191], v[60:63], v[116:119], v[188:191]
    v_mfma_f32_16x16x32_bf16 v[192:195], v[64:67], v[116:119], v[192:195]
    s_waitcnt lgkmcnt(0)
    s_barrier
    v_mfma_f32_16x16x32_bf16 v[196:199], v[52:55], v[120:123], v[196:199]
    ds_read_b64_tr_b16 v[148:149], v28 offset:32768
    v_mfma_f32_16x16x32_bf16 v[200:203], v[56:59], v[120:123], v[200:203]
    ds_read_b64_tr_b16 v[150:151], v28 offset:33792
    v_mfma_f32_16x16x32_bf16 v[204:207], v[60:63], v[120:123], v[204:207]
    ds_read_b128 v[84:87], v24 offset:32768
    v_mfma_f32_16x16x32_bf16 v[208:211], v[64:67], v[120:123], v[208:211]
    ds_read_b128 v[88:91], v24 offset:34816
    v_mfma_f32_16x16x32_bf16 v[212:215], v[52:55], v[124:127], v[212:215]
    ds_read_b128 v[92:95], v26 offset:32768
    v_mfma_f32_16x16x32_bf16 v[216:219], v[56:59], v[124:127], v[216:219]
    ds_read_b128 v[96:99], v26 offset:34816
    v_mfma_f32_16x16x32_bf16 v[220:223], v[60:63], v[124:127], v[220:223]
    ds_read_b64_tr_b16 v[152:153], v29 offset:32768
    v_mfma_f32_16x16x32_bf16 v[224:227], v[64:67], v[124:127], v[224:227]
    ds_read_b64_tr_b16 v[154:155], v29 offset:33792
    v_mfma_f32_16x16x32_bf16 v[228:231], v[52:55], v[128:131], v[228:231]
    ds_read_b64_tr_b16 v[156:157], v30 offset:32768
    v_mfma_f32_16x16x32_bf16 v[232:235], v[56:59], v[128:131], v[232:235]
    ds_read_b64_tr_b16 v[158:159], v30 offset:33792
    v_mfma_f32_16x16x32_bf16 v[236:239], v[60:63], v[128:131], v[236:239]
    ds_read_b64_tr_b16 v[160:161], v31 offset:32768
    v_mfma_f32_16x16x32_bf16 v[240:243], v[64:67], v[128:131], v[240:243]
    ds_read_b64_tr_b16 v[162:163], v31 offset:33792
    v_mfma_f32_16x16x32_bf16 v[180:183], v[68:71], v[132:135], v[180:183]
    ds_read_b64_tr_b16 v[164:165], v28 offset:40960
    v_mfma_f32_16x16x32_bf16 v[184:187], v[72:75], v[132:135], v[184:187]
    ds_read_b64_tr_b16 v[166:167], v28 offset:41984
    v_mfma_f32_16x16x32_bf16 v[188:191], v[76:79], v[132:135], v[188:191]
    ds_read_b128 v[100:103], v25 offset:32768
    v_mfma_f32_16x16x32_bf16 v[192:195], v[80:83], v[132:135], v[192:195]
    s_waitcnt lgkmcnt(9)
    v_mfma_f32_16x16x32_bf16 v[196:199], v[68:71], v[136:139], v[196:199]
    ds_read_b128 v[104:107], v25 offset:34816
    v_mfma_f32_16x16x32_bf16 v[200:203], v[72:75], v[136:139], v[200:203]
    ds_read_b128 v[108:111], v27 offset:32768
    v_mfma_f32_16x16x32_bf16 v[204:207], v[76:79], v[136:139], v[204:207]
    ds_read_b128 v[112:115], v27 offset:34816
    v_mfma_f32_16x16x32_bf16 v[208:211], v[80:83], v[136:139], v[208:211]
    ds_read_b64_tr_b16 v[168:169], v29 offset:40960
    v_mfma_f32_16x16x32_bf16 v[212:215], v[68:71], v[140:143], v[212:215]
    ds_read_b64_tr_b16 v[170:171], v29 offset:41984
    v_mfma_f32_16x16x32_bf16 v[216:219], v[72:75], v[140:143], v[216:219]
    ds_read_b64_tr_b16 v[172:173], v30 offset:40960
    v_mfma_f32_16x16x32_bf16 v[220:223], v[76:79], v[140:143], v[220:223]
    s_waitcnt lgkmcnt(9)
    v_mfma_f32_16x16x32_bf16 v[224:227], v[80:83], v[140:143], v[224:227]
    ds_read_b64_tr_b16 v[174:175], v30 offset:41984
    v_mfma_f32_16x16x32_bf16 v[228:231], v[68:71], v[144:147], v[228:231]
    ds_read_b64_tr_b16 v[176:177], v31 offset:40960
    v_mfma_f32_16x16x32_bf16 v[232:235], v[72:75], v[144:147], v[232:235]
    ds_read_b64_tr_b16 v[178:179], v31 offset:41984
    v_mfma_f32_16x16x32_bf16 v[236:239], v[76:79], v[144:147], v[236:239]
    v_mfma_f32_16x16x32_bf16 v[240:243], v[80:83], v[144:147], v[240:243]
    s_mov_b32 s48, 4
.p2align 3
    s_nop 0
qkv_loop_v:
    s_waitcnt lgkmcnt(12)
    v_mfma_f32_16x16x32_bf16 v[180:183], v[84:87], v[148:151], v[180:183]
    v_xor_b32 v24, 0x10000, v24
    v_xor_b32 v26, 0x10000, v26
    v_mfma_f32_16x16x32_bf16 v[184:187], v[88:91], v[148:151], v[184:187]
    v_xor_b32 v28, 0x10000, v28
    v_mfma_f32_16x16x32_bf16 v[188:191], v[92:95], v[148:151], v[188:191]
    v_xor_b32 v29, 0x10000, v29
    v_xor_b32 v30, 0x10000, v30
    v_mfma_f32_16x16x32_bf16 v[192:195], v[96:99], v[148:151], v[192:195]
    v_xor_b32 v31, 0x10000, v31
    s_waitcnt lgkmcnt(0)
    s_barrier
    v_mfma_f32_16x16x32_bf16 v[196:199], v[84:87], v[152:155], v[196:199]
    ds_read_b64_tr_b16 v[116:117], v28 offset:0
    ds_read_b64_tr_b16 v[118:119], v28 offset:1024
    v_mfma_f32_16x16x32_bf16 v[200:203], v[88:91], v[152:155], v[200:203]
    ds_read_b128 v[52:55], v24 offset:0
    v_mfma_f32_16x16x32_bf16 v[204:207], v[92:95], v[152:155], v[204:207]
    ds_read_b128 v[56:59], v24 offset:2048
    v_mfma_f32_16x16x32_bf16 v[208:211], v[96:99], v[152:155], v[208:211]
    ds_read_b128 v[60:63], v26 offset:0
    v_mfma_f32_16x16x32_bf16 v[212:215], v[84:87], v[156:159], v[212:215]
    ds_read_b128 v[64:67], v26 offset:2048
    v_mfma_f32_16x16x32_bf16 v[216:219], v[88:91], v[156:159], v[216:219]
    ds_read_b64_tr_b16 v[120:121], v29 offset:0
    v_mfma_f32_16x16x32_bf16 v[220:223], v[92:95], v[156:159], v[220:223]
    ds_read_b64_tr_b16 v[122:123], v29 offset:1024
    v_mfma_f32_16x16x32_bf16 v[224:227], v[96:99], v[156:159], v[224:227]
    ds_read_b64_tr_b16 v[124:125], v30 offset:0
    v_mfma_f32_16x16x32_bf16 v[228:231], v[84:87], v[160:163], v[228:231]
    ds_read_b64_tr_b16 v[126:127], v30 offset:1024
    v_mfma_f32_16x16x32_bf16 v[232:235], v[88:91], v[160:163], v[232:235]
    ds_read_b64_tr_b16 v[128:129], v31 offset:0
    v_mfma_f32_16x16x32_bf16 v[236:239], v[92:95], v[160:163], v[236:239]
    ds_read_b64_tr_b16 v[130:131], v31 offset:1024
    v_mfma_f32_16x16x32_bf16 v[240:243], v[96:99], v[160:163], v[240:243]
    v_xor_b32 v25, 0x10000, v25
    v_mfma_f32_16x16x32_bf16 v[180:183], v[100:103], v[164:167], v[180:183]
    v_xor_b32 v27, 0x10000, v27
    v_mfma_f32_16x16x32_bf16 v[184:187], v[104:107], v[164:167], v[184:187]
    ds_read_b64_tr_b16 v[132:133], v28 offset:8192
    ds_read_b64_tr_b16 v[134:135], v28 offset:9216
    v_mfma_f32_16x16x32_bf16 v[188:191], v[108:111], v[164:167], v[188:191]
    ds_read_b128 v[68:71], v25 offset:0
    v_mfma_f32_16x16x32_bf16 v[192:195], v[112:115], v[164:167], v[192:195]
    s_waitcnt lgkmcnt(9)
    v_mfma_f32_16x16x32_bf16 v[196:199], v[100:103], v[168:171], v[196:199]
    ds_read_b128 v[72:75], v25 offset:2048
    v_mfma_f32_16x16x32_bf16 v[200:203], v[104:107], v[168:171], v[200:203]
    ds_read_b128 v[76:79], v27 offset:0
    v_mfma_f32_16x16x32_bf16 v[204:207], v[108:111], v[168:171], v[204:207]
    ds_read_b128 v[80:83], v27 offset:2048
    v_mfma_f32_16x16x32_bf16 v[208:211], v[112:115], v[168:171], v[208:211]
    ds_read_b64_tr_b16 v[136:137], v29 offset:8192
    v_mfma_f32_16x16x32_bf16 v[212:215], v[100:103], v[172:175], v[212:215]
    ds_read_b64_tr_b16 v[138:139], v29 offset:9216
    v_mfma_f32_16x16x32_bf16 v[216:219], v[104:107], v[172:175], v[216:219]
    ds_read_b64_tr_b16 v[140:141], v30 offset:8192
    v_mfma_f32_16x16x32_bf16 v[220:223], v[108:111], v[172:175], v[220:223]
    s_waitcnt lgkmcnt(9)
    v_mfma_f32_16x16x32_bf16 v[224:227], v[112:115], v[172:175], v[224:227]
    ds_read_b64_tr_b16 v[142:143], v30 offset:9216
    v_mfma_f32_16x16x32_bf16 v[228:231], v[100:103], v[176:179], v[228:231]
    ds_read_b64_tr_b16 v[144:145], v31 offset:8192
    v_mfma_f32_16x16x32_bf16 v[232:235], v[104:107], v[176:179], v[232:235]
    ds_read_b64_tr_b16 v[146:147], v31 offset:9216
    v_mfma_f32_16x16x32_bf16 v[236:239], v[108:111], v[176:179], v[236:239]
    v_mfma_f32_16x16x32_bf16 v[240:243], v[112:115], v[176:179], v[240:243]
    s_waitcnt lgkmcnt(12)
    v_mfma_f32_16x16x32_bf16 v[180:183], v[52:55], v[116:119], v[180:183]
    v_mfma_f32_16x16x32_bf16 v[184:187], v[56:59], v[116:119], v[184:187]
    v_mfma_f32_16x16x32_bf16 v[188:191], v[60:63], v[116:119], v[188:191]
    v_mfma_f32_16x16x32_bf16 v[192:195], v[64:67], v[116:119], v[192:195]
    s_waitcnt lgkmcnt(0)
    s_barrier
    v_mfma_f32_16x16x32_bf16 v[196:199], v[52:55], v[120:123], v[196:199]
    ds_read_b64_tr_b16 v[148:149], v28 offset:32768
    v_mfma_f32_16x16x32_bf16 v[200:203], v[56:59], v[120:123], v[200:203]
    ds_read_b64_tr_b16 v[150:151], v28 offset:33792
    v_mfma_f32_16x16x32_bf16 v[204:207], v[60:63], v[120:123], v[204:207]
    ds_read_b128 v[84:87], v24 offset:32768
    v_mfma_f32_16x16x32_bf16 v[208:211], v[64:67], v[120:123], v[208:211]
    ds_read_b128 v[88:91], v24 offset:34816
    v_mfma_f32_16x16x32_bf16 v[212:215], v[52:55], v[124:127], v[212:215]
    ds_read_b128 v[92:95], v26 offset:32768
    v_mfma_f32_16x16x32_bf16 v[216:219], v[56:59], v[124:127], v[216:219]
    ds_read_b128 v[96:99], v26 offset:34816
    v_mfma_f32_16x16x32_bf16 v[220:223], v[60:63], v[124:127], v[220:223]
    ds_read_b64_tr_b16 v[152:153], v29 offset:32768
    v_mfma_f32_16x16x32_bf16 v[224:227], v[64:67], v[124:127], v[224:227]
    ds_read_b64_tr_b16 v[154:155], v29 offset:33792
    v_mfma_f32_16x16x32_bf16 v[228:231], v[52:55], v[128:131], v[228:231]
    ds_read_b64_tr_b16 v[156:157], v30 offset:32768
    v_mfma_f32_16x16x32_bf16 v[232:235], v[56:59], v[128:131], v[232:235]
    ds_read_b64_tr_b16 v[158:159], v30 offset:33792
    v_mfma_f32_16x16x32_bf16 v[236:239], v[60:63], v[128:131], v[236:239]
    ds_read_b64_tr_b16 v[160:161], v31 offset:32768
    v_mfma_f32_16x16x32_bf16 v[240:243], v[64:67], v[128:131], v[240:243]
    ds_read_b64_tr_b16 v[162:163], v31 offset:33792
    v_mfma_f32_16x16x32_bf16 v[180:183], v[68:71], v[132:135], v[180:183]
    ds_read_b64_tr_b16 v[164:165], v28 offset:40960
    v_mfma_f32_16x16x32_bf16 v[184:187], v[72:75], v[132:135], v[184:187]
    ds_read_b64_tr_b16 v[166:167], v28 offset:41984
    v_mfma_f32_16x16x32_bf16 v[188:191], v[76:79], v[132:135], v[188:191]
    ds_read_b128 v[100:103], v25 offset:32768
    v_mfma_f32_16x16x32_bf16 v[192:195], v[80:83], v[132:135], v[192:195]
    s_waitcnt lgkmcnt(9)
    v_mfma_f32_16x16x32_bf16 v[196:199], v[68:71], v[136:139], v[196:199]
    ds_read_b128 v[104:107], v25 offset:34816
    v_mfma_f32_16x16x32_bf16 v[200:203], v[72:75], v[136:139], v[200:203]
    ds_read_b128 v[108:111], v27 offset:32768
    v_mfma_f32_16x16x32_bf16 v[204:207], v[76:79], v[136:139], v[204:207]
    ds_read_b128 v[112:115], v27 offset:34816
    v_mfma_f32_16x16x32_bf16 v[208:211], v[80:83], v[136:139], v[208:211]
    ds_read_b64_tr_b16 v[168:169], v29 offset:40960
    v_mfma_f32_16x16x32_bf16 v[212:215], v[68:71], v[140:143], v[212:215]
    ds_read_b64_tr_b16 v[170:171], v29 offset:41984
    v_mfma_f32_16x16x32_bf16 v[216:219], v[72:75], v[140:143], v[216:219]
    ds_read_b64_tr_b16 v[172:173], v30 offset:40960
    v_mfma_f32_16x16x32_bf16 v[220:223], v[76:79], v[140:143], v[220:223]
    s_waitcnt lgkmcnt(9)
    v_mfma_f32_16x16x32_bf16 v[224:227], v[80:83], v[140:143], v[224:227]
    ds_read_b64_tr_b16 v[174:175], v30 offset:41984
    v_mfma_f32_16x16x32_bf16 v[228:231], v[68:71], v[144:147], v[228:231]
    ds_read_b64_tr_b16 v[176:177], v31 offset:40960
    v_mfma_f32_16x16x32_bf16 v[232:235], v[72:75], v[144:147], v[232:235]
    ds_read_b64_tr_b16 v[178:179], v31 offset:41984
    v_mfma_f32_16x16x32_bf16 v[236:239], v[76:79], v[144:147], v[236:239]
    v_mfma_f32_16x16x32_bf16 v[240:243], v[80:83], v[144:147], v[240:243]
    s_sub_u32 s48, s48, 1
    s_cmp_lg_u32 s48, 0
    s_cbranch_scc1 qkv_loop_v
    s_waitcnt lgkmcnt(12)
    v_mfma_f32_16x16x32_bf16 v[180:183], v[84:87], v[148:151], v[180:183]
    v_mfma_f32_16x16x32_bf16 v[184:187], v[88:91], v[148:151], v[184:187]
    v_mfma_f32_16x16x32_bf16 v[188:191], v[92:95], v[148:151], v[188:191]
    v_mfma_f32_16x16x32_bf16 v[192:195], v[96:99], v[148:151], v[192:195]
    s_waitcnt lgkmcnt(0)
    s_barrier
    v_mfma_f32_16x16x32_bf16 v[196:199], v[84:87], v[152:155], v[196:199]
    v_mfma_f32_16x16x32_bf16 v[200:203], v[88:91], v[152:155], v[200:203]
    v_mfma_f32_16x16x32_bf16 v[204:207], v[92:95], v[152:155], v[204:207]
    v_mfma_f32_16x16x32_bf16 v[208:211], v[96:99], v[152:155], v[208:211]
    v_mfma_f32_16x16x32_bf16 v[212:215], v[84:87], v[156:159], v[212:215]
    v_mfma_f32_16x16x32_bf16 v[216:219], v[88:91], v[156:159], v[216:219]
    v_mfma_f32_16x16x32_bf16 v[220:223], v[92:95], v[156:159], v[220:223]
    v_mfma_f32_16x16x32_bf16 v[224:227], v[96:99], v[156:159], v[224:227]
    v_mfma_f32_16x16x32_bf16 v[228:231], v[84:87], v[160:163], v[228:231]
    v_mfma_f32_16x16x32_bf16 v[232:235], v[88:91], v[160:163], v[232:235]
    v_mfma_f32_16x16x32_bf16 v[236:239], v[92:95], v[160:163], v[236:239]
    v_mfma_f32_16x16x32_bf16 v[240:243], v[96:99], v[160:163], v[240:243]
    s_barrier
    v_mfma_f32_16x16x32_bf16 v[180:183], v[100:103], v[164:167], v[180:183]
    ds_read_b64 v[116:117], v47 offset:0
    ds_read_b64 v[118:119], v47 offset:128
    ds_read_b64 v[120:121], v48 offset:0
    v_mfma_f32_16x16x32_bf16 v[184:187], v[104:107], v[164:167], v[184:187]
    ds_read_b64 v[122:123], v48 offset:128
    ds_read_b32 v124, v49 offset:0
    ds_read_b32 v125, v49 offset:64
    v_mfma_f32_16x16x32_bf16 v[188:191], v[108:111], v[164:167], v[188:191]
    ds_read_b32 v126, v50 offset:0
    ds_read_b32 v127, v50 offset:64
    v_mfma_f32_16x16x32_bf16 v[192:195], v[112:115], v[164:167], v[192:195]
    v_mfma_f32_16x16x32_bf16 v[196:199], v[100:103], v[168:171], v[196:199]
    v_mfma_f32_16x16x32_bf16 v[200:203], v[104:107], v[168:171], v[200:203]
    s_waitcnt lgkmcnt(0)
    v_mfma_f32_16x16x32_bf16 v[204:207], v[108:111], v[168:171], v[204:207]
    v_sub_f32 v144, 0, v116
    v_cndmask_b32_e64 v144, 0, v144, s[52:53]
    v_and_b32 v145, 0xffff0000, v144
    v_sub_f32 v144, v144, v145
    v_mfma_f32_16x16x32_bf16 v[208:211], v[112:115], v[168:171], v[208:211]
    v_cvt_pk_bf16_f32 v128, v145, v145
    v_cvt_pk_bf16_f32 v129, v144, v144
    v_sub_f32 v144, 0, v118
    v_cndmask_b32_e64 v144, 0, v144, s[52:53]
    v_mfma_f32_16x16x32_bf16 v[212:215], v[100:103], v[172:175], v[212:215]
    v_and_b32 v145, 0xffff0000, v144
    v_sub_f32 v144, v144, v145
    v_cvt_pk_bf16_f32 v130, v145, v145
    v_cvt_pk_bf16_f32 v131, v144, v144
    v_mfma_f32_16x16x32_bf16 v[216:219], v[104:107], v[172:175], v[216:219]
    v_sub_f32 v144, 0, v120
    v_cndmask_b32_e64 v144, 0, v144, s[52:53]
    v_and_b32 v145, 0xffff0000, v144
    v_sub_f32 v144, v144, v145
    v_mfma_f32_16x16x32_bf16 v[220:223], v[108:111], v[172:175], v[220:223]
    v_cvt_pk_bf16_f32 v132, v145, v145
    v_cvt_pk_bf16_f32 v133, v144, v144
    v_sub_f32 v144, 0, v122
    v_cndmask_b32_e64 v144, 0, v144, s[52:53]
    v_mfma_f32_16x16x32_bf16 v[224:227], v[112:115], v[172:175], v[224:227]
    v_and_b32 v145, 0xffff0000, v144
    v_sub_f32 v144, v144, v145
    v_cvt_pk_bf16_f32 v134, v145, v145
    v_cvt_pk_bf16_f32 v135, v144, v144
    v_mfma_f32_16x16x32_bf16 v[228:231], v[100:103], v[176:179], v[228:231]
    v_and_b32 v145, 0xffff0000, v124
    v_sub_f32 v144, v124, v145
    v_cvt_pk_bf16_f32 v136, v145, v144
    v_mov_b32 v137, v136
    v_mfma_f32_16x16x32_bf16 v[232:235], v[104:107], v[176:179], v[232:235]
    v_and_b32 v145, 0xffff0000, v125
    v_sub_f32 v144, v125, v145
    v_cvt_pk_bf16_f32 v138, v145, v144
    v_mov_b32 v139, v138
    v_mfma_f32_16x16x32_bf16 v[236:239], v[108:111], v[176:179], v[236:239]
    v_and_b32 v145, 0xffff0000, v126
    v_sub_f32 v144, v126, v145
    v_cvt_pk_bf16_f32 v140, v145, v144
    v_mov_b32 v141, v140
    v_mfma_f32_16x16x32_bf16 v[240:243], v[112:115], v[176:179], v[240:243]
    v_and_b32 v145, 0xffff0000, v127
    v_sub_f32 v144, v127, v145
    v_cvt_pk_bf16_f32 v142, v145, v144
    v_mov_b32 v143, v142
    ds_read_b128 v[52:55], v34 offset:0
    ds_read_b128 v[56:59], v34 offset:16
    ds_read_b128 v[60:63], v34 offset:128
    ds_read_b128 v[64:67], v34 offset:144
    ds_read_b128 v[68:71], v35 offset:0
    ds_read_b128 v[72:75], v35 offset:16
    ds_read_b128 v[76:79], v35 offset:128
    ds_read_b128 v[80:83], v35 offset:144
    v_mfma_f32_16x16x16bf16_1k v[180:183], v[128:129], v[136:137], v[180:183]
    v_mfma_f32_16x16x16bf16_1k v[196:199], v[128:129], v[138:139], v[196:199]
    v_mfma_f32_16x16x16bf16_1k v[212:215], v[128:129], v[140:141], v[212:215]
    v_mfma_f32_16x16x16bf16_1k v[228:231], v[128:129], v[142:143], v[228:231]
    s_waitcnt lgkmcnt(0)
    s_nop 3
    v_mfma_f32_16x16x16bf16_1k v[184:187], v[130:131], v[136:137], v[184:187]
    v_mfma_f32_16x16x16bf16_1k v[200:203], v[130:131], v[138:139], v[200:203]
    v_mul_f32 v180, v53, v180
    v_mul_f32 v181, v55, v181
    v_mul_f32 v182, v57, v182
    v_mul_f32 v183, v59, v183
    v_cvt_pk_bf16_f32 v84, v180, v181
    v_cvt_pk_bf16_f32 v85, v182, v183
    v_mul_f32 v196, v53, v196
    v_mul_f32 v197, v55, v197
    v_mul_f32 v198, v57, v198
    v_mul_f32 v199, v59, v199
    v_cvt_pk_bf16_f32 v86, v196, v197
    v_cvt_pk_bf16_f32 v87, v198, v199
    s_nop 1
    v_permlane32_swap_b32 v84, v86
    v_permlane32_swap_b32 v85, v87
    buffer_store_dwordx4 v[84:87], v32, s[4:7], s50 offen offset:0 sc1
    v_mfma_f32_16x16x16bf16_1k v[216:219], v[130:131], v[140:141], v[216:219]
    v_mfma_f32_16x16x16bf16_1k v[232:235], v[130:131], v[142:143], v[232:235]
    v_mul_f32 v212, v53, v212
    v_mul_f32 v213, v55, v213
    v_mul_f32 v214, v57, v214
    v_mul_f32 v215, v59, v215
    v_cvt_pk_bf16_f32 v88, v212, v213
    v_cvt_pk_bf16_f32 v89, v214, v215
    v_mul_f32 v228, v53, v228
    v_mul_f32 v229, v55, v229
    v_mul_f32 v230, v57, v230
    v_mul_f32 v231, v59, v231
    v_cvt_pk_bf16_f32 v90, v228, v229
    v_cvt_pk_bf16_f32 v91, v230, v231
    s_nop 1
    v_permlane32_swap_b32 v88, v90
    v_permlane32_swap_b32 v89, v91
    buffer_store_dwordx4 v[88:91], v33, s[4:7], s50 offen offset:0 sc1
    v_mfma_f32_16x16x16bf16_1k v[188:191], v[132:133], v[136:137], v[188:191]
    v_mfma_f32_16x16x16bf16_1k v[204:207], v[132:133], v[138:139], v[204:207]
    v_mul_f32 v184, v61, v184
    v_mul_f32 v185, v63, v185
    v_mul_f32 v186, v65, v186
    v_mul_f32 v187, v67, v187
    v_cvt_pk_bf16_f32 v92, v184, v185
    v_cvt_pk_bf16_f32 v93, v186, v187
    v_mul_f32 v200, v61, v200
    v_mul_f32 v201, v63, v201
    v_mul_f32 v202, v65, v202
    v_mul_f32 v203, v67, v203
    v_cvt_pk_bf16_f32 v94, v200, v201
    v_cvt_pk_bf16_f32 v95, v202, v203
    s_nop 1
    v_permlane32_swap_b32 v92, v94
    v_permlane32_swap_b32 v93, v95
    buffer_store_dwordx4 v[92:95], v32, s[4:7], s50 offen offset:640 sc1
    v_mfma_f32_16x16x16bf16_1k v[220:223], v[132:133], v[140:141], v[220:223]
    v_mfma_f32_16x16x16bf16_1k v[236:239], v[132:133], v[142:143], v[236:239]
    v_mul_f32 v216, v61, v216
    v_mul_f32 v217, v63, v217
    v_mul_f32 v218, v65, v218
    v_mul_f32 v219, v67, v219
    v_cvt_pk_bf16_f32 v96, v216, v217
    v_cvt_pk_bf16_f32 v97, v218, v219
    v_mul_f32 v232, v61, v232
    v_mul_f32 v233, v63, v233
    v_mul_f32 v234, v65, v234
    v_mul_f32 v235, v67, v235
    v_cvt_pk_bf16_f32 v98, v232, v233
    v_cvt_pk_bf16_f32 v99, v234, v235
    s_nop 1
    v_permlane32_swap_b32 v96, v98
    v_permlane32_swap_b32 v97, v99
    buffer_store_dwordx4 v[96:99], v33, s[4:7], s50 offen offset:640 sc1
    v_mfma_f32_16x16x16bf16_1k v[192:195], v[134:135], v[136:137], v[192:195]
    v_mfma_f32_16x16x16bf16_1k v[208:211], v[134:135], v[138:139], v[208:211]
    v_mul_f32 v188, v69, v188
    v_mul_f32 v189, v71, v189
    v_mul_f32 v190, v73, v190
    v_mul_f32 v191, v75, v191
    v_cvt_pk_bf16_f32 v84, v188, v189
    v_cvt_pk_bf16_f32 v85, v190, v191
    v_mul_f32 v204, v69, v204
    v_mul_f32 v205, v71, v205
    v_mul_f32 v206, v73, v206
    v_mul_f32 v207, v75, v207
    v_cvt_pk_bf16_f32 v86, v204, v205
    v_cvt_pk_bf16_f32 v87, v206, v207
    s_nop 1
    v_permlane32_swap_b32 v84, v86
    v_permlane32_swap_b32 v85, v87
    buffer_store_dwordx4 v[84:87], v32, s[4:7], s51 offen offset:0 sc1
    v_mfma_f32_16x16x16bf16_1k v[224:227], v[134:135], v[140:141], v[224:227]
    v_mfma_f32_16x16x16bf16_1k v[240:243], v[134:135], v[142:143], v[240:243]
    v_mul_f32 v220, v69, v220
    v_mul_f32 v221, v71, v221
    v_mul_f32 v222, v73, v222
    v_mul_f32 v223, v75, v223
    v_cvt_pk_bf16_f32 v88, v220, v221
    v_cvt_pk_bf16_f32 v89, v222, v223
    v_mul_f32 v236, v69, v236
    v_mul_f32 v237, v71, v237
    v_mul_f32 v238, v73, v238
    v_mul_f32 v239, v75, v239
    v_cvt_pk_bf16_f32 v90, v236, v237
    v_cvt_pk_bf16_f32 v91, v238, v239
    s_nop 1
    v_permlane32_swap_b32 v88, v90
    v_permlane32_swap_b32 v89, v91
    buffer_store_dwordx4 v[88:91], v33, s[4:7], s51 offen offset:0 sc1
    v_mul_f32 v192, v77, v192
    v_mul_f32 v193, v79, v193
    v_mul_f32 v194, v81, v194
    v_mul_f32 v195, v83, v195
    v_cvt_pk_bf16_f32 v92, v192, v193
    v_cvt_pk_bf16_f32 v93, v194, v195
    v_mul_f32 v208, v77, v208
    v_mul_f32 v209, v79, v209
    v_mul_f32 v210, v81, v210
    v_mul_f32 v211, v83, v211
    v_cvt_pk_bf16_f32 v94, v208, v209
    v_cvt_pk_bf16_f32 v95, v210, v211
    s_nop 1
    v_permlane32_swap_b32 v92, v94
    v_permlane32_swap_b32 v93, v95
    buffer_store_dwordx4 v[92:95], v32, s[4:7], s51 offen offset:640 sc1
    v_mul_f32 v224, v77, v224
    v_mul_f32 v225, v79, v225
    v_mul_f32 v226, v81, v226
    v_mul_f32 v227, v83, v227
    v_cvt_pk_bf16_f32 v96, v224, v225
    v_cvt_pk_bf16_f32 v97, v226, v227
    v_mul_f32 v240, v77, v240
    v_mul_f32 v241, v79, v241
    v_mul_f32 v242, v81, v242
    v_mul_f32 v243, v83, v243
    v_cvt_pk_bf16_f32 v98, v240, v241
    v_cvt_pk_bf16_f32 v99, v242, v243
    s_nop 1
    v_permlane32_swap_b32 v96, v98
    v_permlane32_swap_b32 v97, v99
    buffer_store_dwordx4 v[96:99], v33, s[4:7], s51 offen offset:640 sc1
qkv_out:
    s_waitcnt vmcnt(0)
L_h1:
    s_and_b32 s21, s2, 7
    s_lshl_b32 s24, s21, 7
    s_add_u32 s24, s24, 26738688
    v_mul_u32_u24 v4, 1024, v1
    v_mov_b32 v5, 1
    s_barrier
    s_cmp_lg_u32 s3, 7
    s_cbranch_scc1 L_h1_8
    s_cmp_ge_u32 s2, 240
    s_cbranch_scc1 L_h1_8
    s_mov_b64 exec, 0xff
    buffer_atomic_add v5, v4, s[4:7], s24 offen sc1
    s_mov_b64 exec, -1
L_h1_8:
    s_and_b32 s22, s2, 7
    s_lshl_b32 s22, s22, 3
    s_mov_b32 s23, s22
    s_getpc_b64 s[26:27]
L_pc_9:
    s_sub_u32 s26, s26, L_pc_9 - sequential_preLN__softmax_full_mha__swiglu_ffn__prompt_kernel
    s_subb_u32 s27, s27, 0
    s_cmp_lg_u32 s3, 6
    s_cbranch_scc1 L_cw_10
    s_cmp_ge_u32 s2, 16
    s_cbranch_scc1 L_cw_10
    v_lshlrev_b32 v3, 7, v1
    v_add_u32 v3, L_att0 - sequential_preLN__softmax_full_mha__swiglu_ffn__prompt_kernel + 0, v3
    v_min_u32 v3, att_st - sequential_preLN__softmax_full_mha__swiglu_ffn__prompt_kernel - 4, v3
    global_load_dword v182, v3, s[26:27]
    v_lshlrev_b32 v3, 7, v1
    v_add_u32 v3, L_att0 - sequential_preLN__softmax_full_mha__swiglu_ffn__prompt_kernel + 8192, v3
    v_min_u32 v3, att_st - sequential_preLN__softmax_full_mha__swiglu_ffn__prompt_kernel - 4, v3
    global_load_dword v182, v3, s[26:27]
    v_lshlrev_b32 v3, 7, v1
    v_add_u32 v3, L_ool - sequential_preLN__softmax_full_mha__swiglu_ffn__prompt_kernel + 0, v3
    v_min_u32 v3, att_slow1 - sequential_preLN__softmax_full_mha__swiglu_ffn__prompt_kernel - 4, v3
    global_load_dword v182, v3, s[26:27]
L_cw_10:
    s_mul_i32 s60, s3, 5120
    s_add_u32 s60, s60, 61440
    v_and_b32 v3, 3, v1
    v_bfe_u32 v6, v1, 2, 2
    v_lshrrev_b32 v7, 4, v1
    s_cmp_ge_u32 s2, 120
    s_cbranch_scc1 prep_sk
    s_load_dwordx2 s[8:9], s[0:1], 32
    s_load_dwordx2 s[12:13], s[0:1], 40
    s_mul_i32 s61, s2, 52429
    s_lshr_b32 s61, s61, 18
    s_mul_i32 s62, s61, 5
    s_sub_u32 s62, s2, s62
    s_lshl_b32 s63, s62, 3
    s_add_u32 s63, s63, s3
    v_lshrrev_b32 v235, 3, v1
    v_mul_u32_u24 v235, 3072, v235
    v_and_b32 v236, 7, v1
    v_lshl_add_u32 v235, v236, 4, v235
    s_mul_i32 s64, s63, 49152
    s_lshl_b32 s65, s61, 7
    s_add_u32 s64, s64, s65
    v_add_u32 v220, s64, v235
    v_add_u32 v221, 24576, v220
    v_mov_b32 v222, v220
    v_mov_b32 v223, v221
    v_mov_b32 v224, v221
    v_and_b32 v236, 1, v7
    v_lshrrev_b32 v235, 1, v7
    v_lshl_add_u32 v235, v235, 3, v6
    v_lshlrev_b32 v235, 7, v235
    v_lshl_add_u32 v235, v236, 11, v235
    v_lshl_add_u32 v235, v3, 3, v235
    v_add_u32 v235, s60, v235
    v_add_u32 v225, 0, v235
    v_add_u32 v226, 512, v235
    v_add_u32 v227, 32, v235
    v_add_u32 v228, 544, v235
    v_add_u32 v229, 64, v235
    v_add_u32 v230, 576, v235
    v_add_u32 v231, 96, v235
    v_add_u32 v232, 608, v235
    v_add_u32 v233, 0, v235
    v_add_u32 v234, 512, v235
    s_lshl_b32 s57, s61, 2
    s_add_u32 s57, s57, 0
    s_mul_i32 s59, s57, 43691
    s_lshr_b32 s59, s59, 18
    s_mul_i32 s58, s59, 6
    s_sub_u32 s58, s57, s58
    s_mul_i32 s59, s59, 40
    s_add_u32 s59, s59, s63
    s_mul_i32 s59, s59, 6
    s_add_u32 s59, s59, s58
    s_lshl_b32 s59, s59, 10
    s_add_u32 s64, s59, 20250624
    s_lshl_b32 s57, s61, 2
    s_add_u32 s57, s57, 1
    s_mul_i32 s59, s57, 43691
    s_lshr_b32 s59, s59, 18
    s_mul_i32 s58, s59, 6
    s_sub_u32 s58, s57, s58
    s_mul_i32 s59, s59, 40
    s_add_u32 s59, s59, s63
    s_mul_i32 s59, s59, 6
    s_add_u32 s59, s59, s58
    s_lshl_b32 s59, s59, 10
    s_add_u32 s65, s59, 20250624
    s_lshl_b32 s57, s61, 2
    s_add_u32 s57, s57, 2
    s_mul_i32 s59, s57, 43691
    s_lshr_b32 s59, s59, 18
    s_mul_i32 s58, s59, 6
    s_sub_u32 s58, s57, s58
    s_mul_i32 s59, s59, 40
    s_add_u32 s59, s59, s63
    s_mul_i32 s59, s59, 6
    s_add_u32 s59, s59, s58
    s_lshl_b32 s59, s59, 10
    s_add_u32 s66, s59, 20250624
    s_lshl_b32 s57, s61, 2
    s_add_u32 s57, s57, 3
    s_mul_i32 s59, s57, 43691
    s_lshr_b32 s59, s59, 18
    s_mul_i32 s58, s59, 6
    s_sub_u32 s58, s57, s58
    s_mul_i32 s59, s59, 40
    s_add_u32 s59, s59, s63
    s_mul_i32 s59, s59, 6
    s_add_u32 s59, s59, s58
    s_lshl_b32 s59, s59, 10
    s_add_u32 s67, s59, 20250624
    s_mov_b32 s68, 33554432
    s_waitcnt lgkmcnt(0)
    s_and_b32 s9, s9, 0xffff
    s_mov_b32 s10, 0x1e0000
    s_mov_b32 s11, 0x20000
    s_and_b32 s13, s13, 0xffff
    s_mov_b32 s14, 0x1e0000
    s_mov_b32 s15, 0x20000
    s_branch prep_done
prep_sk:
    v_add_u32 v235, 0, v1
    v_mul_u32_u24 v220, 6554, v235
    v_lshrrev_b32 v220, 16, v220
    v_mul_u32_u24 v236, 10, v220
    v_sub_u32 v237, v235, v236
    v_add_u32 v235, 64, v1
    v_mul_u32_u24 v221, 6554, v235
    v_lshrrev_b32 v221, 16, v221
    v_mul_u32_u24 v236, 10, v221
    v_sub_u32 v238, v235, v236
    v_add_u32 v235, 128, v1
    v_mul_u32_u24 v222, 6554, v235
    v_lshrrev_b32 v222, 16, v222
    v_mul_u32_u24 v236, 10, v222
    v_sub_u32 v239, v235, v236
    v_add_u32 v235, 192, v1
    v_mul_u32_u24 v223, 6554, v235
    v_lshrrev_b32 v223, 16, v223
    v_mul_u32_u24 v236, 10, v223
    v_sub_u32 v240, v235, v236
    v_add_u32 v235, 256, v1
    v_mul_u32_u24 v224, 6554, v235
    v_lshrrev_b32 v224, 16, v224
    v_mul_u32_u24 v236, 10, v224
    v_sub_u32 v241, v235, v236
    s_lshl_b32 s59, s2, 3
    s_add_u32 s59, s59, s3
    s_cmp_ge_u32 s2, 168
    s_cbranch_scc1 prep_wo
    s_load_dwordx2 s[8:9], s[0:1], 48
    s_sub_u32 s61, s59, 960
    s_mul_i32 s62, s61, 43691
    s_lshr_b32 s62, s62, 21
    s_mul_i32 s63, s62, 48
    s_sub_u32 s63, s61, s63
    s_lshl_b32 s65, s63, 5
    v_add_u32 v220, s65, v220
    v_add_u32 v221, s65, v221
    v_add_u32 v222, s65, v222
    v_add_u32 v223, s65, v223
    v_add_u32 v224, s65, v224
    s_mul_i32 s64, s61, 5120
    s_add_u32 s64, s64, 24182784
    s_waitcnt lgkmcnt(0)
    s_and_b32 s9, s9, 0xffff
    s_mov_b32 s10, 0x1e0000
    s_mov_b32 s11, 0x20000
    s_branch prep_sk2
prep_wo:
    s_load_dwordx2 s[8:9], s[0:1], 16
    s_sub_u32 s61, s59, 1344
    s_mul_i32 s62, s61, 52429
    s_lshr_b32 s62, s62, 20
    s_mul_i32 s63, s62, 20
    s_sub_u32 s63, s61, s63
    s_mul_i32 s64, s61, 5120
    s_add_u32 s64, s64, 19398656
    s_waitcnt lgkmcnt(0)
    s_and_b32 s9, s9, 0xffff
    s_mov_b32 s10, 0xc8000
    s_mov_b32 s11, 0x20000
    s_cmp_ge_u32 s2, 188
    s_cselect_b32 s10, 0, s10
    s_cselect_b32 s64, 33554432, s64
    s_cmp_ge_u32 s63, 16
    s_cbranch_scc1 prep_rem
    s_mul_i32 s65, s63, 40
    v_lshrrev_b32 v235, 4, v220
    v_lshl_add_u32 v220, v235, 2, v220
    v_add_u32 v220, s65, v220
    v_lshrrev_b32 v235, 4, v221
    v_lshl_add_u32 v221, v235, 2, v221
    v_add_u32 v221, s65, v221
    v_lshrrev_b32 v235, 4, v222
    v_lshl_add_u32 v222, v235, 2, v222
    v_add_u32 v222, s65, v222
    v_lshrrev_b32 v235, 4, v223
    v_lshl_add_u32 v223, v235, 2, v223
    v_add_u32 v223, s65, v223
    v_lshrrev_b32 v235, 4, v224
    v_lshl_add_u32 v224, v235, 2, v224
    v_add_u32 v224, s65, v224
    s_branch prep_sk2
prep_rem:
    s_sub_u32 s65, s63, 16
    s_mul_i32 s65, s65, 160
    s_add_u32 s65, s65, 16
    v_bfe_u32 v235, v220, 4, 1
    v_bfe_u32 v236, v220, 2, 1
    v_lshl_add_u32 v235, v235, 1, v236
    v_bfe_u32 v236, v220, 3, 1
    v_lshl_add_u32 v235, v235, 1, v236
    v_mul_u32_u24 v235, 20, v235
    v_and_b32 v236, 3, v220
    v_add3_u32 v220, v235, v236, s65
    v_bfe_u32 v235, v221, 4, 1
    v_bfe_u32 v236, v221, 2, 1
    v_lshl_add_u32 v235, v235, 1, v236
    v_bfe_u32 v236, v221, 3, 1
    v_lshl_add_u32 v235, v235, 1, v236
    v_mul_u32_u24 v235, 20, v235
    v_and_b32 v236, 3, v221
    v_add3_u32 v221, v235, v236, s65
    v_bfe_u32 v235, v222, 4, 1
    v_bfe_u32 v236, v222, 2, 1
    v_lshl_add_u32 v235, v235, 1, v236
    v_bfe_u32 v236, v222, 3, 1
    v_lshl_add_u32 v235, v235, 1, v236
    v_mul_u32_u24 v235, 20, v235
    v_and_b32 v236, 3, v222
    v_add3_u32 v222, v235, v236, s65
    v_bfe_u32 v235, v223, 4, 1
    v_bfe_u32 v236, v223, 2, 1
    v_lshl_add_u32 v235, v235, 1, v236
    v_bfe_u32 v236, v223, 3, 1
    v_lshl_add_u32 v235, v235, 1, v236
    v_mul_u32_u24 v235, 20, v235
    v_and_b32 v236, 3, v223
    v_add3_u32 v223, v235, v236, s65
    v_bfe_u32 v235, v224, 4, 1
    v_bfe_u32 v236, v224, 2, 1
    v_lshl_add_u32 v235, v235, 1, v236
    v_bfe_u32 v236, v224, 3, 1
    v_lshl_add_u32 v235, v235, 1, v236
    v_mul_u32_u24 v235, 20, v235
    v_and_b32 v236, 3, v224
    v_add3_u32 v224, v235, v236, s65
prep_sk2:
    s_mul_i32 s65, s62, 160
    v_mul_u32_u24 v220, 1280, v220
    v_lshl_add_u32 v220, v237, 4, v220
    v_add_u32 v220, s65, v220
    v_mul_u32_u24 v221, 1280, v221
    v_lshl_add_u32 v221, v238, 4, v221
    v_add_u32 v221, s65, v221
    v_mul_u32_u24 v222, 1280, v222
    v_lshl_add_u32 v222, v239, 4, v222
    v_add_u32 v222, s65, v222
    v_mul_u32_u24 v223, 1280, v223
    v_lshl_add_u32 v223, v240, 4, v223
    v_add_u32 v223, s65, v223
    v_mul_u32_u24 v224, 1280, v224
    v_lshl_add_u32 v224, v241, 4, v224
    v_add_u32 v224, s65, v224
    v_lshrrev_b32 v235, 1, v7
    v_and_b32 v236, 1, v7
    v_lshl_add_u32 v235, v235, 2, v236
    v_lshl_add_u32 v235, v235, 2, v6
    v_mul_u32_u24 v235, 160, v235
    v_add_u32 v235, s60, v235
    v_lshl_add_u32 v236, v3, 3, v235
    v_lshl_add_u32 v235, v3, 4, v235
    v_add_u32 v225, 0, v235
    v_add_u32 v226, 1280, v235
    v_add_u32 v227, 8, v235
    v_add_u32 v228, 1288, v235
    v_add_u32 v229, 64, v235
    v_add_u32 v230, 1344, v235
    v_add_u32 v231, 72, v235
    v_add_u32 v232, 1352, v235
    v_add_u32 v233, 128, v236
    v_add_u32 v234, 1408, v236
    s_add_u32 s65, s64, 1024
    s_add_u32 s66, s64, 2048
    s_add_u32 s67, s64, 3072
    s_add_u32 s68, s64, 4096
    s_mov_b32 s12, s8
    s_mov_b32 s13, s9
    s_mov_b32 s14, s10
    s_mov_b32 s15, s11
prep_done:
    v_mov_b32 v7, 0x3f803f80
    s_mov_b32 s58, 0xff
    s_mov_b32 s59, s58
    v_cndmask_b32_e64 v240, 0, v7, s[58:59]
    v_cndmask_b32_e64 v241, 0, v7, s[58:59]
    v_cndmask_b32_e64 v242, 0, v7, s[58:59]
    v_cndmask_b32_e64 v243, 0, v7, s[58:59]
    s_mov_b32 s58, 0xff00
    s_mov_b32 s59, s58
    v_cndmask_b32_e64 v244, 0, v7, s[58:59]
    v_cndmask_b32_e64 v245, 0, v7, s[58:59]
    v_cndmask_b32_e64 v246, 0, v7, s[58:59]
    v_cndmask_b32_e64 v247, 0, v7, s[58:59]
    s_mov_b32 s58, 0xff0000
    s_mov_b32 s59, s58
    v_cndmask_b32_e64 v248, 0, v7, s[58:59]
    v_cndmask_b32_e64 v249, 0, v7, s[58:59]
    v_cndmask_b32_e64 v250, 0, v7, s[58:59]
    v_cndmask_b32_e64 v251, 0, v7, s[58:59]
    s_mov_b32 s58, 0xff000000
    s_mov_b32 s59, s58
    v_cndmask_b32_e64 v252, 0, v7, s[58:59]
    v_cndmask_b32_e64 v253, 0, v7, s[58:59]
    v_cndmask_b32_e64 v254, 0, v7, s[58:59]
    v_cndmask_b32_e64 v255, 0, v7, s[58:59]
    s_lshl_b32 s59, s3, 9
    s_add_u32 s59, s59, 102400
    v_and_b32 v239, 31, v1
    v_lshl_add_u32 v239, v239, 2, s59
    s_cmp_lt_u32 s2, 120
    s_cselect_b32 s56, s3, 8
    s_and_b32 s20, s2, 7
    s_lshr_b32 s21, s2, 3
    s_lshl_b32 s30, s20, 2
    s_and_b32 s22, s21, 3
    s_add_u32 s30, s30, s22
    s_lshr_b32 s31, s21, 2
    s_and_b32 s20, s2, 7
    s_lshr_b32 s21, s2, 3
    s_lshr_b32 s22, s20, 1
    s_lshl_b32 s70, s22, 3
    s_lshr_b32 s22, s21, 2
    s_add_u32 s70, s70, s22
    s_and_b32 s22, s20, 1
    s_lshl_b32 s71, s22, 2
    s_and_b32 s22, s21, 3
    s_add_u32 s71, s71, s22
    s_mov_b32 s77, 0
    s_and_b32 s32, s3, 3
    s_lshr_b32 s33, s3, 2
    s_mul_i32 s36, s30, 163840
    s_add_u32 s36, s36, 2621440
    s_lshl_b32 s37, s33, 5
    s_add_u32 s37, s37, s32
    s_mul_i32 s37, s37, 2560
    s_add_u32 s37, s37, s36
    s_mul_i32 s38, s3, 2560
    s_lshl_b32 s34, s31, 3
    s_lshl_b32 s35, s32, 1
    s_add_u32 s34, s34, s35
    s_mul_i32 s39, s30, 64
    s_add_u32 s39, s39, s34
    s_mul_i32 s39, s39, 1280
    s_add_u32 s40, s39, 0
    v_lshlrev_b32 v145, 3, v1
    v_mov_b32 v32, 0
    v_mov_b32 v33, 0
    v_mov_b32 v34, 0
    v_mov_b32 v35, 0
    v_and_b32 v3, 31, v1
    v_lshrrev_b32 v6, 5, v1
    s_mul_i32 s44, s33, 10240
    v_add_u32 v144, s44, v2
    v_add_u32 v156, s44, v145
    v_mul_u32_u24 v7, 320, v6
    v_lshl_add_u32 v7, v3, 4, v7
    v_add_u32 v146, s44, v7
    s_mov_b32 s46, 0x11000000
    s_mov_b32 s47, 0x11000000
    v_mov_b32 v6, 0x3f803f80
    v_cndmask_b32_e64 v7, 0, v6, s[46:47]
    v_mov_b32 v128, v7
    v_mov_b32 v129, v7
    v_mov_b32 v130, v7
    v_mov_b32 v131, v7
    v_mov_b32 v132, v7
    v_mov_b32 v133, v7
    v_mov_b32 v134, v7
    v_mov_b32 v135, v7
    v_mov_b32 v124, v6
    v_mov_b32 v125, 0
    v_mov_b32 v136, v7
    v_mov_b32 v137, v7
    v_mov_b32 v138, v7
    v_mov_b32 v139, v7
    v_mov_b32 v140, v7
    v_mov_b32 v141, v7
    v_mov_b32 v142, v7
    v_mov_b32 v143, v7
    v_mov_b32 v126, v6
    v_mov_b32 v127, 0
    v_mov_b32 v84, 0
    v_mov_b32 v85, 0
    v_mov_b32 v86, 0
    v_mov_b32 v87, 0
    v_mov_b32 v88, 0
    v_mov_b32 v89, 0
    v_mov_b32 v90, 0
    v_mov_b32 v91, 0
    v_mov_b32 v92, 0
    v_mov_b32 v93, 0
    v_mov_b32 v94, 0
    v_mov_b32 v95, 0
    v_mov_b32 v96, 0
    v_mov_b32 v97, 0
    v_mov_b32 v98, 0
    v_mov_b32 v99, 0
    v_mov_b32 v100, 0
    v_mov_b32 v101, 0
    v_mov_b32 v102, 0
    v_mov_b32 v103, 0
    v_mov_b32 v104, 0
    v_mov_b32 v105, 0
    v_mov_b32 v106, 0
    v_mov_b32 v107, 0
    v_mov_b32 v108, 0
    v_mov_b32 v109, 0
    v_mov_b32 v110, 0
    v_mov_b32 v111, 0
    v_mov_b32 v112, 0
    v_mov_b32 v113, 0
    v_mov_b32 v114, 0
    v_mov_b32 v115, 0
    v_mov_b32 v80, 0
    v_mov_b32 v81, 0
    v_mov_b32 v82, 0
    v_mov_b32 v83, 0
    v_mov_b32 v184, 0
    v_mov_b32 v185, 0
    v_mov_b32 v186, 0
    v_mov_b32 v187, 0
    v_mov_b32 v188, 0
    v_mov_b32 v189, 0
    v_mov_b32 v190, 0
    v_mov_b32 v191, 0
    v_mov_b32 v192, 0
    v_mov_b32 v193, 0
    s_mul_i32 s72, s71, 102400
    s_mul_i32 s73, s3, 12800
    s_add_u32 s72, s72, s73
    s_add_u32 s72, s72, 19398656
    s_add_u32 s73, s73, 61440
    v_lshlrev_b32 v147, 7, v1
    v_add_u32 v147, 26746880, v147
    s_lshl_b32 s46, s3, 12
    v_add_u32 v149, s46, v2
    v_xor_b32 v150, 0x4000, v149
    s_add_u32 s34, s34, s33
    s_mul_i32 s47, s34, 40960
    s_add_u32 s47, s47, 7864320
    s_lshl_b32 s48, s30, 10
    s_add_u32 s48, s48, s47
    s_lshl_b32 s49, s30, 8
    s_add_u32 s49, s49, s47
    s_add_u32 s49, s49, 32768
    s_mov_b32 s51, 0x63800000
    s_mov_b32 s50, 0x2b800000
    s_lshr_b32 s21, s2, 3
    s_lshl_b32 s21, s21, 3
    s_add_u32 s21, s21, s3
    s_and_b32 s20, s2, 1
    s_mul_i32 s54, s20, 1966080
    s_mul_i32 s22, s21, 7680
    s_add_u32 s54, s54, s22
    s_add_u32 s54, s54, 20250624
    v_min_u32 v3, 59, v1
    v_lshlrev_b32 v152, 7, v3
    s_mul_i32 s55, s20, 983040
    s_mul_i32 s22, s21, 3840
    s_add_u32 s55, s55, s22
    s_add_u32 s55, s55, 24182784
    v_min_u32 v3, 29, v1
    v_lshlrev_b32 v153, 7, v3
    s_lshl_b32 s74, s70, 6
    s_lshl_b32 s75, s32, 4
    s_add_u32 s74, s74, s75
    s_mul_i32 s74, s74, 1280
    s_mul_i32 s75, s71, 160
    s_add_u32 s74, s74, s75
    v_and_b32 v3, 15, v1
    v_lshrrev_b32 v6, 4, v1
    v_mul_u32_u24 v3, 1280, v3
    v_lshl_add_u32 v154, v6, 4, v3
    v_lshl_add_u32 v155, v6, 3, v3
    s_mov_b32 m0, s38
    s_cmp_lg_u32 s3, 7
    s_cbranch_scc1 L_sw_11
    s_lshl_b32 s20, s23, 7
    s_add_u32 s20, s20, 26738688
    v_lshlrev_b32 v4, 7, v1
    s_mov_b64 exec, 0xff
    s_mov_b32 s88, 1048576
L_spin_12:
    buffer_load_dword v5, v4, s[4:7], s20 offen sc1
    s_waitcnt vmcnt(0)
    v_cmp_ne_u32 vcc, 30, v5
    s_sub_u32 s88, s88, 1
    s_cbranch_scc1 L_spun_13
    s_nop 2
    s_cbranch_vccnz L_spin_12
L_spun_13:
    s_mov_b64 exec, -1
L_sw_11:
    s_barrier
L_att0:
    buffer_load_dwordx4 v[24:27], v2, s[4:7], s40 offen offset:0 sc1
    buffer_load_dwordx4 v[28:31], v2, s[4:7], s40 offen offset:1280 sc1
    buffer_load_dwordx4 v[120:123], v2, s[4:7], s36 offen sc1
    s_mov_b64 exec, s[90:91]
    buffer_load_dwordx2 v[32:33], v145, s[4:7], s40 offen offset:1024 sc1
    buffer_load_dwordx2 v[34:35], v145, s[4:7], s40 offen offset:2304 sc1
    buffer_load_dwordx2 v[126:127], v145, s[4:7], s36 offen offset:1024 sc1
    s_mov_b32 m0, s38
    s_mov_b64 exec, -1
    buffer_load_dwordx4 v2, s[4:7], s37 offen offset:0 sc1 lds
    buffer_load_dwordx4 v2, s[4:7], s37 offen offset:1024 sc1 lds
    s_mov_b64 exec, s[90:91]
    buffer_load_dwordx4 v2, s[4:7], s37 offen offset:2048 sc1 lds
    s_mov_b64 exec, -1
    s_add_u32 s37, s37, 10240
    s_waitcnt vmcnt(3)
    v_mfma_f32_32x32x16_bf16 v[36:51], v[120:123], v[24:27], 0
    v_mfma_f32_32x32x16_bf16 v[52:67], v[120:123], v[28:31], 0
    v_mfma_f32_32x32x8bf16_1k v[36:51], v[126:127], v[32:33], v[36:51]
    v_mfma_f32_32x32x8bf16_1k v[52:67], v[126:127], v[34:35], v[52:67]
    s_add_u32 m0, s38, 20480
    s_nop 0
    buffer_load_dwordx4 v2, s[4:7], s37 offen offset:0 sc1 lds
    buffer_load_dwordx4 v2, s[4:7], s37 offen offset:1024 sc1 lds
    s_mov_b64 exec, s[90:91]
    buffer_load_dwordx4 v2, s[4:7], s37 offen offset:2048 sc1 lds
    s_mov_b64 exec, -1
    s_add_u32 s37, s37, 10240
    s_nop 3
    v_max3_f32 v160, v36, v37, v38
    v_max3_f32 v160, v39, v40, v160
    v_max3_f32 v160, v41, v42, v160
    v_max3_f32 v160, v43, v44, v160
    v_max3_f32 v160, v45, v46, v160
    v_max3_f32 v160, v47, v48, v160
    v_max3_f32 v160, v49, v50, v160
    v_max_f32 v160, v51, v160
    v_mov_b32 v161, v160
    s_nop 1
    v_permlane32_swap_b32 v160, v161
    v_max_f32 v160, v160, v161
    v_sub_f32 v160, 0, v160
    v_and_b32 v161, 0xffff0000, v160
    v_sub_f32 v160, v160, v161
    v_cvt_pk_bf16_f32 v160, v161, v160
    v_cndmask_b32_e64 v32, v160, v32, s[90:91]
    v_max3_f32 v160, v52, v53, v54
    v_max3_f32 v160, v55, v56, v160
    v_max3_f32 v160, v57, v58, v160
    v_max3_f32 v160, v59, v60, v160
    v_max3_f32 v160, v61, v62, v160
    v_max3_f32 v160, v63, v64, v160
    v_max3_f32 v160, v65, v66, v160
    v_max_f32 v160, v67, v160
    v_mov_b32 v161, v160
    s_nop 1
    v_permlane32_swap_b32 v160, v161
    v_max_f32 v160, v160, v161
    v_sub_f32 v160, 0, v160
    v_and_b32 v161, 0xffff0000, v160
    v_sub_f32 v160, v160, v161
    v_cvt_pk_bf16_f32 v160, v161, v160
    v_cndmask_b32_e64 v34, v160, v34, s[90:91]
    s_waitcnt vmcnt(3)
    s_barrier
    ds_read_b128 v[116:119], v144
    s_mov_b64 exec, s[90:91]
    ds_read_b64 v[124:125], v156 offset:1024
    s_mov_b64 exec, s[92:93]
    ds_read_b128 v[128:131], v146 offset:1280
    ds_read_b128 v[132:135], v146 offset:1920
    s_add_u32 m0, s38, 40960
    s_mov_b64 exec, -1
    s_waitcnt lgkmcnt(2)
    v_mfma_f32_32x32x16_bf16 v[36:51], v[116:119], v[24:27], 0
    v_mfma_f32_32x32x8bf16_1k v[36:51], v[124:125], v[32:33], v[36:51]
    buffer_load_dwordx4 v2, s[4:7], s37 offen offset:0 sc1 lds
    buffer_load_dwordx4 v2, s[4:7], s37 offen offset:1024 sc1 lds
    s_mov_b64 exec, s[90:91]
    buffer_load_dwordx4 v2, s[4:7], s37 offen offset:2048 sc1 lds
    s_mov_b64 exec, -1
    s_add_u32 s37, s37, 10240
    s_waitcnt lgkmcnt(0)
    s_nop 3
.p2align 3
    v_mfma_f32_32x32x16_bf16 v[52:67], v[116:119], v[28:31], 0
    ds_read_b128 v[120:123], v144 offset:2560
    v_exp_f32 v36, v36
    v_exp_f32 v37, v37
    v_exp_f32 v38, v38
    v_cvt_pk_bf16_f32 v68, v36, v37
    v_exp_f32 v39, v39
    v_mfma_f32_32x32x8bf16_1k v[52:67], v[124:125], v[34:35], v[52:67]
    s_setprio 2
    v_exp_f32 v40, v40
    v_cvt_pk_bf16_f32 v69, v38, v39
    v_exp_f32 v41, v41
    v_exp_f32 v42, v42
    v_cvt_pk_bf16_f32 v70, v40, v41
    v_exp_f32 v43, v43
    v_mfma_f32_32x32x16_bf16 v[100:115], v[140:143], v[80:83], v[100:115]
    s_mov_b64 exec, s[90:91]
    ds_read_b64 v[126:127], v156 offset:3584
    s_mov_b64 exec, -1
    v_exp_f32 v44, v44
    v_cvt_pk_bf16_f32 v71, v42, v43
    v_exp_f32 v45, v45
    v_exp_f32 v46, v46
    v_cvt_pk_bf16_f32 v72, v44, v45
    v_exp_f32 v47, v47
    v_mfma_f32_32x32x16_bf16 v[84:99], v[128:131], v[68:71], v[84:99]
    s_waitcnt lgkmcnt(1)
    v_exp_f32 v48, v48
    v_cvt_pk_bf16_f32 v73, v46, v47
    v_exp_f32 v49, v49
    v_exp_f32 v50, v50
    v_exp_f32 v51, v51
    v_cvt_pk_bf16_f32 v74, v48, v49
    v_cvt_pk_bf16_f32 v75, v50, v51
    v_mfma_f32_32x32x16_bf16 v[36:51], v[120:123], v[24:27], 0
    s_waitcnt lgkmcnt(0)
    v_exp_f32 v52, v52
    v_exp_f32 v53, v53
    v_exp_f32 v54, v54
    v_cvt_pk_bf16_f32 v76, v52, v53
    v_exp_f32 v55, v55
    v_mfma_f32_32x32x8bf16_1k v[36:51], v[126:127], v[32:33], v[36:51]
    v_exp_f32 v56, v56
    v_cvt_pk_bf16_f32 v77, v54, v55
    v_exp_f32 v57, v57
    v_exp_f32 v58, v58
    v_cvt_pk_bf16_f32 v78, v56, v57
    v_exp_f32 v59, v59
    v_mfma_f32_32x32x16_bf16 v[84:99], v[132:135], v[72:75], v[84:99]
    s_mov_b64 exec, s[92:93]
    ds_read_b128 v[136:139], v146 offset:3840
    s_mov_b64 exec, -1
    s_cmp_eq_u32 s3, 0
    s_cbranch_scc1 L_ool_14
L_ool_14_r:
    v_exp_f32 v60, v60
    v_cvt_pk_bf16_f32 v79, v58, v59
    v_exp_f32 v61, v61
    v_exp_f32 v62, v62
    v_cvt_pk_bf16_f32 v80, v60, v61
    v_exp_f32 v63, v63
    v_mfma_f32_32x32x16_bf16 v[100:115], v[128:131], v[76:79], v[100:115]
    s_mov_b64 exec, s[92:93]
    ds_read_b128 v[140:143], v146 offset:4480
    s_mov_b64 exec, -1
    v_exp_f32 v64, v64
    v_cvt_pk_bf16_f32 v81, v62, v63
    v_exp_f32 v65, v65
    v_exp_f32 v66, v66
    v_exp_f32 v67, v67
    v_cvt_pk_bf16_f32 v82, v64, v65
    v_cvt_pk_bf16_f32 v83, v66, v67
    v_mfma_f32_32x32x16_bf16 v[52:67], v[120:123], v[28:31], 0
    s_waitcnt lgkmcnt(1)
    ds_read_b128 v[116:119], v144 offset:5120
    v_exp_f32 v36, v36
    v_exp_f32 v37, v37
    v_exp_f32 v38, v38
    v_cvt_pk_bf16_f32 v68, v36, v37
    v_exp_f32 v39, v39
    v_mfma_f32_32x32x8bf16_1k v[52:67], v[126:127], v[34:35], v[52:67]
    s_setprio 1
    v_exp_f32 v40, v40
    v_cvt_pk_bf16_f32 v69, v38, v39
    v_exp_f32 v41, v41
    v_exp_f32 v42, v42
    v_cvt_pk_bf16_f32 v70, v40, v41
    v_exp_f32 v43, v43
    v_mfma_f32_32x32x16_bf16 v[100:115], v[132:135], v[80:83], v[100:115]
    s_mov_b64 exec, s[90:91]
    ds_read_b64 v[124:125], v156 offset:6144
    s_mov_b64 exec, -1
    s_cmp_eq_u32 s3, 1
    s_cbranch_scc1 L_ool_15
L_ool_15_r:
    v_exp_f32 v44, v44
    v_cvt_pk_bf16_f32 v71, v42, v43
    v_exp_f32 v45, v45
    v_exp_f32 v46, v46
    v_cvt_pk_bf16_f32 v72, v44, v45
    v_exp_f32 v47, v47
    v_mfma_f32_32x32x16_bf16 v[84:99], v[136:139], v[68:71], v[84:99]
    s_waitcnt lgkmcnt(1)
    v_exp_f32 v48, v48
    v_cvt_pk_bf16_f32 v73, v46, v47
    v_exp_f32 v49, v49
    v_exp_f32 v50, v50
    v_exp_f32 v51, v51
    v_cvt_pk_bf16_f32 v74, v48, v49
    v_cvt_pk_bf16_f32 v75, v50, v51
    v_mfma_f32_32x32x16_bf16 v[36:51], v[116:119], v[24:27], 0
    s_waitcnt lgkmcnt(0)
    v_exp_f32 v52, v52
    v_exp_f32 v53, v53
    v_exp_f32 v54, v54
    v_cvt_pk_bf16_f32 v76, v52, v53
    v_exp_f32 v55, v55
    v_mfma_f32_32x32x8bf16_1k v[36:51], v[124:125], v[32:33], v[36:51]
    v_exp_f32 v56, v56
    v_cvt_pk_bf16_f32 v77, v54, v55
    v_exp_f32 v57, v57
    v_exp_f32 v58, v58
    v_cvt_pk_bf16_f32 v78, v56, v57
    v_exp_f32 v59, v59
    v_mfma_f32_32x32x16_bf16 v[84:99], v[140:143], v[72:75], v[84:99]
    s_mov_b64 exec, s[92:93]
    ds_read_b128 v[128:131], v146 offset:6400
    s_mov_b64 exec, -1
    s_cmp_eq_u32 s3, 2
    s_cbranch_scc1 L_ool_16
L_ool_16_r:
    v_exp_f32 v60, v60
    v_cvt_pk_bf16_f32 v79, v58, v59
    v_exp_f32 v61, v61
    v_exp_f32 v62, v62
    v_cvt_pk_bf16_f32 v80, v60, v61
    v_exp_f32 v63, v63
    v_mfma_f32_32x32x16_bf16 v[100:115], v[136:139], v[76:79], v[100:115]
    s_mov_b64 exec, s[92:93]
    ds_read_b128 v[132:135], v146 offset:7040
    s_mov_b64 exec, -1
    v_exp_f32 v64, v64
    v_cvt_pk_bf16_f32 v81, v62, v63
    v_exp_f32 v65, v65
    v_exp_f32 v66, v66
    v_exp_f32 v67, v67
    v_cvt_pk_bf16_f32 v82, v64, v65
    v_cvt_pk_bf16_f32 v83, v66, v67
    v_mfma_f32_32x32x16_bf16 v[52:67], v[116:119], v[28:31], 0
    s_waitcnt lgkmcnt(1)
    ds_read_b128 v[120:123], v144 offset:7680
    v_exp_f32 v36, v36
    v_exp_f32 v37, v37
    v_exp_f32 v38, v38
    v_cvt_pk_bf16_f32 v68, v36, v37
    v_exp_f32 v39, v39
    v_mfma_f32_32x32x8bf16_1k v[52:67], v[124:125], v[34:35], v[52:67]
    s_setprio 0
    v_exp_f32 v40, v40
    v_cvt_pk_bf16_f32 v69, v38, v39
    v_exp_f32 v41, v41
    v_exp_f32 v42, v42
    v_cvt_pk_bf16_f32 v70, v40, v41
    v_exp_f32 v43, v43
    v_mfma_f32_32x32x16_bf16 v[100:115], v[140:143], v[80:83], v[100:115]
    s_mov_b64 exec, s[90:91]
    ds_read_b64 v[126:127], v156 offset:8704
    s_mov_b64 exec, -1
    s_cmp_eq_u32 s3, 3
    s_cbranch_scc1 L_ool_17
L_ool_17_r:
    v_exp_f32 v44, v44
    v_cvt_pk_bf16_f32 v71, v42, v43
    v_exp_f32 v45, v45
    v_exp_f32 v46, v46
    v_cvt_pk_bf16_f32 v72, v44, v45
    v_exp_f32 v47, v47
    v_mfma_f32_32x32x16_bf16 v[84:99], v[128:131], v[68:71], v[84:99]
    s_waitcnt lgkmcnt(1)
    v_exp_f32 v48, v48
    v_cvt_pk_bf16_f32 v73, v46, v47
    v_exp_f32 v49, v49
    v_exp_f32 v50, v50
    v_exp_f32 v51, v51
    v_cvt_pk_bf16_f32 v74, v48, v49
    v_cvt_pk_bf16_f32 v75, v50, v51
    v_mfma_f32_32x32x16_bf16 v[36:51], v[120:123], v[24:27], 0
    s_waitcnt lgkmcnt(0)
    v_exp_f32 v52, v52
    v_exp_f32 v53, v53
    v_exp_f32 v54, v54
    v_cvt_pk_bf16_f32 v76, v52, v53
    v_exp_f32 v55, v55
    v_mfma_f32_32x32x8bf16_1k v[36:51], v[126:127], v[32:33], v[36:51]
    v_exp_f32 v56, v56
    v_cvt_pk_bf16_f32 v77, v54, v55
    v_exp_f32 v57, v57
    v_exp_f32 v58, v58
    v_cvt_pk_bf16_f32 v78, v56, v57
    v_exp_f32 v59, v59
    v_mfma_f32_32x32x16_bf16 v[84:99], v[132:135], v[72:75], v[84:99]
    s_mov_b64 exec, s[92:93]
    ds_read_b128 v[136:139], v146 offset:8960
    s_mov_b64 exec, -1
    s_cmp_eq_u32 s3, 4
    s_cbranch_scc1 L_ool_18
L_ool_18_r:
    v_exp_f32 v60, v60
    v_cvt_pk_bf16_f32 v79, v58, v59
    v_exp_f32 v61, v61
    v_exp_f32 v62, v62
    v_cvt_pk_bf16_f32 v80, v60, v61
    v_exp_f32 v63, v63
    v_mfma_f32_32x32x16_bf16 v[100:115], v[128:131], v[76:79], v[100:115]
    s_mov_b64 exec, s[92:93]
    ds_read_b128 v[140:143], v146 offset:9600
    s_mov_b64 exec, -1
    v_exp_f32 v64, v64
    v_cvt_pk_bf16_f32 v81, v62, v63
    v_exp_f32 v65, v65
    v_exp_f32 v66, v66
    v_exp_f32 v67, v67
    v_cvt_pk_bf16_f32 v82, v64, v65
    v_cvt_pk_bf16_f32 v83, v66, v67
    v_mfma_f32_32x32x16_bf16 v[52:67], v[120:123], v[28:31], 0
    s_cmp_lt_u32 s3, 5
    s_cbranch_scc1 L_b1_19
    s_waitcnt vmcnt(3)
L_b1_19:
    s_waitcnt vmcnt(8) lgkmcnt(0)
    s_barrier
    ds_read_b128 v[116:119], v144 offset:20480
    v_exp_f32 v36, v36
    v_exp_f32 v37, v37
    v_exp_f32 v38, v38
    v_cvt_pk_bf16_f32 v68, v36, v37
    v_exp_f32 v39, v39
    v_mfma_f32_32x32x8bf16_1k v[52:67], v[126:127], v[34:35], v[52:67]
    s_setprio 3
    v_exp_f32 v40, v40
    v_cvt_pk_bf16_f32 v69, v38, v39
    v_exp_f32 v41, v41
    v_exp_f32 v42, v42
    v_cvt_pk_bf16_f32 v70, v40, v41
    v_exp_f32 v43, v43
    v_mfma_f32_32x32x16_bf16 v[100:115], v[132:135], v[80:83], v[100:115]
    s_mov_b64 exec, s[90:91]
    ds_read_b64 v[124:125], v156 offset:21504
    s_mov_b64 exec, -1
    s_cmp_eq_u32 s3, 5
    s_cbranch_scc1 L_ool_21
L_ool_21_r:
    v_exp_f32 v44, v44
    v_cvt_pk_bf16_f32 v71, v42, v43
    v_exp_f32 v45, v45
    v_exp_f32 v46, v46
    v_cvt_pk_bf16_f32 v72, v44, v45
    v_exp_f32 v47, v47
    v_mfma_f32_32x32x16_bf16 v[84:99], v[136:139], v[68:71], v[84:99]
    s_waitcnt lgkmcnt(1)
    v_exp_f32 v48, v48
    v_cvt_pk_bf16_f32 v73, v46, v47
    v_exp_f32 v49, v49
    v_exp_f32 v50, v50
    v_exp_f32 v51, v51
    v_cvt_pk_bf16_f32 v74, v48, v49
    v_cvt_pk_bf16_f32 v75, v50, v51
    v_mfma_f32_32x32x16_bf16 v[36:51], v[116:119], v[24:27], 0
    s_waitcnt lgkmcnt(0)
    v_exp_f32 v52, v52
    v_exp_f32 v53, v53
    v_exp_f32 v54, v54
    v_cvt_pk_bf16_f32 v76, v52, v53
    v_exp_f32 v55, v55
    v_mfma_f32_32x32x8bf16_1k v[36:51], v[124:125], v[32:33], v[36:51]
    v_exp_f32 v56, v56
    v_cvt_pk_bf16_f32 v77, v54, v55
    v_exp_f32 v57, v57
    v_exp_f32 v58, v58
    v_cvt_pk_bf16_f32 v78, v56, v57
    v_exp_f32 v59, v59
    v_mfma_f32_32x32x16_bf16 v[84:99], v[140:143], v[72:75], v[84:99]
    s_mov_b64 exec, s[92:93]
    ds_read_b128 v[128:131], v146 offset:21760
    s_mov_b64 exec, -1
    s_cmp_eq_u32 s3, 6
    s_cbranch_scc1 L_ool_22
L_ool_22_r:
    v_exp_f32 v60, v60
    v_cvt_pk_bf16_f32 v79, v58, v59
    v_exp_f32 v61, v61
    v_exp_f32 v62, v62
    v_cvt_pk_bf16_f32 v80, v60, v61
    v_exp_f32 v63, v63
    v_mfma_f32_32x32x16_bf16 v[100:115], v[136:139], v[76:79], v[100:115]
    s_mov_b64 exec, s[92:93]
    ds_read_b128 v[132:135], v146 offset:22400
    s_mov_b64 exec, -1
    v_exp_f32 v64, v64
    v_cvt_pk_bf16_f32 v81, v62, v63
    v_exp_f32 v65, v65
    v_exp_f32 v66, v66
    v_exp_f32 v67, v67
    v_cvt_pk_bf16_f32 v82, v64, v65
    v_cvt_pk_bf16_f32 v83, v66, v67
    v_mfma_f32_32x32x16_bf16 v[52:67], v[116:119], v[28:31], 0
    s_waitcnt lgkmcnt(1)
    ds_read_b128 v[120:123], v144 offset:23040
    s_add_u32 m0, s38, 0
    v_exp_f32 v36, v36
    v_exp_f32 v37, v37
    v_exp_f32 v38, v38
    v_cvt_pk_bf16_f32 v68, v36, v37
    v_exp_f32 v39, v39
    v_mfma_f32_32x32x8bf16_1k v[52:67], v[124:125], v[34:35], v[52:67]
    s_setprio 2
    buffer_load_dwordx4 v2, s[4:7], s37 offen offset:0 sc1 lds
    buffer_load_dwordx4 v2, s[4:7], s37 offen offset:1024 sc1 lds
    s_mov_b64 exec, s[90:91]
    buffer_load_dwordx4 v2, s[4:7], s37 offen offset:2048 sc1 lds
    s_mov_b64 exec, -1
    s_add_u32 s37, s37, 10240
    v_exp_f32 v40, v40
    v_cvt_pk_bf16_f32 v69, v38, v39
    v_exp_f32 v41, v41
    v_exp_f32 v42, v42
    v_cvt_pk_bf16_f32 v70, v40, v41
    v_exp_f32 v43, v43
    v_mfma_f32_32x32x16_bf16 v[100:115], v[140:143], v[80:83], v[100:115]
    s_mov_b64 exec, s[90:91]
    ds_read_b64 v[126:127], v156 offset:24064
    s_mov_b64 exec, -1
    s_cmp_eq_u32 s3, 7
    s_cbranch_scc1 L_ool_23
L_ool_23_r:
    v_exp_f32 v44, v44
    v_cvt_pk_bf16_f32 v71, v42, v43
    v_exp_f32 v45, v45
    v_exp_f32 v46, v46
    v_cvt_pk_bf16_f32 v72, v44, v45
    v_exp_f32 v47, v47
    v_mfma_f32_32x32x16_bf16 v[84:99], v[128:131], v[68:71], v[84:99]
    s_waitcnt lgkmcnt(1)
    v_exp_f32 v48, v48
    v_cvt_pk_bf16_f32 v73, v46, v47
    v_exp_f32 v49, v49
    v_exp_f32 v50, v50
    v_exp_f32 v51, v51
    v_cvt_pk_bf16_f32 v74, v48, v49
    v_cvt_pk_bf16_f32 v75, v50, v51
    v_mfma_f32_32x32x16_bf16 v[36:51], v[120:123], v[24:27], 0
    s_waitcnt lgkmcnt(0)
    v_exp_f32 v52, v52
    v_exp_f32 v53, v53
    v_exp_f32 v54, v54
    v_cvt_pk_bf16_f32 v76, v52, v53
    v_exp_f32 v55, v55
    v_mfma_f32_32x32x8bf16_1k v[36:51], v[126:127], v[32:33], v[36:51]
    v_exp_f32 v56, v56
    v_cvt_pk_bf16_f32 v77, v54, v55
    v_exp_f32 v57, v57
    v_exp_f32 v58, v58
    v_cvt_pk_bf16_f32 v78, v56, v57
    v_exp_f32 v59, v59
    v_mfma_f32_32x32x16_bf16 v[84:99], v[132:135], v[72:75], v[84:99]
    s_mov_b64 exec, s[92:93]
    ds_read_b128 v[136:139], v146 offset:24320
    s_mov_b64 exec, -1
    v_exp_f32 v60, v60
    v_cvt_pk_bf16_f32 v79, v58, v59
    v_exp_f32 v61, v61
    v_exp_f32 v62, v62
    v_cvt_pk_bf16_f32 v80, v60, v61
    v_exp_f32 v63, v63
    v_mfma_f32_32x32x16_bf16 v[100:115], v[128:131], v[76:79], v[100:115]
    s_mov_b64 exec, s[92:93]
    ds_read_b128 v[140:143], v146 offset:24960
    s_mov_b64 exec, -1
    v_exp_f32 v64, v64
    v_cvt_pk_bf16_f32 v81, v62, v63
    v_exp_f32 v65, v65
    v_exp_f32 v66, v66
    v_exp_f32 v67, v67
    v_cvt_pk_bf16_f32 v82, v64, v65
    v_cvt_pk_bf16_f32 v83, v66, v67
    v_mfma_f32_32x32x16_bf16 v[52:67], v[120:123], v[28:31], 0
    s_waitcnt lgkmcnt(1)
    ds_read_b128 v[116:119], v144 offset:25600
    v_exp_f32 v36, v36
    v_exp_f32 v37, v37
    v_exp_f32 v38, v38
    v_cvt_pk_bf16_f32 v68, v36, v37
    v_exp_f32 v39, v39
    v_mfma_f32_32x32x8bf16_1k v[52:67], v[126:127], v[34:35], v[52:67]
    s_setprio 1
    v_exp_f32 v40, v40
    v_cvt_pk_bf16_f32 v69, v38, v39
    v_exp_f32 v41, v41
    v_exp_f32 v42, v42
    v_cvt_pk_bf16_f32 v70, v40, v41
    v_exp_f32 v43, v43
    v_mfma_f32_32x32x16_bf16 v[100:115], v[132:135], v[80:83], v[100:115]
    s_mov_b64 exec, s[90:91]
    ds_read_b64 v[124:125], v156 offset:26624
    s_mov_b64 exec, -1
    v_exp_f32 v44, v44
    v_cvt_pk_bf16_f32 v71, v42, v43
    v_exp_f32 v45, v45
    v_exp_f32 v46, v46
    v_cvt_pk_bf16_f32 v72, v44, v45
    v_exp_f32 v47, v47
    v_mfma_f32_32x32x16_bf16 v[84:99], v[136:139], v[68:71], v[84:99]
    s_waitcnt lgkmcnt(1)
    v_exp_f32 v48, v48
    v_cvt_pk_bf16_f32 v73, v46, v47
    v_exp_f32 v49, v49
    v_exp_f32 v50, v50
    v_exp_f32 v51, v51
    v_cvt_pk_bf16_f32 v74, v48, v49
    v_cvt_pk_bf16_f32 v75, v50, v51
    v_mfma_f32_32x32x16_bf16 v[36:51], v[116:119], v[24:27], 0
    s_waitcnt lgkmcnt(0)
    v_exp_f32 v52, v52
    v_exp_f32 v53, v53
    v_exp_f32 v54, v54
    v_cvt_pk_bf16_f32 v76, v52, v53
    v_exp_f32 v55, v55
    v_mfma_f32_32x32x8bf16_1k v[36:51], v[124:125], v[32:33], v[36:51]
    v_exp_f32 v56, v56
    v_cvt_pk_bf16_f32 v77, v54, v55
    v_exp_f32 v57, v57
    v_exp_f32 v58, v58
    v_cvt_pk_bf16_f32 v78, v56, v57
    v_exp_f32 v59, v59
    v_mfma_f32_32x32x16_bf16 v[84:99], v[140:143], v[72:75], v[84:99]
    s_mov_b64 exec, s[92:93]
    ds_read_b128 v[128:131], v146 offset:26880
    s_mov_b64 exec, -1
    v_exp_f32 v60, v60
    v_cvt_pk_bf16_f32 v79, v58, v59
    v_exp_f32 v61, v61
    v_exp_f32 v62, v62
    v_cvt_pk_bf16_f32 v80, v60, v61
    v_exp_f32 v63, v63
    v_mfma_f32_32x32x16_bf16 v[100:115], v[136:139], v[76:79], v[100:115]
    s_mov_b64 exec, s[92:93]
    ds_read_b128 v[132:135], v146 offset:27520
    s_mov_b64 exec, -1
    v_exp_f32 v64, v64
    v_cvt_pk_bf16_f32 v81, v62, v63
    v_exp_f32 v65, v65
    v_exp_f32 v66, v66
    v_exp_f32 v67, v67
    v_cvt_pk_bf16_f32 v82, v64, v65
    v_cvt_pk_bf16_f32 v83, v66, v67
    v_mfma_f32_32x32x16_bf16 v[52:67], v[116:119], v[28:31], 0
    s_waitcnt lgkmcnt(1)
    ds_read_b128 v[120:123], v144 offset:28160
    v_exp_f32 v36, v36
    v_exp_f32 v37, v37
    v_exp_f32 v38, v38
    v_cvt_pk_bf16_f32 v68, v36, v37
    v_exp_f32 v39, v39
    v_mfma_f32_32x32x8bf16_1k v[52:67], v[124:125], v[34:35], v[52:67]
    s_setprio 0
    v_exp_f32 v40, v40
    v_cvt_pk_bf16_f32 v69, v38, v39
    v_exp_f32 v41, v41
    v_exp_f32 v42, v42
    v_cvt_pk_bf16_f32 v70, v40, v41
    v_exp_f32 v43, v43
    v_mfma_f32_32x32x16_bf16 v[100:115], v[140:143], v[80:83], v[100:115]
    s_mov_b64 exec, s[90:91]
    ds_read_b64 v[126:127], v156 offset:29184
    s_mov_b64 exec, -1
    v_exp_f32 v44, v44
    v_cvt_pk_bf16_f32 v71, v42, v43
    v_exp_f32 v45, v45
    v_exp_f32 v46, v46
    v_cvt_pk_bf16_f32 v72, v44, v45
    v_exp_f32 v47, v47
    v_mfma_f32_32x32x16_bf16 v[84:99], v[128:131], v[68:71], v[84:99]
    s_waitcnt lgkmcnt(1)
    v_exp_f32 v48, v48
    v_cvt_pk_bf16_f32 v73, v46, v47
    v_exp_f32 v49, v49
    v_exp_f32 v50, v50
    v_exp_f32 v51, v51
    v_cvt_pk_bf16_f32 v74, v48, v49
    v_cvt_pk_bf16_f32 v75, v50, v51
    v_mfma_f32_32x32x16_bf16 v[36:51], v[120:123], v[24:27], 0
    s_waitcnt lgkmcnt(0)
    v_exp_f32 v52, v52
    v_exp_f32 v53, v53
    v_exp_f32 v54, v54
    v_cvt_pk_bf16_f32 v76, v52, v53
    v_exp_f32 v55, v55
    v_mfma_f32_32x32x8bf16_1k v[36:51], v[126:127], v[32:33], v[36:51]
    v_exp_f32 v56, v56
    v_cvt_pk_bf16_f32 v77, v54, v55
    v_exp_f32 v57, v57
    v_exp_f32 v58, v58
    v_cvt_pk_bf16_f32 v78, v56, v57
    v_exp_f32 v59, v59
    v_mfma_f32_32x32x16_bf16 v[84:99], v[132:135], v[72:75], v[84:99]
    s_mov_b64 exec, s[92:93]
    ds_read_b128 v[136:139], v146 offset:29440
    s_mov_b64 exec, -1
    v_exp_f32 v60, v60
    v_cvt_pk_bf16_f32 v79, v58, v59
    v_exp_f32 v61, v61
    v_exp_f32 v62, v62
    v_cvt_pk_bf16_f32 v80, v60, v61
    v_exp_f32 v63, v63
    v_mfma_f32_32x32x16_bf16 v[100:115], v[128:131], v[76:79], v[100:115]
    s_mov_b64 exec, s[92:93]
    ds_read_b128 v[140:143], v146 offset:30080
    s_mov_b64 exec, -1
    v_exp_f32 v64, v64
    v_cvt_pk_bf16_f32 v81, v62, v63
    v_exp_f32 v65, v65
    v_exp_f32 v66, v66
    v_exp_f32 v67, v67
    v_cvt_pk_bf16_f32 v82, v64, v65
    v_cvt_pk_bf16_f32 v83, v66, v67
    v_mfma_f32_32x32x16_bf16 v[52:67], v[120:123], v[28:31], 0
    s_waitcnt vmcnt(0) lgkmcnt(0)
    s_barrier
    ds_read_b128 v[116:119], v144 offset:40960
    v_exp_f32 v36, v36
    v_exp_f32 v37, v37
    v_exp_f32 v38, v38
    v_cvt_pk_bf16_f32 v68, v36, v37
    v_exp_f32 v39, v39
    v_mfma_f32_32x32x8bf16_1k v[52:67], v[126:127], v[34:35], v[52:67]
    s_setprio 3
    v_exp_f32 v40, v40
    v_cvt_pk_bf16_f32 v69, v38, v39
    v_exp_f32 v41, v41
    v_exp_f32 v42, v42
    v_cvt_pk_bf16_f32 v70, v40, v41
    v_exp_f32 v43, v43
    v_mfma_f32_32x32x16_bf16 v[100:115], v[132:135], v[80:83], v[100:115]
    s_mov_b64 exec, s[90:91]
    ds_read_b64 v[124:125], v156 offset:41984
    s_mov_b64 exec, -1
    v_exp_f32 v44, v44
    v_cvt_pk_bf16_f32 v71, v42, v43
    v_exp_f32 v45, v45
    v_exp_f32 v46, v46
    v_cvt_pk_bf16_f32 v72, v44, v45
    v_exp_f32 v47, v47
    v_mfma_f32_32x32x16_bf16 v[84:99], v[136:139], v[68:71], v[84:99]
    s_waitcnt lgkmcnt(1)
    v_exp_f32 v48, v48
    v_cvt_pk_bf16_f32 v73, v46, v47
    v_exp_f32 v49, v49
    v_exp_f32 v50, v50
    v_exp_f32 v51, v51
    v_cvt_pk_bf16_f32 v74, v48, v49
    v_cvt_pk_bf16_f32 v75, v50, v51
    v_mfma_f32_32x32x16_bf16 v[36:51], v[116:119], v[24:27], 0
    s_waitcnt lgkmcnt(0)
    v_exp_f32 v52, v52
    v_exp_f32 v53, v53
    v_exp_f32 v54, v54
    v_cvt_pk_bf16_f32 v76, v52, v53
    v_exp_f32 v55, v55
    v_mfma_f32_32x32x8bf16_1k v[36:51], v[124:125], v[32:33], v[36:51]
    ds_read_b64_tr_b16 v[200:201], v225
    ds_read_b64_tr_b16 v[202:203], v226
    v_exp_f32 v56, v56
    v_cvt_pk_bf16_f32 v77, v54, v55
    v_exp_f32 v57, v57
    v_exp_f32 v58, v58
    v_cvt_pk_bf16_f32 v78, v56, v57
    v_exp_f32 v59, v59
    v_mfma_f32_32x32x16_bf16 v[84:99], v[140:143], v[72:75], v[84:99]
    s_mov_b64 exec, s[92:93]
    ds_read_b128 v[128:131], v146 offset:42240
    s_mov_b64 exec, -1
    v_exp_f32 v60, v60
    v_cvt_pk_bf16_f32 v79, v58, v59
    v_exp_f32 v61, v61
    v_exp_f32 v62, v62
    v_cvt_pk_bf16_f32 v80, v60, v61
    v_exp_f32 v63, v63
    v_mfma_f32_32x32x16_bf16 v[100:115], v[136:139], v[76:79], v[100:115]
    s_mov_b64 exec, s[92:93]
    ds_read_b128 v[132:135], v146 offset:42880
    s_mov_b64 exec, -1
    v_exp_f32 v64, v64
    v_cvt_pk_bf16_f32 v81, v62, v63
    v_exp_f32 v65, v65
    v_exp_f32 v66, v66
    v_exp_f32 v67, v67
    v_cvt_pk_bf16_f32 v82, v64, v65
    v_cvt_pk_bf16_f32 v83, v66, v67
    v_mfma_f32_32x32x16_bf16 v[52:67], v[116:119], v[28:31], 0
    s_waitcnt lgkmcnt(1)
    ds_read_b128 v[120:123], v144 offset:43520
    s_add_u32 m0, s38, 20480
    v_exp_f32 v36, v36
    v_exp_f32 v37, v37
    v_exp_f32 v38, v38
    v_cvt_pk_bf16_f32 v68, v36, v37
    v_exp_f32 v39, v39
    v_mfma_f32_32x32x8bf16_1k v[52:67], v[124:125], v[34:35], v[52:67]
    s_setprio 2
    buffer_load_dwordx4 v2, s[4:7], s37 offen offset:0 sc1 lds
    buffer_load_dwordx4 v2, s[4:7], s37 offen offset:1024 sc1 lds
    s_mov_b64 exec, s[90:91]
    buffer_load_dwordx4 v2, s[4:7], s37 offen offset:2048 sc1 lds
    s_mov_b64 exec, -1
    s_add_u32 s37, s37, 10240
    buffer_store_dwordx4 v[200:203], v2, s[4:7], s64 offen sc1
    ds_read_b64_tr_b16 v[204:205], v227
    ds_read_b64_tr_b16 v[206:207], v228
    v_mfma_f32_32x32x16_bf16 v[168:183], v[240:243], v[200:203], 0
    v_exp_f32 v40, v40
    v_cvt_pk_bf16_f32 v69, v38, v39
    v_exp_f32 v41, v41
    v_exp_f32 v42, v42
    v_cvt_pk_bf16_f32 v70, v40, v41
    v_exp_f32 v43, v43
    v_mfma_f32_32x32x16_bf16 v[100:115], v[140:143], v[80:83], v[100:115]
    s_mov_b64 exec, s[90:91]
    ds_read_b64 v[126:127], v156 offset:44544
    s_mov_b64 exec, -1
    v_exp_f32 v44, v44
    v_cvt_pk_bf16_f32 v71, v42, v43
    v_exp_f32 v45, v45
    v_exp_f32 v46, v46
    v_cvt_pk_bf16_f32 v72, v44, v45
    v_exp_f32 v47, v47
    v_mfma_f32_32x32x16_bf16 v[84:99], v[128:131], v[68:71], v[84:99]
    s_waitcnt lgkmcnt(1)
    v_exp_f32 v48, v48
    v_cvt_pk_bf16_f32 v73, v46, v47
    v_exp_f32 v49, v49
    v_exp_f32 v50, v50
    v_exp_f32 v51, v51
    v_cvt_pk_bf16_f32 v74, v48, v49
    v_cvt_pk_bf16_f32 v75, v50, v51
    v_mfma_f32_32x32x16_bf16 v[36:51], v[120:123], v[24:27], 0
    s_waitcnt lgkmcnt(0)
    v_exp_f32 v52, v52
    v_exp_f32 v53, v53
    v_exp_f32 v54, v54
    v_cvt_pk_bf16_f32 v76, v52, v53
    v_exp_f32 v55, v55
    v_mfma_f32_32x32x8bf16_1k v[36:51], v[126:127], v[32:33], v[36:51]
    buffer_store_dwordx4 v[204:207], v2, s[4:7], s65 offen sc1
    ds_read_b64_tr_b16 v[208:209], v229
    ds_read_b64_tr_b16 v[210:211], v230
    v_mfma_f32_32x32x16_bf16 v[168:183], v[244:247], v[204:207], v[168:183]
    v_exp_f32 v56, v56
    v_cvt_pk_bf16_f32 v77, v54, v55
    v_exp_f32 v57, v57
    v_exp_f32 v58, v58
    v_cvt_pk_bf16_f32 v78, v56, v57
    v_exp_f32 v59, v59
    v_mfma_f32_32x32x16_bf16 v[84:99], v[132:135], v[72:75], v[84:99]
    s_mov_b64 exec, s[92:93]
    ds_read_b128 v[136:139], v146 offset:44800
    s_mov_b64 exec, -1
    v_exp_f32 v60, v60
    v_cvt_pk_bf16_f32 v79, v58, v59
    v_exp_f32 v61, v61
    v_exp_f32 v62, v62
    v_cvt_pk_bf16_f32 v80, v60, v61
    v_exp_f32 v63, v63
    v_mfma_f32_32x32x16_bf16 v[100:115], v[128:131], v[76:79], v[100:115]
    s_mov_b64 exec, s[92:93]
    ds_read_b128 v[140:143], v146 offset:45440
    s_mov_b64 exec, -1
    v_exp_f32 v64, v64
    v_cvt_pk_bf16_f32 v81, v62, v63
    v_exp_f32 v65, v65
    v_exp_f32 v66, v66
    v_exp_f32 v67, v67
    v_cvt_pk_bf16_f32 v82, v64, v65
    v_cvt_pk_bf16_f32 v83, v66, v67
    v_mfma_f32_32x32x16_bf16 v[52:67], v[120:123], v[28:31], 0
    s_waitcnt lgkmcnt(1)
    ds_read_b128 v[116:119], v144 offset:46080
    v_exp_f32 v36, v36
    v_exp_f32 v37, v37
    v_exp_f32 v38, v38
    v_cvt_pk_bf16_f32 v68, v36, v37
    v_exp_f32 v39, v39
    v_mfma_f32_32x32x8bf16_1k v[52:67], v[126:127], v[34:35], v[52:67]
    s_setprio 1
    buffer_store_dwordx4 v[208:211], v2, s[4:7], s66 offen sc1
    ds_read_b64_tr_b16 v[212:213], v231
    ds_read_b64_tr_b16 v[214:215], v232
    v_mfma_f32_32x32x16_bf16 v[168:183], v[248:251], v[208:211], v[168:183]
    v_exp_f32 v40, v40
    v_cvt_pk_bf16_f32 v69, v38, v39
    v_exp_f32 v41, v41
    v_exp_f32 v42, v42
    v_cvt_pk_bf16_f32 v70, v40, v41
    v_exp_f32 v43, v43
    v_mfma_f32_32x32x16_bf16 v[100:115], v[132:135], v[80:83], v[100:115]
    s_mov_b64 exec, s[90:91]
    ds_read_b64 v[124:125], v156 offset:47104
    s_mov_b64 exec, -1
    v_exp_f32 v44, v44
    v_cvt_pk_bf16_f32 v71, v42, v43
    v_exp_f32 v45, v45
    v_exp_f32 v46, v46
    v_cvt_pk_bf16_f32 v72, v44, v45
    v_exp_f32 v47, v47
    v_mfma_f32_32x32x16_bf16 v[84:99], v[136:139], v[68:71], v[84:99]
    s_waitcnt lgkmcnt(1)
    v_exp_f32 v48, v48
    v_cvt_pk_bf16_f32 v73, v46, v47
    v_exp_f32 v49, v49
    v_exp_f32 v50, v50
    v_exp_f32 v51, v51
    v_cvt_pk_bf16_f32 v74, v48, v49
    v_cvt_pk_bf16_f32 v75, v50, v51
    v_mfma_f32_32x32x16_bf16 v[36:51], v[116:119], v[24:27], 0
    s_waitcnt lgkmcnt(0)
    v_exp_f32 v52, v52
    v_exp_f32 v53, v53
    v_exp_f32 v54, v54
    v_cvt_pk_bf16_f32 v76, v52, v53
    v_exp_f32 v55, v55
    v_mfma_f32_32x32x8bf16_1k v[36:51], v[124:125], v[32:33], v[36:51]
    buffer_store_dwordx4 v[212:215], v2, s[4:7], s67 offen sc1
    ds_read_b64_tr_b16 v[216:217], v233
    ds_read_b64_tr_b16 v[218:219], v234
    v_mfma_f32_32x32x16_bf16 v[168:183], v[252:255], v[212:215], v[168:183]
    v_exp_f32 v56, v56
    v_cvt_pk_bf16_f32 v77, v54, v55
    v_exp_f32 v57, v57
    v_exp_f32 v58, v58
    v_cvt_pk_bf16_f32 v78, v56, v57
    v_exp_f32 v59, v59
    v_mfma_f32_32x32x16_bf16 v[84:99], v[140:143], v[72:75], v[84:99]
    s_mov_b64 exec, s[92:93]
    ds_read_b128 v[128:131], v146 offset:47360
    s_mov_b64 exec, -1
    v_exp_f32 v60, v60
    v_cvt_pk_bf16_f32 v79, v58, v59
    v_exp_f32 v61, v61
    v_exp_f32 v62, v62
    v_cvt_pk_bf16_f32 v80, v60, v61
    v_exp_f32 v63, v63
    v_mfma_f32_32x32x16_bf16 v[100:115], v[136:139], v[76:79], v[100:115]
    s_mov_b64 exec, s[92:93]
    ds_read_b128 v[132:135], v146 offset:48000
    s_mov_b64 exec, -1
    v_exp_f32 v64, v64
    v_cvt_pk_bf16_f32 v81, v62, v63
    v_exp_f32 v65, v65
    v_exp_f32 v66, v66
    v_exp_f32 v67, v67
    v_cvt_pk_bf16_f32 v82, v64, v65
    v_cvt_pk_bf16_f32 v83, v66, v67
    v_mfma_f32_32x32x16_bf16 v[52:67], v[116:119], v[28:31], 0
    s_waitcnt lgkmcnt(1)
    ds_read_b128 v[120:123], v144 offset:48640
    v_exp_f32 v36, v36
    v_exp_f32 v37, v37
    v_exp_f32 v38, v38
    v_cvt_pk_bf16_f32 v68, v36, v37
    v_exp_f32 v39, v39
    v_mfma_f32_32x32x8bf16_1k v[52:67], v[124:125], v[34:35], v[52:67]
    s_setprio 0
    buffer_store_dwordx4 v[216:219], v2, s[4:7], s68 offen sc1
    v_exp_f32 v40, v40
    v_cvt_pk_bf16_f32 v69, v38, v39
    v_exp_f32 v41, v41
    v_exp_f32 v42, v42
    v_cvt_pk_bf16_f32 v70, v40, v41
    v_exp_f32 v43, v43
    v_mfma_f32_32x32x16_bf16 v[100:115], v[140:143], v[80:83], v[100:115]
    s_mov_b64 exec, s[90:91]
    ds_read_b64 v[126:127], v156 offset:49664
    s_mov_b64 exec, -1
    v_exp_f32 v44, v44
    v_cvt_pk_bf16_f32 v71, v42, v43
    v_exp_f32 v45, v45
    v_exp_f32 v46, v46
    v_cvt_pk_bf16_f32 v72, v44, v45
    v_exp_f32 v47, v47
    v_mfma_f32_32x32x16_bf16 v[84:99], v[128:131], v[68:71], v[84:99]
    s_waitcnt lgkmcnt(1)
    v_exp_f32 v48, v48
    v_cvt_pk_bf16_f32 v73, v46, v47
    v_exp_f32 v49, v49
    v_exp_f32 v50, v50
    v_exp_f32 v51, v51
    v_cvt_pk_bf16_f32 v74, v48, v49
    v_cvt_pk_bf16_f32 v75, v50, v51
    v_mfma_f32_32x32x16_bf16 v[36:51], v[120:123], v[24:27], 0
    s_waitcnt lgkmcnt(0)
    v_exp_f32 v52, v52
    v_exp_f32 v53, v53
    v_exp_f32 v54, v54
    v_cvt_pk_bf16_f32 v76, v52, v53
    v_exp_f32 v55, v55
    v_mfma_f32_32x32x8bf16_1k v[36:51], v[126:127], v[32:33], v[36:51]
    ds_write_b32 v239, v168 offset:0
    ds_write_b32 v239, v172 offset:128
    ds_write_b32 v239, v176 offset:256
    ds_write_b32 v239, v180 offset:384
    v_exp_f32 v56, v56
    v_cvt_pk_bf16_f32 v77, v54, v55
    v_exp_f32 v57, v57
    v_exp_f32 v58, v58
    v_cvt_pk_bf16_f32 v78, v56, v57
    v_exp_f32 v59, v59
    v_mfma_f32_32x32x16_bf16 v[84:99], v[132:135], v[72:75], v[84:99]
    s_mov_b64 exec, s[92:93]
    ds_read_b128 v[136:139], v146 offset:49920
    s_mov_b64 exec, -1
    v_exp_f32 v60, v60
    v_cvt_pk_bf16_f32 v79, v58, v59
    v_exp_f32 v61, v61
    v_exp_f32 v62, v62
    v_cvt_pk_bf16_f32 v80, v60, v61
    v_exp_f32 v63, v63
    v_mfma_f32_32x32x16_bf16 v[100:115], v[128:131], v[76:79], v[100:115]
    s_mov_b64 exec, s[92:93]
    ds_read_b128 v[140:143], v146 offset:50560
    s_mov_b64 exec, -1
    v_exp_f32 v64, v64
    v_cvt_pk_bf16_f32 v81, v62, v63
    v_exp_f32 v65, v65
    v_exp_f32 v66, v66
    v_exp_f32 v67, v67
    v_cvt_pk_bf16_f32 v82, v64, v65
    v_cvt_pk_bf16_f32 v83, v66, v67
    v_mfma_f32_32x32x16_bf16 v[52:67], v[120:123], v[28:31], 0
    s_waitcnt vmcnt(8) lgkmcnt(0)
    s_barrier
    ds_read_b128 v[116:119], v144 offset:0
    v_exp_f32 v36, v36
    v_exp_f32 v37, v37
    v_exp_f32 v38, v38
    v_cvt_pk_bf16_f32 v68, v36, v37
    v_exp_f32 v39, v39
    v_mfma_f32_32x32x8bf16_1k v[52:67], v[126:127], v[34:35], v[52:67]
    s_setprio 3
    v_exp_f32 v40, v40
    v_cvt_pk_bf16_f32 v69, v38, v39
    v_exp_f32 v41, v41
    v_exp_f32 v42, v42
    v_cvt_pk_bf16_f32 v70, v40, v41
    v_exp_f32 v43, v43
    v_mfma_f32_32x32x16_bf16 v[100:115], v[132:135], v[80:83], v[100:115]
    s_mov_b64 exec, s[90:91]
    ds_read_b64 v[124:125], v156 offset:1024
    s_mov_b64 exec, -1
    v_exp_f32 v44, v44
    v_cvt_pk_bf16_f32 v71, v42, v43
    v_exp_f32 v45, v45
    v_exp_f32 v46, v46
    v_cvt_pk_bf16_f32 v72, v44, v45
    v_exp_f32 v47, v47
    v_mfma_f32_32x32x16_bf16 v[84:99], v[136:139], v[68:71], v[84:99]
    s_waitcnt lgkmcnt(1)
    v_exp_f32 v48, v48
    v_cvt_pk_bf16_f32 v73, v46, v47
    v_exp_f32 v49, v49
    v_exp_f32 v50, v50
    v_exp_f32 v51, v51
    v_cvt_pk_bf16_f32 v74, v48, v49
    v_cvt_pk_bf16_f32 v75, v50, v51
    v_mfma_f32_32x32x16_bf16 v[36:51], v[116:119], v[24:27], 0
    s_waitcnt lgkmcnt(0)
    v_exp_f32 v52, v52
    v_exp_f32 v53, v53
    v_exp_f32 v54, v54
    v_cvt_pk_bf16_f32 v76, v52, v53
    v_exp_f32 v55, v55
    v_mfma_f32_32x32x8bf16_1k v[36:51], v[124:125], v[32:33], v[36:51]
    s_cmp_lt_u32 s56, 2
    s_cbranch_scc1 L_ool_24
L_ool_24_r:
    v_exp_f32 v56, v56
    v_cvt_pk_bf16_f32 v77, v54, v55
    v_exp_f32 v57, v57
    v_exp_f32 v58, v58
    v_cvt_pk_bf16_f32 v78, v56, v57
    v_exp_f32 v59, v59
    v_mfma_f32_32x32x16_bf16 v[84:99], v[140:143], v[72:75], v[84:99]
    s_mov_b64 exec, s[92:93]
    ds_read_b128 v[128:131], v146 offset:1280
    s_mov_b64 exec, -1
    v_exp_f32 v60, v60
    v_cvt_pk_bf16_f32 v79, v58, v59
    v_exp_f32 v61, v61
    v_exp_f32 v62, v62
    v_cvt_pk_bf16_f32 v80, v60, v61
    v_exp_f32 v63, v63
    v_mfma_f32_32x32x16_bf16 v[100:115], v[136:139], v[76:79], v[100:115]
    s_mov_b64 exec, s[92:93]
    ds_read_b128 v[132:135], v146 offset:1920
    s_mov_b64 exec, -1
    v_exp_f32 v64, v64
    v_cvt_pk_bf16_f32 v81, v62, v63
    v_exp_f32 v65, v65
    v_exp_f32 v66, v66
    v_exp_f32 v67, v67
    v_cvt_pk_bf16_f32 v82, v64, v65
    v_cvt_pk_bf16_f32 v83, v66, v67
    v_mfma_f32_32x32x16_bf16 v[52:67], v[116:119], v[28:31], 0
    s_waitcnt lgkmcnt(1)
    ds_read_b128 v[120:123], v144 offset:2560
    s_add_u32 m0, s38, 40960
    v_exp_f32 v36, v36
    v_exp_f32 v37, v37
    v_exp_f32 v38, v38
    v_cvt_pk_bf16_f32 v68, v36, v37
    v_exp_f32 v39, v39
    v_mfma_f32_32x32x8bf16_1k v[52:67], v[124:125], v[34:35], v[52:67]
    s_setprio 2
    buffer_load_dwordx4 v2, s[4:7], s37 offen offset:0 sc1 lds
    buffer_load_dwordx4 v2, s[4:7], s37 offen offset:1024 sc1 lds
    s_mov_b64 exec, s[90:91]
    buffer_load_dwordx4 v2, s[4:7], s37 offen offset:2048 sc1 lds
    s_mov_b64 exec, -1
    s_add_u32 s37, s37, 10240
    v_exp_f32 v40, v40
    v_cvt_pk_bf16_f32 v69, v38, v39
    v_exp_f32 v41, v41
    v_exp_f32 v42, v42
    v_cvt_pk_bf16_f32 v70, v40, v41
    v_exp_f32 v43, v43
    v_mfma_f32_32x32x16_bf16 v[100:115], v[140:143], v[80:83], v[100:115]
    s_mov_b64 exec, s[90:91]
    ds_read_b64 v[126:127], v156 offset:3584
    s_mov_b64 exec, -1
    v_exp_f32 v44, v44
    v_cvt_pk_bf16_f32 v71, v42, v43
    v_exp_f32 v45, v45
    v_exp_f32 v46, v46
    v_cvt_pk_bf16_f32 v72, v44, v45
    v_exp_f32 v47, v47
    v_mfma_f32_32x32x16_bf16 v[84:99], v[128:131], v[68:71], v[84:99]
    s_waitcnt lgkmcnt(1)
    v_exp_f32 v48, v48
    v_cvt_pk_bf16_f32 v73, v46, v47
    v_exp_f32 v49, v49
    v_exp_f32 v50, v50
    v_exp_f32 v51, v51
    v_cvt_pk_bf16_f32 v74, v48, v49
    v_cvt_pk_bf16_f32 v75, v50, v51
    v_mfma_f32_32x32x16_bf16 v[36:51], v[120:123], v[24:27], 0
    s_waitcnt lgkmcnt(0)
    v_exp_f32 v52, v52
    v_exp_f32 v53, v53
    v_exp_f32 v54, v54
    v_cvt_pk_bf16_f32 v76, v52, v53
    v_exp_f32 v55, v55
    v_mfma_f32_32x32x8bf16_1k v[36:51], v[126:127], v[32:33], v[36:51]
    s_cmp_lt_u32 s56, 2
    s_cbranch_scc1 L_ool_25
L_ool_25_r:
    v_exp_f32 v56, v56
    v_cvt_pk_bf16_f32 v77, v54, v55
    v_exp_f32 v57, v57
    v_exp_f32 v58, v58
    v_cvt_pk_bf16_f32 v78, v56, v57
    v_exp_f32 v59, v59
    v_mfma_f32_32x32x16_bf16 v[84:99], v[132:135], v[72:75], v[84:99]
    s_mov_b64 exec, s[92:93]
    ds_read_b128 v[136:139], v146 offset:3840
    s_mov_b64 exec, -1
    v_exp_f32 v60, v60
    v_cvt_pk_bf16_f32 v79, v58, v59
    v_exp_f32 v61, v61
    v_exp_f32 v62, v62
    v_cvt_pk_bf16_f32 v80, v60, v61
    v_exp_f32 v63, v63
    v_mfma_f32_32x32x16_bf16 v[100:115], v[128:131], v[76:79], v[100:115]
    s_mov_b64 exec, s[92:93]
    ds_read_b128 v[140:143], v146 offset:4480
    s_mov_b64 exec, -1
    v_exp_f32 v64, v64
    v_cvt_pk_bf16_f32 v81, v62, v63
    v_exp_f32 v65, v65
    v_exp_f32 v66, v66
    v_exp_f32 v67, v67
    v_cvt_pk_bf16_f32 v82, v64, v65
    v_cvt_pk_bf16_f32 v83, v66, v67
    v_mfma_f32_32x32x16_bf16 v[52:67], v[120:123], v[28:31], 0
    s_waitcnt lgkmcnt(1)
    ds_read_b128 v[116:119], v144 offset:5120
    v_exp_f32 v36, v36
    v_exp_f32 v37, v37
    v_exp_f32 v38, v38
    v_cvt_pk_bf16_f32 v68, v36, v37
    v_exp_f32 v39, v39
    v_mfma_f32_32x32x8bf16_1k v[52:67], v[126:127], v[34:35], v[52:67]
    s_setprio 1
    v_exp_f32 v40, v40
    v_cvt_pk_bf16_f32 v69, v38, v39
    v_exp_f32 v41, v41
    v_exp_f32 v42, v42
    v_cvt_pk_bf16_f32 v70, v40, v41
    v_exp_f32 v43, v43
    v_mfma_f32_32x32x16_bf16 v[100:115], v[132:135], v[80:83], v[100:115]
    s_mov_b64 exec, s[90:91]
    ds_read_b64 v[124:125], v156 offset:6144
    s_mov_b64 exec, -1
    v_exp_f32 v44, v44
    v_cvt_pk_bf16_f32 v71, v42, v43
    v_exp_f32 v45, v45
    v_exp_f32 v46, v46
    v_cvt_pk_bf16_f32 v72, v44, v45
    v_exp_f32 v47, v47
    v_mfma_f32_32x32x16_bf16 v[84:99], v[136:139], v[68:71], v[84:99]
    s_waitcnt lgkmcnt(1)
    v_exp_f32 v48, v48
    v_cvt_pk_bf16_f32 v73, v46, v47
    v_exp_f32 v49, v49
    v_exp_f32 v50, v50
    v_exp_f32 v51, v51
    v_cvt_pk_bf16_f32 v74, v48, v49
    v_cvt_pk_bf16_f32 v75, v50, v51
    v_mfma_f32_32x32x16_bf16 v[36:51], v[116:119], v[24:27], 0
    s_waitcnt lgkmcnt(0)
    v_exp_f32 v52, v52
    v_exp_f32 v53, v53
    v_exp_f32 v54, v54
    v_cvt_pk_bf16_f32 v76, v52, v53
    v_exp_f32 v55, v55
    v_mfma_f32_32x32x8bf16_1k v[36:51], v[124:125], v[32:33], v[36:51]
    v_exp_f32 v56, v56
    v_cvt_pk_bf16_f32 v77, v54, v55
    v_exp_f32 v57, v57
    v_exp_f32 v58, v58
    v_cvt_pk_bf16_f32 v78, v56, v57
    v_exp_f32 v59, v59
    v_mfma_f32_32x32x16_bf16 v[84:99], v[140:143], v[72:75], v[84:99]
    s_mov_b64 exec, s[92:93]
    ds_read_b128 v[128:131], v146 offset:6400
    s_mov_b64 exec, -1
    v_exp_f32 v60, v60
    v_cvt_pk_bf16_f32 v79, v58, v59
    v_exp_f32 v61, v61
    v_exp_f32 v62, v62
    v_cvt_pk_bf16_f32 v80, v60, v61
    v_exp_f32 v63, v63
    v_mfma_f32_32x32x16_bf16 v[100:115], v[136:139], v[76:79], v[100:115]
    s_mov_b64 exec, s[92:93]
    ds_read_b128 v[132:135], v146 offset:7040
    s_mov_b64 exec, -1
    v_exp_f32 v64, v64
    v_cvt_pk_bf16_f32 v81, v62, v63
    v_exp_f32 v65, v65
    v_exp_f32 v66, v66
    v_exp_f32 v67, v67
    v_cvt_pk_bf16_f32 v82, v64, v65
    v_cvt_pk_bf16_f32 v83, v66, v67
    v_mfma_f32_32x32x16_bf16 v[52:67], v[116:119], v[28:31], 0
    s_waitcnt lgkmcnt(1)
    ds_read_b128 v[120:123], v144 offset:7680
    v_exp_f32 v36, v36
    v_exp_f32 v37, v37
    v_exp_f32 v38, v38
    v_cvt_pk_bf16_f32 v68, v36, v37
    v_exp_f32 v39, v39
    v_mfma_f32_32x32x8bf16_1k v[52:67], v[124:125], v[34:35], v[52:67]
    s_setprio 0
    v_exp_f32 v40, v40
    v_cvt_pk_bf16_f32 v69, v38, v39
    v_exp_f32 v41, v41
    v_exp_f32 v42, v42
    v_cvt_pk_bf16_f32 v70, v40, v41
    v_exp_f32 v43, v43
    v_mfma_f32_32x32x16_bf16 v[100:115], v[140:143], v[80:83], v[100:115]
    s_mov_b64 exec, s[90:91]
    ds_read_b64 v[126:127], v156 offset:8704
    s_mov_b64 exec, -1
    v_exp_f32 v44, v44
    v_cvt_pk_bf16_f32 v71, v42, v43
    v_exp_f32 v45, v45
    v_exp_f32 v46, v46
    v_cvt_pk_bf16_f32 v72, v44, v45
    v_exp_f32 v47, v47
    v_mfma_f32_32x32x16_bf16 v[84:99], v[128:131], v[68:71], v[84:99]
    s_waitcnt lgkmcnt(1)
    v_exp_f32 v48, v48
    v_cvt_pk_bf16_f32 v73, v46, v47
    v_exp_f32 v49, v49
    v_exp_f32 v50, v50
    v_exp_f32 v51, v51
    v_cvt_pk_bf16_f32 v74, v48, v49
    v_cvt_pk_bf16_f32 v75, v50, v51
    v_mfma_f32_32x32x16_bf16 v[36:51], v[120:123], v[24:27], 0
    s_waitcnt lgkmcnt(0)
    v_exp_f32 v52, v52
    v_exp_f32 v53, v53
    v_exp_f32 v54, v54
    v_cvt_pk_bf16_f32 v76, v52, v53
    v_exp_f32 v55, v55
    v_mfma_f32_32x32x8bf16_1k v[36:51], v[126:127], v[32:33], v[36:51]
    v_exp_f32 v56, v56
    v_cvt_pk_bf16_f32 v77, v54, v55
    v_exp_f32 v57, v57
    v_exp_f32 v58, v58
    v_cvt_pk_bf16_f32 v78, v56, v57
    v_exp_f32 v59, v59
    v_mfma_f32_32x32x16_bf16 v[84:99], v[132:135], v[72:75], v[84:99]
    s_mov_b64 exec, s[92:93]
    ds_read_b128 v[136:139], v146 offset:8960
    s_mov_b64 exec, -1
    v_exp_f32 v60, v60
    v_cvt_pk_bf16_f32 v79, v58, v59
    v_exp_f32 v61, v61
    v_exp_f32 v62, v62
    v_cvt_pk_bf16_f32 v80, v60, v61
    v_exp_f32 v63, v63
    v_mfma_f32_32x32x16_bf16 v[100:115], v[128:131], v[76:79], v[100:115]
    s_mov_b64 exec, s[92:93]
    ds_read_b128 v[140:143], v146 offset:9600
    s_mov_b64 exec, -1
    v_exp_f32 v64, v64
    v_cvt_pk_bf16_f32 v81, v62, v63
    v_exp_f32 v65, v65
    v_exp_f32 v66, v66
    v_exp_f32 v67, v67
    v_cvt_pk_bf16_f32 v82, v64, v65
    v_cvt_pk_bf16_f32 v83, v66, v67
    v_mfma_f32_32x32x16_bf16 v[52:67], v[120:123], v[28:31], 0
    s_waitcnt vmcnt(0) lgkmcnt(0)
    s_barrier
    ds_read_b128 v[116:119], v144 offset:20480
    v_exp_f32 v36, v36
    v_exp_f32 v37, v37
    v_exp_f32 v38, v38
    v_cvt_pk_bf16_f32 v68, v36, v37
    v_exp_f32 v39, v39
    v_mfma_f32_32x32x8bf16_1k v[52:67], v[126:127], v[34:35], v[52:67]
    s_setprio 3
    v_exp_f32 v40, v40
    v_cvt_pk_bf16_f32 v69, v38, v39
    v_exp_f32 v41, v41
    v_exp_f32 v42, v42
    v_cvt_pk_bf16_f32 v70, v40, v41
    v_exp_f32 v43, v43
    v_mfma_f32_32x32x16_bf16 v[100:115], v[132:135], v[80:83], v[100:115]
    s_mov_b64 exec, s[90:91]
    ds_read_b64 v[124:125], v156 offset:21504
    s_mov_b64 exec, -1
    v_exp_f32 v44, v44
    v_cvt_pk_bf16_f32 v71, v42, v43
    v_exp_f32 v45, v45
    v_exp_f32 v46, v46
    v_cvt_pk_bf16_f32 v72, v44, v45
    v_exp_f32 v47, v47
    v_mfma_f32_32x32x16_bf16 v[84:99], v[136:139], v[68:71], v[84:99]
    s_waitcnt lgkmcnt(1)
    s_cmp_eq_u32 s3, 1
    s_cbranch_scc1 L_ool_26
L_ool_26_r:
    v_exp_f32 v48, v48
    v_cvt_pk_bf16_f32 v73, v46, v47
    v_exp_f32 v49, v49
    v_exp_f32 v50, v50
    v_exp_f32 v51, v51
    v_cvt_pk_bf16_f32 v74, v48, v49
    v_cvt_pk_bf16_f32 v75, v50, v51
    v_mfma_f32_32x32x16_bf16 v[36:51], v[116:119], v[24:27], 0
    s_waitcnt lgkmcnt(0)
    v_exp_f32 v52, v52
    v_exp_f32 v53, v53
    v_exp_f32 v54, v54
    v_cvt_pk_bf16_f32 v76, v52, v53
    v_exp_f32 v55, v55
    v_mfma_f32_32x32x8bf16_1k v[36:51], v[124:125], v[32:33], v[36:51]
    v_exp_f32 v56, v56
    v_cvt_pk_bf16_f32 v77, v54, v55
    v_exp_f32 v57, v57
    v_exp_f32 v58, v58
    v_cvt_pk_bf16_f32 v78, v56, v57
    v_exp_f32 v59, v59
    v_mfma_f32_32x32x16_bf16 v[84:99], v[140:143], v[72:75], v[84:99]
    s_mov_b64 exec, s[92:93]
    ds_read_b128 v[128:131], v146 offset:21760
    s_mov_b64 exec, -1
    v_exp_f32 v60, v60
    v_cvt_pk_bf16_f32 v79, v58, v59
    v_exp_f32 v61, v61
    v_exp_f32 v62, v62
    v_cvt_pk_bf16_f32 v80, v60, v61
    v_exp_f32 v63, v63
    v_mfma_f32_32x32x16_bf16 v[100:115], v[136:139], v[76:79], v[100:115]
    s_mov_b64 exec, s[92:93]
    ds_read_b128 v[132:135], v146 offset:22400
    s_mov_b64 exec, -1
    v_exp_f32 v64, v64
    v_cvt_pk_bf16_f32 v81, v62, v63
    v_exp_f32 v65, v65
    v_exp_f32 v66, v66
    v_exp_f32 v67, v67
    v_cvt_pk_bf16_f32 v82, v64, v65
    v_cvt_pk_bf16_f32 v83, v66, v67
    v_mfma_f32_32x32x16_bf16 v[52:67], v[116:119], v[28:31], 0
    s_waitcnt lgkmcnt(1)
    ds_read_b128 v[120:123], v144 offset:23040
    s_add_u32 m0, s38, 0
    v_exp_f32 v36, v36
    v_exp_f32 v37, v37
    v_exp_f32 v38, v38
    v_cvt_pk_bf16_f32 v68, v36, v37
    v_exp_f32 v39, v39
    v_mfma_f32_32x32x8bf16_1k v[52:67], v[124:125], v[34:35], v[52:67]
    s_setprio 2
    buffer_load_dwordx4 v2, s[4:7], s37 offen offset:0 sc1 lds
    buffer_load_dwordx4 v2, s[4:7], s37 offen offset:1024 sc1 lds
    s_mov_b64 exec, s[90:91]
    buffer_load_dwordx4 v2, s[4:7], s37 offen offset:2048 sc1 lds
    s_mov_b64 exec, -1
    s_add_u32 s37, s37, 10240
    v_exp_f32 v40, v40
    v_cvt_pk_bf16_f32 v69, v38, v39
    v_exp_f32 v41, v41
    v_exp_f32 v42, v42
    v_cvt_pk_bf16_f32 v70, v40, v41
    v_exp_f32 v43, v43
    v_mfma_f32_32x32x16_bf16 v[100:115], v[140:143], v[80:83], v[100:115]
    s_mov_b64 exec, s[90:91]
    ds_read_b64 v[126:127], v156 offset:24064
    s_mov_b64 exec, -1
    s_cmp_eq_u32 s3, 0
    s_cbranch_scc1 L_ool_27
L_ool_27_r:
    v_exp_f32 v44, v44
    v_cvt_pk_bf16_f32 v71, v42, v43
    v_exp_f32 v45, v45
    v_exp_f32 v46, v46
    v_cvt_pk_bf16_f32 v72, v44, v45
    v_exp_f32 v47, v47
    v_mfma_f32_32x32x16_bf16 v[84:99], v[128:131], v[68:71], v[84:99]
    s_waitcnt lgkmcnt(1)
    v_exp_f32 v48, v48
    v_cvt_pk_bf16_f32 v73, v46, v47
    v_exp_f32 v49, v49
    v_exp_f32 v50, v50
    v_exp_f32 v51, v51
    v_cvt_pk_bf16_f32 v74, v48, v49
    v_cvt_pk_bf16_f32 v75, v50, v51
    v_mfma_f32_32x32x16_bf16 v[36:51], v[120:123], v[24:27], 0
    s_waitcnt lgkmcnt(0)
    v_exp_f32 v52, v52
    v_exp_f32 v53, v53
    v_exp_f32 v54, v54
    v_cvt_pk_bf16_f32 v76, v52, v53
    v_exp_f32 v55, v55
    v_mfma_f32_32x32x8bf16_1k v[36:51], v[126:127], v[32:33], v[36:51]
    v_exp_f32 v56, v56
    v_cvt_pk_bf16_f32 v77, v54, v55
    v_exp_f32 v57, v57
    v_exp_f32 v58, v58
    v_cvt_pk_bf16_f32 v78, v56, v57
    v_exp_f32 v59, v59
    v_mfma_f32_32x32x16_bf16 v[84:99], v[132:135], v[72:75], v[84:99]
    s_mov_b64 exec, s[92:93]
    ds_read_b128 v[136:139], v146 offset:24320
    s_mov_b64 exec, -1
    s_cmp_eq_u32 s3, 1
    s_cbranch_scc1 L_ool_28
L_ool_28_r:
    v_exp_f32 v60, v60
    v_cvt_pk_bf16_f32 v79, v58, v59
    v_exp_f32 v61, v61
    v_exp_f32 v62, v62
    v_cvt_pk_bf16_f32 v80, v60, v61
    v_exp_f32 v63, v63
    v_mfma_f32_32x32x16_bf16 v[100:115], v[128:131], v[76:79], v[100:115]
    s_mov_b64 exec, s[92:93]
    ds_read_b128 v[140:143], v146 offset:24960
    s_mov_b64 exec, -1
    v_exp_f32 v64, v64
    v_cvt_pk_bf16_f32 v81, v62, v63
    v_exp_f32 v65, v65
    v_exp_f32 v66, v66
    v_exp_f32 v67, v67
    v_cvt_pk_bf16_f32 v82, v64, v65
    v_cvt_pk_bf16_f32 v83, v66, v67
    v_mfma_f32_32x32x16_bf16 v[52:67], v[120:123], v[28:31], 0
    s_waitcnt lgkmcnt(1)
    ds_read_b128 v[116:119], v144 offset:25600
    v_exp_f32 v36, v36
    v_exp_f32 v37, v37
    v_exp_f32 v38, v38
    v_cvt_pk_bf16_f32 v68, v36, v37
    v_exp_f32 v39, v39
    v_mfma_f32_32x32x8bf16_1k v[52:67], v[126:127], v[34:35], v[52:67]
    s_setprio 1
    v_exp_f32 v40, v40
    v_cvt_pk_bf16_f32 v69, v38, v39
    v_exp_f32 v41, v41
    v_exp_f32 v42, v42
    v_cvt_pk_bf16_f32 v70, v40, v41
    v_exp_f32 v43, v43
    v_mfma_f32_32x32x16_bf16 v[100:115], v[132:135], v[80:83], v[100:115]
    s_mov_b64 exec, s[90:91]
    ds_read_b64 v[124:125], v156 offset:26624
    s_mov_b64 exec, -1
    s_cmp_eq_u32 s3, 2
    s_cbranch_scc1 L_ool_29
L_ool_29_r:
    v_exp_f32 v44, v44
    v_cvt_pk_bf16_f32 v71, v42, v43
    v_exp_f32 v45, v45
    v_exp_f32 v46, v46
    v_cvt_pk_bf16_f32 v72, v44, v45
    v_exp_f32 v47, v47
    v_mfma_f32_32x32x16_bf16 v[84:99], v[136:139], v[68:71], v[84:99]
    s_waitcnt lgkmcnt(1)
    v_exp_f32 v48, v48
    v_cvt_pk_bf16_f32 v73, v46, v47
    v_exp_f32 v49, v49
    v_exp_f32 v50, v50
    v_exp_f32 v51, v51
    v_cvt_pk_bf16_f32 v74, v48, v49
    v_cvt_pk_bf16_f32 v75, v50, v51
    v_mfma_f32_32x32x16_bf16 v[36:51], v[116:119], v[24:27], 0
    s_waitcnt lgkmcnt(0)
    v_exp_f32 v52, v52
    v_exp_f32 v53, v53
    v_exp_f32 v54, v54
    v_cvt_pk_bf16_f32 v76, v52, v53
    v_exp_f32 v55, v55
    v_mfma_f32_32x32x8bf16_1k v[36:51], v[124:125], v[32:33], v[36:51]
    v_exp_f32 v56, v56
    v_cvt_pk_bf16_f32 v77, v54, v55
    v_exp_f32 v57, v57
    v_exp_f32 v58, v58
    v_cvt_pk_bf16_f32 v78, v56, v57
    v_exp_f32 v59, v59
    v_mfma_f32_32x32x16_bf16 v[84:99], v[140:143], v[72:75], v[84:99]
    s_mov_b64 exec, s[92:93]
    ds_read_b128 v[128:131], v146 offset:26880
    s_mov_b64 exec, -1
    s_cmp_eq_u32 s3, 3
    s_cbranch_scc1 L_ool_30
L_ool_30_r:
    v_exp_f32 v60, v60
    v_cvt_pk_bf16_f32 v79, v58, v59
    v_exp_f32 v61, v61
    v_exp_f32 v62, v62
    v_cvt_pk_bf16_f32 v80, v60, v61
    v_exp_f32 v63, v63
    v_mfma_f32_32x32x16_bf16 v[100:115], v[136:139], v[76:79], v[100:115]
    s_mov_b64 exec, s[92:93]
    ds_read_b128 v[132:135], v146 offset:27520
    s_mov_b64 exec, -1
    v_exp_f32 v64, v64
    v_cvt_pk_bf16_f32 v81, v62, v63
    v_exp_f32 v65, v65
    v_exp_f32 v66, v66
    v_exp_f32 v67, v67
    v_cvt_pk_bf16_f32 v82, v64, v65
    v_cvt_pk_bf16_f32 v83, v66, v67
    v_mfma_f32_32x32x16_bf16 v[52:67], v[116:119], v[28:31], 0
    s_waitcnt lgkmcnt(1)
    ds_read_b128 v[120:123], v144 offset:28160
    v_exp_f32 v36, v36
    v_exp_f32 v37, v37
    v_exp_f32 v38, v38
    v_cvt_pk_bf16_f32 v68, v36, v37
    v_exp_f32 v39, v39
    v_mfma_f32_32x32x8bf16_1k v[52:67], v[124:125], v[34:35], v[52:67]
    s_setprio 0
    v_exp_f32 v40, v40
    v_cvt_pk_bf16_f32 v69, v38, v39
    v_exp_f32 v41, v41
    v_exp_f32 v42, v42
    v_cvt_pk_bf16_f32 v70, v40, v41
    v_exp_f32 v43, v43
    v_mfma_f32_32x32x16_bf16 v[100:115], v[140:143], v[80:83], v[100:115]
    s_mov_b64 exec, s[90:91]
    ds_read_b64 v[126:127], v156 offset:29184
    s_mov_b64 exec, -1
    v_exp_f32 v44, v44
    v_cvt_pk_bf16_f32 v71, v42, v43
    v_exp_f32 v45, v45
    v_exp_f32 v46, v46
    v_cvt_pk_bf16_f32 v72, v44, v45
    v_exp_f32 v47, v47
    v_mfma_f32_32x32x16_bf16 v[84:99], v[128:131], v[68:71], v[84:99]
    s_waitcnt lgkmcnt(1)
    v_exp_f32 v48, v48
    v_cvt_pk_bf16_f32 v73, v46, v47
    v_exp_f32 v49, v49
    v_exp_f32 v50, v50
    v_exp_f32 v51, v51
    v_cvt_pk_bf16_f32 v74, v48, v49
    v_cvt_pk_bf16_f32 v75, v50, v51
    v_mfma_f32_32x32x16_bf16 v[36:51], v[120:123], v[24:27], 0
    s_waitcnt lgkmcnt(0)
    v_exp_f32 v52, v52
    v_exp_f32 v53, v53
    v_exp_f32 v54, v54
    v_cvt_pk_bf16_f32 v76, v52, v53
    v_exp_f32 v55, v55
    v_mfma_f32_32x32x8bf16_1k v[36:51], v[126:127], v[32:33], v[36:51]
    v_exp_f32 v56, v56
    v_cvt_pk_bf16_f32 v77, v54, v55
    v_exp_f32 v57, v57
    v_exp_f32 v58, v58
    v_cvt_pk_bf16_f32 v78, v56, v57
    v_exp_f32 v59, v59
    v_mfma_f32_32x32x16_bf16 v[84:99], v[132:135], v[72:75], v[84:99]
    s_mov_b64 exec, s[92:93]
    ds_read_b128 v[136:139], v146 offset:29440
    s_mov_b64 exec, -1
    v_exp_f32 v60, v60
    v_cvt_pk_bf16_f32 v79, v58, v59
    v_exp_f32 v61, v61
    v_exp_f32 v62, v62
    v_cvt_pk_bf16_f32 v80, v60, v61
    v_exp_f32 v63, v63
    v_mfma_f32_32x32x16_bf16 v[100:115], v[128:131], v[76:79], v[100:115]
    s_mov_b64 exec, s[92:93]
    ds_read_b128 v[140:143], v146 offset:30080
    s_mov_b64 exec, -1
    v_exp_f32 v64, v64
    v_cvt_pk_bf16_f32 v81, v62, v63
    v_exp_f32 v65, v65
    v_exp_f32 v66, v66
    v_exp_f32 v67, v67
    v_cvt_pk_bf16_f32 v82, v64, v65
    v_cvt_pk_bf16_f32 v83, v66, v67
    v_mfma_f32_32x32x16_bf16 v[52:67], v[120:123], v[28:31], 0
    s_waitcnt lgkmcnt(0)
    s_barrier
    ds_read_b128 v[116:119], v144 offset:40960
    v_exp_f32 v36, v36
    v_exp_f32 v37, v37
    v_exp_f32 v38, v38
    v_cvt_pk_bf16_f32 v68, v36, v37
    v_exp_f32 v39, v39
    v_mfma_f32_32x32x8bf16_1k v[52:67], v[126:127], v[34:35], v[52:67]
    s_setprio 3
    v_exp_f32 v40, v40
    v_cvt_pk_bf16_f32 v69, v38, v39
    v_exp_f32 v41, v41
    v_exp_f32 v42, v42
    v_cvt_pk_bf16_f32 v70, v40, v41
    v_exp_f32 v43, v43
    v_mfma_f32_32x32x16_bf16 v[100:115], v[132:135], v[80:83], v[100:115]
    s_mov_b64 exec, s[90:91]
    ds_read_b64 v[124:125], v156 offset:41984
    s_mov_b64 exec, -1
    v_exp_f32 v44, v44
    v_cvt_pk_bf16_f32 v71, v42, v43
    v_exp_f32 v45, v45
    v_exp_f32 v46, v46
    v_cvt_pk_bf16_f32 v72, v44, v45
    v_exp_f32 v47, v47
    v_mfma_f32_32x32x16_bf16 v[84:99], v[136:139], v[68:71], v[84:99]
    s_waitcnt lgkmcnt(1)
    v_exp_f32 v48, v48
    v_cvt_pk_bf16_f32 v73, v46, v47
    v_exp_f32 v49, v49
    v_exp_f32 v50, v50
    v_exp_f32 v51, v51
    v_cvt_pk_bf16_f32 v74, v48, v49
    v_cvt_pk_bf16_f32 v75, v50, v51
    v_mfma_f32_32x32x16_bf16 v[36:51], v[116:119], v[24:27], 0
    s_waitcnt lgkmcnt(0)
    v_exp_f32 v52, v52
    v_exp_f32 v53, v53
    v_exp_f32 v54, v54
    v_cvt_pk_bf16_f32 v76, v52, v53
    v_exp_f32 v55, v55
    v_mfma_f32_32x32x8bf16_1k v[36:51], v[124:125], v[32:33], v[36:51]
    v_exp_f32 v56, v56
    v_cvt_pk_bf16_f32 v77, v54, v55
    v_exp_f32 v57, v57
    v_exp_f32 v58, v58
    v_cvt_pk_bf16_f32 v78, v56, v57
    v_exp_f32 v59, v59
    v_mfma_f32_32x32x16_bf16 v[84:99], v[140:143], v[72:75], v[84:99]
    s_mov_b64 exec, s[92:93]
    ds_read_b128 v[128:131], v146 offset:42240
    s_mov_b64 exec, -1
    v_exp_f32 v60, v60
    v_cvt_pk_bf16_f32 v79, v58, v59
    v_exp_f32 v61, v61
    v_exp_f32 v62, v62
    v_cvt_pk_bf16_f32 v80, v60, v61
    v_exp_f32 v63, v63
    v_mfma_f32_32x32x16_bf16 v[100:115], v[136:139], v[76:79], v[100:115]
    s_mov_b64 exec, s[92:93]
    ds_read_b128 v[132:135], v146 offset:42880
    s_mov_b64 exec, -1
    v_exp_f32 v64, v64
    v_cvt_pk_bf16_f32 v81, v62, v63
    v_exp_f32 v65, v65
    v_exp_f32 v66, v66
    v_exp_f32 v67, v67
    v_cvt_pk_bf16_f32 v82, v64, v65
    v_cvt_pk_bf16_f32 v83, v66, v67
    v_mfma_f32_32x32x16_bf16 v[52:67], v[116:119], v[28:31], 0
    s_waitcnt lgkmcnt(1)
    ds_read_b128 v[120:123], v144 offset:43520
    s_add_u32 m0, s38, 20480
    v_exp_f32 v36, v36
    v_exp_f32 v37, v37
    v_exp_f32 v38, v38
    v_cvt_pk_bf16_f32 v68, v36, v37
    v_exp_f32 v39, v39
    v_mfma_f32_32x32x8bf16_1k v[52:67], v[124:125], v[34:35], v[52:67]
    s_setprio 2
    buffer_load_dwordx4 v2, s[4:7], s37 offen offset:0 sc1 lds
    buffer_load_dwordx4 v2, s[4:7], s37 offen offset:1024 sc1 lds
    s_mov_b64 exec, s[90:91]
    buffer_load_dwordx4 v2, s[4:7], s37 offen offset:2048 sc1 lds
    s_mov_b64 exec, -1
    s_add_u32 s37, s37, 10240
    v_exp_f32 v40, v40
    v_cvt_pk_bf16_f32 v69, v38, v39
    v_exp_f32 v41, v41
    v_exp_f32 v42, v42
    v_cvt_pk_bf16_f32 v70, v40, v41
    v_exp_f32 v43, v43
    v_mfma_f32_32x32x16_bf16 v[100:115], v[140:143], v[80:83], v[100:115]
    s_mov_b64 exec, s[90:91]
    ds_read_b64 v[126:127], v156 offset:44544
    s_mov_b64 exec, -1
    s_cmp_eq_u32 s3, 5
    s_cbranch_scc1 L_ool_31
L_ool_31_r:
    v_exp_f32 v44, v44
    v_cvt_pk_bf16_f32 v71, v42, v43
    v_exp_f32 v45, v45
    v_exp_f32 v46, v46
    v_cvt_pk_bf16_f32 v72, v44, v45
    v_exp_f32 v47, v47
    v_mfma_f32_32x32x16_bf16 v[84:99], v[128:131], v[68:71], v[84:99]
    s_waitcnt lgkmcnt(1)
    v_exp_f32 v48, v48
    v_cvt_pk_bf16_f32 v73, v46, v47
    v_exp_f32 v49, v49
    v_exp_f32 v50, v50
    v_exp_f32 v51, v51
    v_cvt_pk_bf16_f32 v74, v48, v49
    v_cvt_pk_bf16_f32 v75, v50, v51
    v_mfma_f32_32x32x16_bf16 v[36:51], v[120:123], v[24:27], 0
    s_waitcnt lgkmcnt(0)
    v_exp_f32 v52, v52
    v_exp_f32 v53, v53
    v_exp_f32 v54, v54
    v_cvt_pk_bf16_f32 v76, v52, v53
    v_exp_f32 v55, v55
    v_mfma_f32_32x32x8bf16_1k v[36:51], v[126:127], v[32:33], v[36:51]
    v_exp_f32 v56, v56
    v_cvt_pk_bf16_f32 v77, v54, v55
    v_exp_f32 v57, v57
    v_exp_f32 v58, v58
    v_cvt_pk_bf16_f32 v78, v56, v57
    v_exp_f32 v59, v59
    v_mfma_f32_32x32x16_bf16 v[84:99], v[132:135], v[72:75], v[84:99]
    s_mov_b64 exec, s[92:93]
    ds_read_b128 v[136:139], v146 offset:44800
    s_mov_b64 exec, -1
    v_exp_f32 v60, v60
    v_cvt_pk_bf16_f32 v79, v58, v59
    v_exp_f32 v61, v61
    v_exp_f32 v62, v62
    v_cvt_pk_bf16_f32 v80, v60, v61
    v_exp_f32 v63, v63
    v_mfma_f32_32x32x16_bf16 v[100:115], v[128:131], v[76:79], v[100:115]
    s_mov_b64 exec, s[92:93]
    ds_read_b128 v[140:143], v146 offset:45440
    s_mov_b64 exec, -1
    v_exp_f32 v64, v64
    v_cvt_pk_bf16_f32 v81, v62, v63
    v_exp_f32 v65, v65
    v_exp_f32 v66, v66
    v_exp_f32 v67, v67
    v_cvt_pk_bf16_f32 v82, v64, v65
    v_cvt_pk_bf16_f32 v83, v66, v67
    v_mfma_f32_32x32x16_bf16 v[52:67], v[120:123], v[28:31], 0
    s_waitcnt lgkmcnt(1)
    ds_read_b128 v[116:119], v144 offset:46080
    v_exp_f32 v36, v36
    v_exp_f32 v37, v37
    v_exp_f32 v38, v38
    v_cvt_pk_bf16_f32 v68, v36, v37
    v_exp_f32 v39, v39
    v_mfma_f32_32x32x8bf16_1k v[52:67], v[126:127], v[34:35], v[52:67]
    s_setprio 1
    v_exp_f32 v40, v40
    v_cvt_pk_bf16_f32 v69, v38, v39
    v_exp_f32 v41, v41
    v_exp_f32 v42, v42
    v_cvt_pk_bf16_f32 v70, v40, v41
    v_exp_f32 v43, v43
    v_mfma_f32_32x32x16_bf16 v[100:115], v[132:135], v[80:83], v[100:115]
    s_mov_b64 exec, s[90:91]
    ds_read_b64 v[124:125], v156 offset:47104
    s_mov_b64 exec, -1
    v_exp_f32 v44, v44
    v_cvt_pk_bf16_f32 v71, v42, v43
    v_exp_f32 v45, v45
    v_exp_f32 v46, v46
    v_cvt_pk_bf16_f32 v72, v44, v45
    v_exp_f32 v47, v47
    v_mfma_f32_32x32x16_bf16 v[84:99], v[136:139], v[68:71], v[84:99]
    s_waitcnt lgkmcnt(1)
    v_exp_f32 v48, v48
    v_cvt_pk_bf16_f32 v73, v46, v47
    v_exp_f32 v49, v49
    v_exp_f32 v50, v50
    v_exp_f32 v51, v51
    v_cvt_pk_bf16_f32 v74, v48, v49
    v_cvt_pk_bf16_f32 v75, v50, v51
    v_mfma_f32_32x32x16_bf16 v[36:51], v[116:119], v[24:27], 0
    s_waitcnt lgkmcnt(0)
    v_exp_f32 v52, v52
    v_exp_f32 v53, v53
    v_exp_f32 v54, v54
    v_cvt_pk_bf16_f32 v76, v52, v53
    v_exp_f32 v55, v55
    v_mfma_f32_32x32x8bf16_1k v[36:51], v[124:125], v[32:33], v[36:51]
    v_exp_f32 v56, v56
    v_cvt_pk_bf16_f32 v77, v54, v55
    v_exp_f32 v57, v57
    v_exp_f32 v58, v58
    v_cvt_pk_bf16_f32 v78, v56, v57
    v_exp_f32 v59, v59
    v_mfma_f32_32x32x16_bf16 v[84:99], v[140:143], v[72:75], v[84:99]
    s_mov_b64 exec, s[92:93]
    ds_read_b128 v[128:131], v146 offset:47360
    s_mov_b64 exec, -1
    v_exp_f32 v60, v60
    v_cvt_pk_bf16_f32 v79, v58, v59
    v_exp_f32 v61, v61
    v_exp_f32 v62, v62
    v_cvt_pk_bf16_f32 v80, v60, v61
    v_exp_f32 v63, v63
    v_mfma_f32_32x32x16_bf16 v[100:115], v[136:139], v[76:79], v[100:115]
    s_mov_b64 exec, s[92:93]
    ds_read_b128 v[132:135], v146 offset:48000
    s_mov_b64 exec, -1
    v_exp_f32 v64, v64
    v_cvt_pk_bf16_f32 v81, v62, v63
    v_exp_f32 v65, v65
    v_exp_f32 v66, v66
    v_exp_f32 v67, v67
    v_cvt_pk_bf16_f32 v82, v64, v65
    v_cvt_pk_bf16_f32 v83, v66, v67
L_att48:
    v_mfma_f32_32x32x16_bf16 v[52:67], v[116:119], v[28:31], 0
    s_waitcnt lgkmcnt(1)
    ds_read_b128 v[120:123], v144 offset:48640
    v_exp_f32 v36, v36
    v_exp_f32 v37, v37
    v_exp_f32 v38, v38
    v_cvt_pk_bf16_f32 v68, v36, v37
    v_exp_f32 v39, v39
    v_mfma_f32_32x32x8bf16_1k v[52:67], v[124:125], v[34:35], v[52:67]
    s_setprio 0
    v_exp_f32 v40, v40
    v_cvt_pk_bf16_f32 v69, v38, v39
    v_exp_f32 v41, v41
    v_exp_f32 v42, v42
    v_cvt_pk_bf16_f32 v70, v40, v41
    v_exp_f32 v43, v43
    v_mfma_f32_32x32x16_bf16 v[100:115], v[140:143], v[80:83], v[100:115]
    s_mov_b64 exec, s[90:91]
    ds_read_b64 v[126:127], v156 offset:49664
    s_mov_b64 exec, -1
    v_exp_f32 v44, v44
    v_cvt_pk_bf16_f32 v71, v42, v43
    v_exp_f32 v45, v45
    v_exp_f32 v46, v46
    v_cvt_pk_bf16_f32 v72, v44, v45
    v_exp_f32 v47, v47
    v_mfma_f32_32x32x16_bf16 v[84:99], v[128:131], v[68:71], v[84:99]
    s_waitcnt lgkmcnt(1)
    s_cmp_eq_u32 s3, 2
    s_cbranch_scc1 L_ool_33
L_ool_33_r:
    v_exp_f32 v48, v48
    v_cvt_pk_bf16_f32 v73, v46, v47
    v_exp_f32 v49, v49
    v_exp_f32 v50, v50
    v_exp_f32 v51, v51
    v_cvt_pk_bf16_f32 v74, v48, v49
    v_cvt_pk_bf16_f32 v75, v50, v51
    v_mfma_f32_32x32x16_bf16 v[36:51], v[120:123], v[24:27], 0
    s_waitcnt lgkmcnt(0)
    v_exp_f32 v52, v52
    v_exp_f32 v53, v53
    v_exp_f32 v54, v54
    v_cvt_pk_bf16_f32 v76, v52, v53
    v_exp_f32 v55, v55
    v_mfma_f32_32x32x8bf16_1k v[36:51], v[126:127], v[32:33], v[36:51]
    v_exp_f32 v56, v56
    v_cvt_pk_bf16_f32 v77, v54, v55
    v_exp_f32 v57, v57
    v_exp_f32 v58, v58
    v_cvt_pk_bf16_f32 v78, v56, v57
    v_exp_f32 v59, v59
    v_mfma_f32_32x32x16_bf16 v[84:99], v[132:135], v[72:75], v[84:99]
    s_mov_b64 exec, s[92:93]
    ds_read_b128 v[136:139], v146 offset:49920
    s_mov_b64 exec, -1
    v_exp_f32 v60, v60
    v_cvt_pk_bf16_f32 v79, v58, v59
    v_exp_f32 v61, v61
    v_exp_f32 v62, v62
    v_cvt_pk_bf16_f32 v80, v60, v61
    v_exp_f32 v63, v63
    v_mfma_f32_32x32x16_bf16 v[100:115], v[128:131], v[76:79], v[100:115]
    s_mov_b64 exec, s[92:93]
    ds_read_b128 v[140:143], v146 offset:50560
    s_mov_b64 exec, -1
    v_exp_f32 v64, v64
    v_cvt_pk_bf16_f32 v81, v62, v63
    v_exp_f32 v65, v65
    v_exp_f32 v66, v66
    v_exp_f32 v67, v67
    v_cvt_pk_bf16_f32 v82, v64, v65
    v_cvt_pk_bf16_f32 v83, v66, v67
    v_mfma_f32_32x32x16_bf16 v[52:67], v[120:123], v[28:31], 0
    s_waitcnt vmcnt(0) lgkmcnt(0)
    s_cmp_eq_u32 s3, 2
    s_cbranch_scc1 L_ool_34
L_ool_34_r:
    s_barrier
    ds_read_b128 v[116:119], v144 offset:0
    v_exp_f32 v36, v36
    v_exp_f32 v37, v37
    v_exp_f32 v38, v38
    v_cvt_pk_bf16_f32 v68, v36, v37
    v_exp_f32 v39, v39
    v_mfma_f32_32x32x8bf16_1k v[52:67], v[126:127], v[34:35], v[52:67]
    s_setprio 3
    v_exp_f32 v40, v40
    v_cvt_pk_bf16_f32 v69, v38, v39
    v_exp_f32 v41, v41
    v_exp_f32 v42, v42
    v_cvt_pk_bf16_f32 v70, v40, v41
    v_exp_f32 v43, v43
    v_mfma_f32_32x32x16_bf16 v[100:115], v[132:135], v[80:83], v[100:115]
    s_mov_b64 exec, s[90:91]
    ds_read_b64 v[124:125], v156 offset:1024
    s_mov_b64 exec, -1
    v_exp_f32 v44, v44
    v_cvt_pk_bf16_f32 v71, v42, v43
    v_exp_f32 v45, v45
    v_exp_f32 v46, v46
    v_cvt_pk_bf16_f32 v72, v44, v45
    v_exp_f32 v47, v47
    v_mfma_f32_32x32x16_bf16 v[84:99], v[136:139], v[68:71], v[84:99]
    s_waitcnt lgkmcnt(1)
    v_exp_f32 v48, v48
    v_cvt_pk_bf16_f32 v73, v46, v47
    v_exp_f32 v49, v49
    v_exp_f32 v50, v50
    v_exp_f32 v51, v51
    v_cvt_pk_bf16_f32 v74, v48, v49
    v_cvt_pk_bf16_f32 v75, v50, v51
    v_mfma_f32_32x32x16_bf16 v[36:51], v[116:119], v[24:27], 0
    s_waitcnt lgkmcnt(0)
    v_exp_f32 v52, v52
    v_exp_f32 v53, v53
    v_exp_f32 v54, v54
    v_cvt_pk_bf16_f32 v76, v52, v53
    v_exp_f32 v55, v55
    v_mfma_f32_32x32x8bf16_1k v[36:51], v[124:125], v[32:33], v[36:51]
    v_exp_f32 v56, v56
    v_cvt_pk_bf16_f32 v77, v54, v55
    v_exp_f32 v57, v57
    v_exp_f32 v58, v58
    v_cvt_pk_bf16_f32 v78, v56, v57
    v_exp_f32 v59, v59
    v_mfma_f32_32x32x16_bf16 v[84:99], v[140:143], v[72:75], v[84:99]
    s_mov_b64 exec, s[92:93]
    ds_read_b128 v[128:131], v146 offset:1280
    s_mov_b64 exec, -1
    s_cmp_eq_u32 s3, 0
    s_cbranch_scc1 L_ool_37
L_ool_37_r:
    v_exp_f32 v60, v60
    v_cvt_pk_bf16_f32 v79, v58, v59
    v_exp_f32 v61, v61
    v_exp_f32 v62, v62
    v_cvt_pk_bf16_f32 v80, v60, v61
    v_exp_f32 v63, v63
    v_mfma_f32_32x32x16_bf16 v[100:115], v[136:139], v[76:79], v[100:115]
    s_mov_b64 exec, s[92:93]
    ds_read_b128 v[132:135], v146 offset:1920
    s_mov_b64 exec, -1
    v_exp_f32 v64, v64
    v_cvt_pk_bf16_f32 v81, v62, v63
    v_exp_f32 v65, v65
    v_exp_f32 v66, v66
    v_exp_f32 v67, v67
    v_cvt_pk_bf16_f32 v82, v64, v65
    v_cvt_pk_bf16_f32 v83, v66, v67
    v_mfma_f32_32x32x16_bf16 v[52:67], v[116:119], v[28:31], 0
    s_waitcnt lgkmcnt(1)
    ds_read_b128 v[120:123], v144 offset:2560
    s_mov_b32 m0, s73
    v_exp_f32 v36, v36
    v_exp_f32 v37, v37
    v_exp_f32 v38, v38
    v_cvt_pk_bf16_f32 v68, v36, v37
    v_exp_f32 v39, v39
    v_mfma_f32_32x32x8bf16_1k v[52:67], v[124:125], v[34:35], v[52:67]
    s_setprio 2
    buffer_load_dwordx4 v2, s[4:7], s72 offen offset:0 sc1 lds
    buffer_load_dwordx4 v2, s[4:7], s72 offen offset:1024 sc1 lds
    buffer_load_dwordx4 v2, s[4:7], s72 offen offset:2048 sc1 lds
    buffer_load_dwordx4 v2, s[4:7], s72 offen offset:3072 sc1 lds
    v_exp_f32 v40, v40
    v_cvt_pk_bf16_f32 v69, v38, v39
    v_exp_f32 v41, v41
    v_exp_f32 v42, v42
    v_cvt_pk_bf16_f32 v70, v40, v41
    v_exp_f32 v43, v43
    v_mfma_f32_32x32x16_bf16 v[100:115], v[140:143], v[80:83], v[100:115]
    s_mov_b64 exec, s[90:91]
    ds_read_b64 v[126:127], v156 offset:3584
    s_mov_b64 exec, -1
    s_cmp_eq_u32 s3, 1
    s_cbranch_scc1 L_ool_38
L_ool_38_r:
    v_exp_f32 v44, v44
    v_cvt_pk_bf16_f32 v71, v42, v43
    v_exp_f32 v45, v45
    v_exp_f32 v46, v46
    v_cvt_pk_bf16_f32 v72, v44, v45
    v_exp_f32 v47, v47
    v_mfma_f32_32x32x16_bf16 v[84:99], v[128:131], v[68:71], v[84:99]
    s_waitcnt lgkmcnt(1)
    v_exp_f32 v48, v48
    v_cvt_pk_bf16_f32 v73, v46, v47
    v_exp_f32 v49, v49
    v_exp_f32 v50, v50
    v_exp_f32 v51, v51
    v_cvt_pk_bf16_f32 v74, v48, v49
    v_cvt_pk_bf16_f32 v75, v50, v51
    v_mfma_f32_32x32x16_bf16 v[36:51], v[120:123], v[24:27], 0
    s_waitcnt lgkmcnt(0)
    v_exp_f32 v52, v52
    v_exp_f32 v53, v53
    v_exp_f32 v54, v54
    v_cvt_pk_bf16_f32 v76, v52, v53
    v_exp_f32 v55, v55
    v_mfma_f32_32x32x8bf16_1k v[36:51], v[126:127], v[32:33], v[36:51]
    v_exp_f32 v56, v56
    v_cvt_pk_bf16_f32 v77, v54, v55
    v_exp_f32 v57, v57
    v_exp_f32 v58, v58
    v_cvt_pk_bf16_f32 v78, v56, v57
    v_exp_f32 v59, v59
    v_mfma_f32_32x32x16_bf16 v[84:99], v[132:135], v[72:75], v[84:99]
    s_mov_b64 exec, s[92:93]
    ds_read_b128 v[136:139], v146 offset:3840
    s_mov_b64 exec, -1
    s_cmp_eq_u32 s3, 2
    s_cbranch_scc1 L_ool_39
L_ool_39_r:
    v_exp_f32 v60, v60
    v_cvt_pk_bf16_f32 v79, v58, v59
    v_exp_f32 v61, v61
    v_exp_f32 v62, v62
    v_cvt_pk_bf16_f32 v80, v60, v61
    v_exp_f32 v63, v63
    v_mfma_f32_32x32x16_bf16 v[100:115], v[128:131], v[76:79], v[100:115]
    s_mov_b64 exec, s[92:93]
    ds_read_b128 v[140:143], v146 offset:4480
    s_mov_b64 exec, -1
    v_exp_f32 v64, v64
    v_cvt_pk_bf16_f32 v81, v62, v63
    v_exp_f32 v65, v65
    v_exp_f32 v66, v66
    v_exp_f32 v67, v67
    v_cvt_pk_bf16_f32 v82, v64, v65
    v_cvt_pk_bf16_f32 v83, v66, v67
    v_mfma_f32_32x32x16_bf16 v[52:67], v[120:123], v[28:31], 0
    s_waitcnt lgkmcnt(1)
    ds_read_b128 v[116:119], v144 offset:5120
    v_exp_f32 v36, v36
    v_exp_f32 v37, v37
    v_exp_f32 v38, v38
    v_cvt_pk_bf16_f32 v68, v36, v37
    v_exp_f32 v39, v39
    v_mfma_f32_32x32x8bf16_1k v[52:67], v[126:127], v[34:35], v[52:67]
    s_setprio 1
    v_exp_f32 v40, v40
    v_cvt_pk_bf16_f32 v69, v38, v39
    v_exp_f32 v41, v41
    v_exp_f32 v42, v42
    v_cvt_pk_bf16_f32 v70, v40, v41
    v_exp_f32 v43, v43
    v_mfma_f32_32x32x16_bf16 v[100:115], v[132:135], v[80:83], v[100:115]
    s_mov_b64 exec, s[90:91]
    ds_read_b64 v[124:125], v156 offset:6144
    s_mov_b64 exec, -1
    s_cmp_eq_u32 s3, 3
    s_cbranch_scc1 L_ool_40
L_ool_40_r:
    v_exp_f32 v44, v44
    v_cvt_pk_bf16_f32 v71, v42, v43
    v_exp_f32 v45, v45
    v_exp_f32 v46, v46
    v_cvt_pk_bf16_f32 v72, v44, v45
    v_exp_f32 v47, v47
    v_mfma_f32_32x32x16_bf16 v[84:99], v[136:139], v[68:71], v[84:99]
    s_waitcnt lgkmcnt(1)
    v_exp_f32 v48, v48
    v_cvt_pk_bf16_f32 v73, v46, v47
    v_exp_f32 v49, v49
    v_exp_f32 v50, v50
    v_exp_f32 v51, v51
    v_cvt_pk_bf16_f32 v74, v48, v49
    v_cvt_pk_bf16_f32 v75, v50, v51
    v_mfma_f32_32x32x16_bf16 v[36:51], v[116:119], v[24:27], 0
    s_waitcnt lgkmcnt(0)
    s_add_u32 s72, s72, 4096
    s_add_u32 s73, s73, 4096
    s_mov_b32 m0, s73
    v_exp_f32 v52, v52
    v_exp_f32 v53, v53
    v_exp_f32 v54, v54
    v_cvt_pk_bf16_f32 v76, v52, v53
    v_exp_f32 v55, v55
    v_mfma_f32_32x32x8bf16_1k v[36:51], v[124:125], v[32:33], v[36:51]
    buffer_load_dwordx4 v2, s[4:7], s72 offen offset:0 sc1 lds
    buffer_load_dwordx4 v2, s[4:7], s72 offen offset:1024 sc1 lds
    buffer_load_dwordx4 v2, s[4:7], s72 offen offset:2048 sc1 lds
    buffer_load_dwordx4 v2, s[4:7], s72 offen offset:3072 sc1 lds
    v_exp_f32 v56, v56
    v_cvt_pk_bf16_f32 v77, v54, v55
    v_exp_f32 v57, v57
    v_exp_f32 v58, v58
    v_cvt_pk_bf16_f32 v78, v56, v57
    v_exp_f32 v59, v59
    v_mfma_f32_32x32x16_bf16 v[84:99], v[140:143], v[72:75], v[84:99]
    s_mov_b64 exec, s[92:93]
    ds_read_b128 v[128:131], v146 offset:6400
    s_mov_b64 exec, -1
    s_cmp_eq_u32 s3, 4
    s_cbranch_scc1 L_ool_41
L_ool_41_r:
    v_exp_f32 v60, v60
    v_cvt_pk_bf16_f32 v79, v58, v59
    v_exp_f32 v61, v61
    v_exp_f32 v62, v62
    v_cvt_pk_bf16_f32 v80, v60, v61
    v_exp_f32 v63, v63
    v_mfma_f32_32x32x16_bf16 v[100:115], v[136:139], v[76:79], v[100:115]
    s_mov_b64 exec, s[92:93]
    ds_read_b128 v[132:135], v146 offset:7040
    s_mov_b64 exec, -1
    v_exp_f32 v64, v64
    v_cvt_pk_bf16_f32 v81, v62, v63
    v_exp_f32 v65, v65
    v_exp_f32 v66, v66
    v_exp_f32 v67, v67
    v_cvt_pk_bf16_f32 v82, v64, v65
    v_cvt_pk_bf16_f32 v83, v66, v67
    v_mfma_f32_32x32x16_bf16 v[52:67], v[116:119], v[28:31], 0
    s_waitcnt lgkmcnt(1)
    ds_read_b128 v[120:123], v144 offset:7680
    v_exp_f32 v36, v36
    v_exp_f32 v37, v37
    v_exp_f32 v38, v38
    v_cvt_pk_bf16_f32 v68, v36, v37
    v_exp_f32 v39, v39
    v_mfma_f32_32x32x8bf16_1k v[52:67], v[124:125], v[34:35], v[52:67]
    s_setprio 0
    v_exp_f32 v40, v40
    v_cvt_pk_bf16_f32 v69, v38, v39
    v_exp_f32 v41, v41
    v_exp_f32 v42, v42
    v_cvt_pk_bf16_f32 v70, v40, v41
    v_exp_f32 v43, v43
    v_mfma_f32_32x32x16_bf16 v[100:115], v[140:143], v[80:83], v[100:115]
    s_mov_b64 exec, s[90:91]
    ds_read_b64 v[126:127], v156 offset:8704
    s_mov_b64 exec, -1
    s_cmp_eq_u32 s3, 5
    s_cbranch_scc1 L_ool_42
L_ool_42_r:
    v_exp_f32 v44, v44
    v_cvt_pk_bf16_f32 v71, v42, v43
    v_exp_f32 v45, v45
    v_exp_f32 v46, v46
    v_cvt_pk_bf16_f32 v72, v44, v45
    v_exp_f32 v47, v47
    v_mfma_f32_32x32x16_bf16 v[84:99], v[128:131], v[68:71], v[84:99]
    s_waitcnt lgkmcnt(1)
    v_exp_f32 v48, v48
    v_cvt_pk_bf16_f32 v73, v46, v47
    v_exp_f32 v49, v49
    v_exp_f32 v50, v50
    v_exp_f32 v51, v51
    v_cvt_pk_bf16_f32 v74, v48, v49
    v_cvt_pk_bf16_f32 v75, v50, v51
    v_mfma_f32_32x32x16_bf16 v[36:51], v[120:123], v[24:27], 0
    s_waitcnt lgkmcnt(0)
    v_exp_f32 v52, v52
    v_exp_f32 v53, v53
    v_exp_f32 v54, v54
    v_cvt_pk_bf16_f32 v76, v52, v53
    v_exp_f32 v55, v55
    v_mfma_f32_32x32x8bf16_1k v[36:51], v[126:127], v[32:33], v[36:51]
    v_exp_f32 v56, v56
    v_cvt_pk_bf16_f32 v77, v54, v55
    v_exp_f32 v57, v57
    v_exp_f32 v58, v58
    v_cvt_pk_bf16_f32 v78, v56, v57
    v_exp_f32 v59, v59
    v_mfma_f32_32x32x16_bf16 v[84:99], v[132:135], v[72:75], v[84:99]
    s_mov_b64 exec, s[92:93]
    ds_read_b128 v[136:139], v146 offset:8960
    s_mov_b64 exec, -1
    s_cmp_eq_u32 s3, 6
    s_cbranch_scc1 L_ool_43
L_ool_43_r:
    v_exp_f32 v60, v60
    v_cvt_pk_bf16_f32 v79, v58, v59
    v_exp_f32 v61, v61
    v_exp_f32 v62, v62
    v_cvt_pk_bf16_f32 v80, v60, v61
    v_exp_f32 v63, v63
    v_mfma_f32_32x32x16_bf16 v[100:115], v[128:131], v[76:79], v[100:115]
    s_mov_b64 exec, s[92:93]
    ds_read_b128 v[140:143], v146 offset:9600
    s_mov_b64 exec, -1
    v_exp_f32 v64, v64
    v_cvt_pk_bf16_f32 v81, v62, v63
    v_exp_f32 v65, v65
    v_exp_f32 v66, v66
    v_exp_f32 v67, v67
    v_cvt_pk_bf16_f32 v82, v64, v65
    v_cvt_pk_bf16_f32 v83, v66, v67
    v_mfma_f32_32x32x16_bf16 v[52:67], v[120:123], v[28:31], 0
    s_waitcnt lgkmcnt(0)
    s_barrier
    ds_read_b128 v[116:119], v144 offset:20480
    v_exp_f32 v36, v36
    v_exp_f32 v37, v37
    v_exp_f32 v38, v38
    v_cvt_pk_bf16_f32 v68, v36, v37
    v_exp_f32 v39, v39
    v_mfma_f32_32x32x8bf16_1k v[52:67], v[126:127], v[34:35], v[52:67]
    s_setprio 3
    v_exp_f32 v40, v40
    v_cvt_pk_bf16_f32 v69, v38, v39
    v_exp_f32 v41, v41
    v_exp_f32 v42, v42
    v_cvt_pk_bf16_f32 v70, v40, v41
    v_exp_f32 v43, v43
    v_mfma_f32_32x32x16_bf16 v[100:115], v[132:135], v[80:83], v[100:115]
    s_mov_b64 exec, s[90:91]
    ds_read_b64 v[124:125], v156 offset:21504
    s_mov_b64 exec, -1
    s_cmp_eq_u32 s3, 7
    s_cbranch_scc1 L_ool_44
L_ool_44_r:
    v_exp_f32 v44, v44
    v_cvt_pk_bf16_f32 v71, v42, v43
    v_exp_f32 v45, v45
    v_exp_f32 v46, v46
    v_cvt_pk_bf16_f32 v72, v44, v45
    v_exp_f32 v47, v47
    v_mfma_f32_32x32x16_bf16 v[84:99], v[136:139], v[68:71], v[84:99]
    s_waitcnt lgkmcnt(1)
    v_exp_f32 v48, v48
    v_cvt_pk_bf16_f32 v73, v46, v47
    v_exp_f32 v49, v49
    v_exp_f32 v50, v50
    v_exp_f32 v51, v51
    v_cvt_pk_bf16_f32 v74, v48, v49
    v_cvt_pk_bf16_f32 v75, v50, v51
    v_mfma_f32_32x32x16_bf16 v[36:51], v[116:119], v[24:27], 0
    s_waitcnt lgkmcnt(0)
    v_exp_f32 v52, v52
    v_exp_f32 v53, v53
    v_exp_f32 v54, v54
    v_cvt_pk_bf16_f32 v76, v52, v53
    v_exp_f32 v55, v55
    v_mfma_f32_32x32x8bf16_1k v[36:51], v[124:125], v[32:33], v[36:51]
    v_exp_f32 v56, v56
    v_cvt_pk_bf16_f32 v77, v54, v55
    v_exp_f32 v57, v57
    v_exp_f32 v58, v58
    v_cvt_pk_bf16_f32 v78, v56, v57
    v_exp_f32 v59, v59
    v_mfma_f32_32x32x16_bf16 v[84:99], v[140:143], v[72:75], v[84:99]
    s_mov_b64 exec, s[92:93]
    ds_read_b128 v[128:131], v146 offset:21760
    s_mov_b64 exec, -1
    s_cmp_eq_u32 s3, 0
    s_cbranch_scc1 L_ool_45
L_ool_45_r:
    v_exp_f32 v60, v60
    v_cvt_pk_bf16_f32 v79, v58, v59
    v_exp_f32 v61, v61
    v_exp_f32 v62, v62
    v_cvt_pk_bf16_f32 v80, v60, v61
    v_exp_f32 v63, v63
    v_mfma_f32_32x32x16_bf16 v[100:115], v[136:139], v[76:79], v[100:115]
    s_mov_b64 exec, s[92:93]
    ds_read_b128 v[132:135], v146 offset:22400
    s_mov_b64 exec, -1
    v_exp_f32 v64, v64
    v_cvt_pk_bf16_f32 v81, v62, v63
    v_exp_f32 v65, v65
    v_exp_f32 v66, v66
    v_exp_f32 v67, v67
    v_cvt_pk_bf16_f32 v82, v64, v65
    v_cvt_pk_bf16_f32 v83, v66, v67
    v_mfma_f32_32x32x16_bf16 v[52:67], v[116:119], v[28:31], 0
    s_waitcnt lgkmcnt(1)
    ds_read_b128 v[120:123], v144 offset:23040
    s_add_u32 s72, s72, 4096
    s_add_u32 s73, s73, 4096
    s_mov_b32 m0, s73
    v_exp_f32 v36, v36
    v_exp_f32 v37, v37
    v_exp_f32 v38, v38
    v_cvt_pk_bf16_f32 v68, v36, v37
    v_exp_f32 v39, v39
    v_mfma_f32_32x32x8bf16_1k v[52:67], v[124:125], v[34:35], v[52:67]
    s_setprio 2
    buffer_load_dwordx4 v2, s[4:7], s72 offen offset:0 sc1 lds
    buffer_load_dwordx4 v2, s[4:7], s72 offen offset:1024 sc1 lds
    buffer_load_dwordx4 v2, s[4:7], s72 offen offset:2048 sc1 lds
    buffer_load_dwordx4 v2, s[4:7], s72 offen offset:3072 sc1 lds
    v_exp_f32 v40, v40
    v_cvt_pk_bf16_f32 v69, v38, v39
    v_exp_f32 v41, v41
    v_exp_f32 v42, v42
    v_cvt_pk_bf16_f32 v70, v40, v41
    v_exp_f32 v43, v43
    v_mfma_f32_32x32x16_bf16 v[100:115], v[140:143], v[80:83], v[100:115]
    s_mov_b64 exec, s[90:91]
    ds_read_b64 v[126:127], v156 offset:24064
    s_mov_b64 exec, -1
    s_cmp_eq_u32 s3, 1
    s_cbranch_scc1 L_ool_46
L_ool_46_r:
    v_exp_f32 v44, v44
    v_cvt_pk_bf16_f32 v71, v42, v43
    v_exp_f32 v45, v45
    v_exp_f32 v46, v46
    v_cvt_pk_bf16_f32 v72, v44, v45
    v_exp_f32 v47, v47
    v_mfma_f32_32x32x16_bf16 v[84:99], v[128:131], v[68:71], v[84:99]
    s_waitcnt lgkmcnt(1)
    v_exp_f32 v48, v48
    v_cvt_pk_bf16_f32 v73, v46, v47
    v_exp_f32 v49, v49
    v_exp_f32 v50, v50
    v_exp_f32 v51, v51
    v_cvt_pk_bf16_f32 v74, v48, v49
    v_cvt_pk_bf16_f32 v75, v50, v51
    v_mfma_f32_32x32x16_bf16 v[36:51], v[120:123], v[24:27], 0
    s_waitcnt lgkmcnt(0)
    v_exp_f32 v52, v52
    v_exp_f32 v53, v53
    v_exp_f32 v54, v54
    v_cvt_pk_bf16_f32 v76, v52, v53
    v_exp_f32 v55, v55
    v_mfma_f32_32x32x8bf16_1k v[36:51], v[126:127], v[32:33], v[36:51]
    v_exp_f32 v56, v56
    v_cvt_pk_bf16_f32 v77, v54, v55
    v_exp_f32 v57, v57
    v_exp_f32 v58, v58
    v_cvt_pk_bf16_f32 v78, v56, v57
    v_exp_f32 v59, v59
    v_mfma_f32_32x32x16_bf16 v[84:99], v[132:135], v[72:75], v[84:99]
    s_mov_b64 exec, s[92:93]
    ds_read_b128 v[136:139], v146 offset:24320
    s_mov_b64 exec, -1
    s_cmp_eq_u32 s3, 2
    s_cbranch_scc1 L_ool_47
L_ool_47_r:
    v_exp_f32 v60, v60
    v_cvt_pk_bf16_f32 v79, v58, v59
    v_exp_f32 v61, v61
    v_exp_f32 v62, v62
    v_cvt_pk_bf16_f32 v80, v60, v61
    v_exp_f32 v63, v63
    v_mfma_f32_32x32x16_bf16 v[100:115], v[128:131], v[76:79], v[100:115]
    s_mov_b64 exec, s[92:93]
    ds_read_b128 v[140:143], v146 offset:24960
    s_mov_b64 exec, -1
    v_exp_f32 v64, v64
    v_cvt_pk_bf16_f32 v81, v62, v63
    v_exp_f32 v65, v65
    v_exp_f32 v66, v66
    v_exp_f32 v67, v67
    v_cvt_pk_bf16_f32 v82, v64, v65
    v_cvt_pk_bf16_f32 v83, v66, v67
    v_mfma_f32_32x32x16_bf16 v[52:67], v[120:123], v[28:31], 0
    s_waitcnt lgkmcnt(1)
    ds_read_b128 v[116:119], v144 offset:25600
    v_exp_f32 v36, v36
    v_exp_f32 v37, v37
    v_exp_f32 v38, v38
    v_cvt_pk_bf16_f32 v68, v36, v37
    v_exp_f32 v39, v39
    v_mfma_f32_32x32x8bf16_1k v[52:67], v[126:127], v[34:35], v[52:67]
    s_setprio 1
    v_exp_f32 v40, v40
    v_cvt_pk_bf16_f32 v69, v38, v39
    v_exp_f32 v41, v41
    v_exp_f32 v42, v42
    v_cvt_pk_bf16_f32 v70, v40, v41
    v_exp_f32 v43, v43
    v_mfma_f32_32x32x16_bf16 v[100:115], v[132:135], v[80:83], v[100:115]
    s_mov_b64 exec, s[90:91]
    ds_read_b64 v[124:125], v156 offset:26624
    s_mov_b64 exec, -1
    s_cmp_eq_u32 s3, 3
    s_cbranch_scc1 L_ool_48
L_ool_48_r:
    v_exp_f32 v44, v44
    v_cvt_pk_bf16_f32 v71, v42, v43
    v_exp_f32 v45, v45
    v_exp_f32 v46, v46
    v_cvt_pk_bf16_f32 v72, v44, v45
    v_exp_f32 v47, v47
    v_mfma_f32_32x32x16_bf16 v[84:99], v[136:139], v[68:71], v[84:99]
    s_waitcnt lgkmcnt(1)
    v_exp_f32 v48, v48
    v_cvt_pk_bf16_f32 v73, v46, v47
    v_exp_f32 v49, v49
    v_exp_f32 v50, v50
    v_exp_f32 v51, v51
    v_cvt_pk_bf16_f32 v74, v48, v49
    v_cvt_pk_bf16_f32 v75, v50, v51
    v_mfma_f32_32x32x16_bf16 v[36:51], v[116:119], v[24:27], 0
    s_waitcnt lgkmcnt(0)
    s_add_u32 s72, s72, 4096
    s_add_u32 s73, s73, 4096
    s_mov_b32 m0, s73
    v_exp_f32 v52, v52
    v_exp_f32 v53, v53
    v_exp_f32 v54, v54
    v_cvt_pk_bf16_f32 v76, v52, v53
    v_exp_f32 v55, v55
    v_mfma_f32_32x32x8bf16_1k v[36:51], v[124:125], v[32:33], v[36:51]
    s_mov_b64 exec, s[90:91]
    buffer_load_dwordx4 v2, s[4:7], s72 offen offset:0 sc1 lds
    s_mov_b64 exec, -1
    v_exp_f32 v56, v56
    v_cvt_pk_bf16_f32 v77, v54, v55
    v_exp_f32 v57, v57
    v_exp_f32 v58, v58
    v_cvt_pk_bf16_f32 v78, v56, v57
    v_exp_f32 v59, v59
    v_mfma_f32_32x32x16_bf16 v[84:99], v[140:143], v[72:75], v[84:99]
    s_mov_b64 exec, s[92:93]
    ds_read_b128 v[128:131], v146 offset:26880
    s_mov_b64 exec, -1
    s_cmp_eq_u32 s3, 4
    s_cbranch_scc1 L_ool_49
L_ool_49_r:
    v_exp_f32 v60, v60
    v_cvt_pk_bf16_f32 v79, v58, v59
    v_exp_f32 v61, v61
    v_exp_f32 v62, v62
    v_cvt_pk_bf16_f32 v80, v60, v61
    v_exp_f32 v63, v63
    v_mfma_f32_32x32x16_bf16 v[100:115], v[136:139], v[76:79], v[100:115]
    s_mov_b64 exec, s[92:93]
    ds_read_b128 v[132:135], v146 offset:27520
    s_mov_b64 exec, -1
    v_exp_f32 v64, v64
    v_cvt_pk_bf16_f32 v81, v62, v63
    v_exp_f32 v65, v65
    v_exp_f32 v66, v66
    v_exp_f32 v67, v67
    v_cvt_pk_bf16_f32 v82, v64, v65
    v_cvt_pk_bf16_f32 v83, v66, v67
    v_mfma_f32_32x32x16_bf16 v[52:67], v[116:119], v[28:31], 0
    s_waitcnt lgkmcnt(1)
    ds_read_b128 v[120:123], v144 offset:28160
    v_exp_f32 v36, v36
    v_exp_f32 v37, v37
    v_exp_f32 v38, v38
    v_cvt_pk_bf16_f32 v68, v36, v37
    v_exp_f32 v39, v39
    v_mfma_f32_32x32x8bf16_1k v[52:67], v[124:125], v[34:35], v[52:67]
    s_setprio 0
    v_exp_f32 v40, v40
    v_cvt_pk_bf16_f32 v69, v38, v39
    v_exp_f32 v41, v41
    v_exp_f32 v42, v42
    v_cvt_pk_bf16_f32 v70, v40, v41
    v_exp_f32 v43, v43
    v_mfma_f32_32x32x16_bf16 v[100:115], v[140:143], v[80:83], v[100:115]
    s_mov_b64 exec, s[90:91]
    ds_read_b64 v[126:127], v156 offset:29184
    s_mov_b64 exec, -1
    s_cmp_eq_u32 s3, 5
    s_cbranch_scc1 L_ool_50
L_ool_50_r:
    s_cmp_eq_u32 s3, 1
    s_cbranch_scc1 L_ool_51
L_ool_51_r:
    v_exp_f32 v44, v44
    v_cvt_pk_bf16_f32 v71, v42, v43
    v_exp_f32 v45, v45
    v_exp_f32 v46, v46
    v_cvt_pk_bf16_f32 v72, v44, v45
    v_exp_f32 v47, v47
    v_mfma_f32_32x32x16_bf16 v[84:99], v[128:131], v[68:71], v[84:99]
    s_waitcnt lgkmcnt(1)
    v_exp_f32 v48, v48
    v_cvt_pk_bf16_f32 v73, v46, v47
    v_exp_f32 v49, v49
    v_exp_f32 v50, v50
    v_exp_f32 v51, v51
    v_cvt_pk_bf16_f32 v74, v48, v49
    v_cvt_pk_bf16_f32 v75, v50, v51
    v_mfma_f32_32x32x16_bf16 v[36:51], v[120:123], v[24:27], 0
    s_waitcnt lgkmcnt(0)
    v_exp_f32 v52, v52
    v_exp_f32 v53, v53
    v_exp_f32 v54, v54
    v_cvt_pk_bf16_f32 v76, v52, v53
    v_exp_f32 v55, v55
    v_mfma_f32_32x32x8bf16_1k v[36:51], v[126:127], v[32:33], v[36:51]
    v_exp_f32 v56, v56
    v_cvt_pk_bf16_f32 v77, v54, v55
    v_exp_f32 v57, v57
    v_exp_f32 v58, v58
    v_cvt_pk_bf16_f32 v78, v56, v57
    v_exp_f32 v59, v59
    v_mfma_f32_32x32x16_bf16 v[84:99], v[132:135], v[72:75], v[84:99]
    s_mov_b64 exec, s[92:93]
    ds_read_b128 v[136:139], v146 offset:29440
    s_mov_b64 exec, -1
    s_cmp_eq_u32 s3, 6
    s_cbranch_scc1 L_ool_53
L_ool_53_r:
    v_exp_f32 v60, v60
    v_cvt_pk_bf16_f32 v79, v58, v59
    v_exp_f32 v61, v61
    v_exp_f32 v62, v62
    v_cvt_pk_bf16_f32 v80, v60, v61
    v_exp_f32 v63, v63
    v_mfma_f32_32x32x16_bf16 v[100:115], v[128:131], v[76:79], v[100:115]
    s_mov_b64 exec, s[92:93]
    ds_read_b128 v[140:143], v146 offset:30080
    s_mov_b64 exec, -1
    v_exp_f32 v64, v64
    v_cvt_pk_bf16_f32 v81, v62, v63
    v_exp_f32 v65, v65
    v_exp_f32 v66, v66
    v_exp_f32 v67, v67
    v_cvt_pk_bf16_f32 v82, v64, v65
    v_cvt_pk_bf16_f32 v83, v66, v67
    v_mfma_f32_32x32x16_bf16 v[52:67], v[120:123], v[28:31], 0
    s_waitcnt lgkmcnt(0)
    s_barrier
    v_exp_f32 v36, v36
    v_exp_f32 v37, v37
    v_exp_f32 v38, v38
    v_cvt_pk_bf16_f32 v68, v36, v37
    v_exp_f32 v39, v39
    v_mfma_f32_32x32x8bf16_1k v[52:67], v[126:127], v[34:35], v[52:67]
    s_setprio 3
    v_exp_f32 v40, v40
    v_cvt_pk_bf16_f32 v69, v38, v39
    v_exp_f32 v41, v41
    v_exp_f32 v42, v42
    v_cvt_pk_bf16_f32 v70, v40, v41
    v_exp_f32 v43, v43
    v_mfma_f32_32x32x16_bf16 v[100:115], v[132:135], v[80:83], v[100:115]
    s_cmp_eq_u32 s3, 7
    s_cbranch_scc1 L_ool_54
L_ool_54_r:
    v_exp_f32 v44, v44
    v_cvt_pk_bf16_f32 v71, v42, v43
    v_exp_f32 v45, v45
    v_exp_f32 v46, v46
    v_cvt_pk_bf16_f32 v72, v44, v45
    v_exp_f32 v47, v47
    v_mfma_f32_32x32x16_bf16 v[84:99], v[136:139], v[68:71], v[84:99]
    v_exp_f32 v48, v48
    v_cvt_pk_bf16_f32 v73, v46, v47
    v_exp_f32 v49, v49
    v_exp_f32 v50, v50
    v_exp_f32 v51, v51
    v_cvt_pk_bf16_f32 v74, v48, v49
    v_cvt_pk_bf16_f32 v75, v50, v51
    s_waitcnt lgkmcnt(0)
    v_exp_f32 v52, v52
    v_exp_f32 v53, v53
    v_exp_f32 v54, v54
    v_cvt_pk_bf16_f32 v76, v52, v53
    v_exp_f32 v55, v55
    v_exp_f32 v56, v56
    v_cvt_pk_bf16_f32 v77, v54, v55
    v_exp_f32 v57, v57
    v_exp_f32 v58, v58
    v_cvt_pk_bf16_f32 v78, v56, v57
    v_exp_f32 v59, v59
    v_mfma_f32_32x32x16_bf16 v[84:99], v[140:143], v[72:75], v[84:99]
    v_exp_f32 v60, v60
    v_cvt_pk_bf16_f32 v79, v58, v59
    v_exp_f32 v61, v61
    v_exp_f32 v62, v62
    v_cvt_pk_bf16_f32 v80, v60, v61
    v_exp_f32 v63, v63
    v_mfma_f32_32x32x16_bf16 v[100:115], v[136:139], v[76:79], v[100:115]
    v_exp_f32 v64, v64
    v_cvt_pk_bf16_f32 v81, v62, v63
    v_exp_f32 v65, v65
    v_exp_f32 v66, v66
    v_exp_f32 v67, v67
    v_cvt_pk_bf16_f32 v82, v64, v65
    v_cvt_pk_bf16_f32 v83, v66, v67
    s_setprio 0
    s_cmp_eq_u32 s33, 0
    v_mfma_f32_32x32x16_bf16 v[100:115], v[140:143], v[80:83], v[100:115]
    s_cbranch_scc1 att_x0
    ds_write_b128 v149, v[84:87] offset:0
    ds_write_b128 v149, v[88:91] offset:1024
    ds_write_b128 v149, v[92:95] offset:2048
    ds_write_b32 v149, v96 offset:3072
    s_waitcnt lgkmcnt(0)
    s_barrier
    ds_read_b32 v48, v150 offset:3072
    ds_read_b128 v[36:39], v150 offset:0
    ds_read_b128 v[40:43], v150 offset:1024
    ds_read_b128 v[44:47], v150 offset:2048
    s_waitcnt lgkmcnt(3)
    v_add_f32 v112, v112, v48
    v_cmp_nle_f32 vcc, v112, s51
    v_cmp_nge_f32 s[52:53], v112, s50
    v_rcp_f32 v160, v112
    s_waitcnt lgkmcnt(2)
    v_pk_add_f32 v[100:101], v[100:101], v[36:37]
    v_pk_add_f32 v[102:103], v[102:103], v[38:39]
    s_waitcnt lgkmcnt(1)
    v_pk_add_f32 v[104:105], v[104:105], v[40:41]
    v_pk_add_f32 v[106:107], v[106:107], v[42:43]
    s_waitcnt lgkmcnt(0)
    v_pk_add_f32 v[108:109], v[108:109], v[44:45]
    v_pk_add_f32 v[110:111], v[110:111], v[46:47]
    s_or_b64 vcc, vcc, s[52:53]
    s_cbranch_scc1 att_slow1
    v_mov_b32 v161, v160
    v_pk_mul_f32 v[100:101], v[100:101], v[160:161]
    v_pk_mul_f32 v[102:103], v[102:103], v[160:161]
    v_pk_mul_f32 v[104:105], v[104:105], v[160:161]
    v_pk_mul_f32 v[106:107], v[106:107], v[160:161]
    v_pk_mul_f32 v[108:109], v[108:109], v[160:161]
    v_pk_mul_f32 v[110:111], v[110:111], v[160:161]
    v_cvt_pk_bf16_f32 v68, v100, v101
    v_cvt_pk_bf16_f32 v69, v102, v103
    v_cvt_pk_bf16_f32 v70, v104, v105
    v_cvt_pk_bf16_f32 v71, v106, v107
    v_cvt_pk_bf16_f32 v72, v108, v109
    v_cvt_pk_bf16_f32 v73, v110, v111
    s_branch att_st
att_x0:
    s_nop 10
    ds_write_b128 v149, v[100:103] offset:0
    ds_write_b128 v149, v[104:107] offset:1024
    ds_write_b128 v149, v[108:111] offset:2048
    ds_write_b32 v149, v112 offset:3072
    s_waitcnt lgkmcnt(0)
    s_barrier
    ds_read_b32 v48, v150 offset:3072
    ds_read_b128 v[36:39], v150 offset:0
    ds_read_b128 v[40:43], v150 offset:1024
    ds_read_b128 v[44:47], v150 offset:2048
    s_waitcnt lgkmcnt(3)
    v_add_f32 v96, v96, v48
    v_cmp_nle_f32 vcc, v96, s51
    v_cmp_nge_f32 s[52:53], v96, s50
    v_rcp_f32 v160, v96
    s_waitcnt lgkmcnt(2)
    v_pk_add_f32 v[84:85], v[84:85], v[36:37]
    v_pk_add_f32 v[86:87], v[86:87], v[38:39]
    s_waitcnt lgkmcnt(1)
    v_pk_add_f32 v[88:89], v[88:89], v[40:41]
    v_pk_add_f32 v[90:91], v[90:91], v[42:43]
    s_waitcnt lgkmcnt(0)
    v_pk_add_f32 v[92:93], v[92:93], v[44:45]
    v_pk_add_f32 v[94:95], v[94:95], v[46:47]
    s_or_b64 vcc, vcc, s[52:53]
    s_cbranch_scc1 att_slow0
att_fin:
    v_mov_b32 v161, v160
    v_pk_mul_f32 v[84:85], v[84:85], v[160:161]
    v_pk_mul_f32 v[86:87], v[86:87], v[160:161]
    v_pk_mul_f32 v[88:89], v[88:89], v[160:161]
    v_pk_mul_f32 v[90:91], v[90:91], v[160:161]
    v_pk_mul_f32 v[92:93], v[92:93], v[160:161]
    v_pk_mul_f32 v[94:95], v[94:95], v[160:161]
    v_cvt_pk_bf16_f32 v68, v84, v85
    v_cvt_pk_bf16_f32 v69, v86, v87
    v_cvt_pk_bf16_f32 v70, v88, v89
    v_cvt_pk_bf16_f32 v71, v90, v91
    v_cvt_pk_bf16_f32 v72, v92, v93
    v_cvt_pk_bf16_f32 v73, v94, v95
att_st:
    buffer_store_dwordx4 v[68:71], v2, s[4:7], s48 offen sc1
    s_mov_b64 exec, s[90:91]
    buffer_store_dwordx2 v[72:73], v145, s[4:7], s49 offen sc1
    s_mov_b64 exec, -1
    v_and_b32 v3, 15, v1
    v_lshrrev_b32 v4, 4, v1
    v_lshlrev_b32 v5, 9, v4
    v_lshl_add_u32 v24, v3, 4, v5
    v_lshl_add_u32 v27, v3, 3, v5
    s_mul_i32 s40, s33, 40960
    s_add_u32 s40, s40, 61440
    v_add_u32 v26, s40, v2
    s_mul_i32 s40, s33, 10240
    s_add_u32 s40, s40, 143360
    v_add_u32 v28, s40, v2
    s_lshl_b32 s34, s70, 1
    s_bfe_u32 s35, s3, 0x10001
    s_add_u32 s34, s34, s35
    s_mul_i32 s76, s34, 40960
    s_and_b32 s35, s3, 1
    s_lshl_b32 s37, s35, 8
    s_lshl_b32 s42, s35, 7
    s_add_u32 s42, s42, s76
    s_add_u32 s42, s42, 7897088
    s_add_u32 s76, s76, s37
    s_mul_i32 s41, s33, 16384
    s_lshl_b32 s40, s33, 12
    s_add_u32 s42, s42, s40
    s_add_u32 s41, s41, s76
    s_add_u32 s41, s41, 7864320
    s_mul_i32 s37, s71, 5120
    s_add_u32 s76, s76, s37
    s_add_u32 s76, s76, 10485760
    v_lshrrev_b32 v5, 1, v4
    v_lshlrev_b32 v5, 9, v5
    v_lshl_add_u32 v5, v3, 4, v5
    v_and_b32 v6, 1, v4
    v_lshl_add_u32 v5, v6, 3, v5
    v_add_u32 v25, 4096, v5
    s_add_u32 s21, s31, 104
    s_lshr_b32 s22, s70, 2
    s_add_u32 s22, s22, 104
    s_lshl_b32 s24, s21, 7
    s_add_u32 s24, s24, 26738688
    v_mul_u32_u24 v5, 128, v1
    v_mov_b32 v6, 1
    s_waitcnt vmcnt(0)
    s_barrier
    s_cmp_lg_u32 s3, 0
    s_cbranch_scc1 L_wo_55
    s_mov_b64 exec, 0x1
    buffer_atomic_add v6, v5, s[4:7], s24 offen sc1
    s_mov_b64 exec, -1
L_wo_55:
    ds_read_b128 v[92:95], v26 offset:0
    ds_read_b128 v[96:99], v26 offset:1024
    ds_read_b128 v[100:103], v26 offset:2048
    ds_read_b128 v[104:107], v26 offset:3072
    ds_read_b128 v[108:111], v26 offset:4096
    ds_read_b128 v[112:115], v26 offset:5120
    ds_read_b128 v[116:119], v26 offset:6144
    ds_read_b128 v[120:123], v26 offset:7168
    ds_read_b128 v[124:127], v26 offset:8192
    ds_read_b128 v[128:131], v26 offset:9216
    ds_read_b128 v[132:135], v26 offset:10240
    ds_read_b128 v[136:139], v26 offset:11264
    ds_read_b128 v[140:143], v26 offset:12288
    ds_read_b128 v[144:147], v26 offset:13312
    ds_read_b128 v[148:151], v26 offset:14336
    s_waitcnt lgkmcnt(10)
    ds_read_b128 v[152:155], v26 offset:15360
    ds_read_b128 v[156:159], v26 offset:16384
    ds_read_b128 v[160:163], v26 offset:17408
    ds_read_b128 v[164:167], v26 offset:18432
    ds_read_b128 v[168:171], v26 offset:19456
    s_waitcnt lgkmcnt(10)
    ds_read_b128 v[196:199], v26 offset:20480
    ds_read_b128 v[200:203], v26 offset:21504
    ds_read_b128 v[204:207], v26 offset:22528
    ds_read_b128 v[208:211], v26 offset:23552
    ds_read_b128 v[212:215], v26 offset:24576
    s_waitcnt lgkmcnt(10)
    ds_read_b128 v[216:219], v26 offset:25600
    ds_read_b128 v[220:223], v26 offset:26624
    ds_read_b128 v[224:227], v26 offset:27648
    ds_read_b128 v[228:231], v26 offset:28672
    ds_read_b128 v[232:235], v26 offset:29696
    s_waitcnt lgkmcnt(10)
    ds_read_b128 v[236:239], v26 offset:30720
    ds_read_b128 v[240:243], v26 offset:31744
    ds_read_b128 v[244:247], v26 offset:32768
    ds_read_b128 v[248:251], v26 offset:33792
    ds_read_b128 v[252:255], v26 offset:34816
    v_lshlrev_b32 v72, 16, v184
    v_and_b32 v73, 0xffff0000, v184
    v_lshlrev_b32 v74, 16, v185
    v_and_b32 v75, 0xffff0000, v185
    v_lshlrev_b32 v76, 16, v186
    v_and_b32 v77, 0xffff0000, v186
    v_lshlrev_b32 v78, 16, v187
    v_and_b32 v79, 0xffff0000, v187
    v_lshlrev_b32 v80, 16, v188
    v_and_b32 v81, 0xffff0000, v188
    v_lshlrev_b32 v82, 16, v189
    v_and_b32 v83, 0xffff0000, v189
    v_lshlrev_b32 v84, 16, v190
    v_and_b32 v85, 0xffff0000, v190
    v_lshlrev_b32 v86, 16, v191
    v_and_b32 v87, 0xffff0000, v191
    v_lshlrev_b32 v88, 16, v192
    v_and_b32 v89, 0xffff0000, v192
    v_lshlrev_b32 v90, 16, v193
    v_and_b32 v91, 0xffff0000, v193
    s_cmp_lg_u32 s3, 0
    s_cbranch_scc1 L_sw_56
    s_lshl_b32 s20, s22, 7
    s_add_u32 s20, s20, 26738688
    v_lshlrev_b32 v5, 7, v1
    s_mov_b64 exec, 0x1
    s_mov_b32 s88, 1048576
L_spin_57:
    buffer_load_dword v6, v5, s[4:7], s20 offen sc1
    s_waitcnt vmcnt(0)
    v_cmp_ne_u32 vcc, 32, v6
    s_sub_u32 s88, s88, 1
    s_cbranch_scc1 L_spun_58
    s_nop 2
    s_cbranch_vccnz L_spin_57
L_spun_58:
    s_mov_b64 exec, -1
L_sw_56:
    s_barrier
    buffer_load_dwordx4 v[32:35], v24, s[4:7], s41 offen offset:0 sc1
    buffer_load_dwordx4 v[36:39], v24, s[4:7], s41 offen offset:2048 sc1
    s_add_u32 s41, s41, 4096
    buffer_load_dwordx4 v[40:43], v24, s[4:7], s41 offen offset:0 sc1
    buffer_load_dwordx4 v[44:47], v24, s[4:7], s41 offen offset:2048 sc1
    s_add_u32 s41, s41, 4096
    buffer_load_dwordx4 v[48:51], v24, s[4:7], s41 offen offset:0 sc1
    buffer_load_dwordx4 v[52:55], v24, s[4:7], s41 offen offset:2048 sc1
    s_add_u32 s41, s41, 4096
    buffer_load_dwordx4 v[56:59], v24, s[4:7], s41 offen offset:0 sc1
    buffer_load_dwordx4 v[60:63], v24, s[4:7], s41 offen offset:2048 sc1
    buffer_load_dwordx2 v[64:65], v27, s[4:7], s42 offen offset:0 sc1
    buffer_load_dwordx2 v[66:67], v27, s[4:7], s42 offen offset:256 sc1
    buffer_load_dwordx2 v[68:69], v27, s[4:7], s42 offen offset:2048 sc1
    buffer_load_dwordx2 v[70:71], v27, s[4:7], s42 offen offset:2304 sc1
.p2align 3
    s_nop 0
    s_waitcnt vmcnt(11) lgkmcnt(0)
    v_mfma_f32_16x16x32_bf16 v[72:75], v[92:95], v[32:35], v[72:75]
    v_mfma_f32_16x16x32_bf16 v[76:79], v[96:99], v[32:35], v[76:79]
    v_mfma_f32_16x16x32_bf16 v[80:83], v[100:103], v[32:35], v[80:83]
    v_mfma_f32_16x16x32_bf16 v[84:87], v[104:107], v[32:35], v[84:87]
    v_mfma_f32_16x16x32_bf16 v[88:91], v[108:111], v[32:35], v[88:91]
    s_waitcnt vmcnt(10)
    v_mfma_f32_16x16x32_bf16 v[72:75], v[112:115], v[36:39], v[72:75]
    ds_read_b128 v[92:95], v26 offset:35840
    ds_read_b128 v[96:99], v26 offset:36864
    v_mfma_f32_16x16x32_bf16 v[76:79], v[116:119], v[36:39], v[76:79]
    ds_read_b128 v[100:103], v26 offset:37888
    ds_read_b128 v[104:107], v26 offset:38912
    v_mfma_f32_16x16x32_bf16 v[80:83], v[120:123], v[36:39], v[80:83]
    ds_read_b128 v[108:111], v26 offset:39936
    v_mfma_f32_16x16x32_bf16 v[84:87], v[124:127], v[36:39], v[84:87]
    v_mfma_f32_16x16x32_bf16 v[88:91], v[128:131], v[36:39], v[88:91]
    s_waitcnt vmcnt(9)
    v_mfma_f32_16x16x32_bf16 v[72:75], v[132:135], v[40:43], v[72:75]
    ds_read_b128 v[112:115], v28 offset:0
    ds_read_b128 v[116:119], v28 offset:1024
    v_mfma_f32_16x16x32_bf16 v[76:79], v[136:139], v[40:43], v[76:79]
    ds_read_b128 v[120:123], v28 offset:2048
    ds_read_b128 v[124:127], v28 offset:3072
    v_mfma_f32_16x16x32_bf16 v[80:83], v[140:143], v[40:43], v[80:83]
    ds_read_b128 v[128:131], v28 offset:4096
    v_mfma_f32_16x16x32_bf16 v[84:87], v[144:147], v[40:43], v[84:87]
    v_mfma_f32_16x16x32_bf16 v[88:91], v[148:151], v[40:43], v[88:91]
    s_waitcnt vmcnt(8)
    v_mfma_f32_16x16x32_bf16 v[72:75], v[152:155], v[44:47], v[72:75]
    ds_read_b128 v[132:135], v28 offset:5120
    ds_read_b128 v[136:139], v28 offset:6144
    v_mfma_f32_16x16x32_bf16 v[76:79], v[156:159], v[44:47], v[76:79]
    ds_read_b128 v[140:143], v28 offset:7168
    ds_read_b128 v[144:147], v28 offset:8192
    v_mfma_f32_16x16x32_bf16 v[80:83], v[160:163], v[44:47], v[80:83]
    ds_read_b128 v[148:151], v28 offset:9216
    v_mfma_f32_16x16x32_bf16 v[84:87], v[164:167], v[44:47], v[84:87]
    v_mfma_f32_16x16x32_bf16 v[88:91], v[168:171], v[44:47], v[88:91]
    s_waitcnt vmcnt(7)
    v_mfma_f32_16x16x32_bf16 v[72:75], v[196:199], v[48:51], v[72:75]
    v_mfma_f32_16x16x32_bf16 v[76:79], v[200:203], v[48:51], v[76:79]
    v_mfma_f32_16x16x32_bf16 v[80:83], v[204:207], v[48:51], v[80:83]
    v_mfma_f32_16x16x32_bf16 v[84:87], v[208:211], v[48:51], v[84:87]
    v_mfma_f32_16x16x32_bf16 v[88:91], v[212:215], v[48:51], v[88:91]
    s_waitcnt vmcnt(6)
    v_mfma_f32_16x16x32_bf16 v[72:75], v[216:219], v[52:55], v[72:75]
    v_mfma_f32_16x16x32_bf16 v[76:79], v[220:223], v[52:55], v[76:79]
    v_mfma_f32_16x16x32_bf16 v[80:83], v[224:227], v[52:55], v[80:83]
    v_mfma_f32_16x16x32_bf16 v[84:87], v[228:231], v[52:55], v[84:87]
    v_mfma_f32_16x16x32_bf16 v[88:91], v[232:235], v[52:55], v[88:91]
    s_waitcnt vmcnt(5)
    v_mfma_f32_16x16x32_bf16 v[72:75], v[236:239], v[56:59], v[72:75]
    v_mfma_f32_16x16x32_bf16 v[76:79], v[240:243], v[56:59], v[76:79]
    v_mfma_f32_16x16x32_bf16 v[80:83], v[244:247], v[56:59], v[80:83]
    v_mfma_f32_16x16x32_bf16 v[84:87], v[248:251], v[56:59], v[84:87]
    v_mfma_f32_16x16x32_bf16 v[88:91], v[252:255], v[56:59], v[88:91]
    s_waitcnt vmcnt(4) lgkmcnt(10)
    v_mfma_f32_16x16x32_bf16 v[72:75], v[92:95], v[60:63], v[72:75]
    v_mfma_f32_16x16x32_bf16 v[76:79], v[96:99], v[60:63], v[76:79]
    v_mfma_f32_16x16x32_bf16 v[80:83], v[100:103], v[60:63], v[80:83]
    v_mfma_f32_16x16x32_bf16 v[84:87], v[104:107], v[60:63], v[84:87]
    v_mfma_f32_16x16x32_bf16 v[88:91], v[108:111], v[60:63], v[88:91]
    s_waitcnt vmcnt(2) lgkmcnt(5)
    v_mfma_f32_16x16x32_bf16 v[72:75], v[112:115], v[64:67], v[72:75]
    v_mfma_f32_16x16x32_bf16 v[76:79], v[116:119], v[64:67], v[76:79]
    v_mfma_f32_16x16x32_bf16 v[80:83], v[120:123], v[64:67], v[80:83]
    v_mfma_f32_16x16x32_bf16 v[84:87], v[124:127], v[64:67], v[84:87]
    v_mfma_f32_16x16x32_bf16 v[88:91], v[128:131], v[64:67], v[88:91]
    s_waitcnt vmcnt(0) lgkmcnt(0)
    v_mfma_f32_16x16x32_bf16 v[72:75], v[132:135], v[68:71], v[72:75]
    v_mfma_f32_16x16x32_bf16 v[76:79], v[136:139], v[68:71], v[76:79]
    v_mfma_f32_16x16x32_bf16 v[80:83], v[140:143], v[68:71], v[80:83]
    v_mfma_f32_16x16x32_bf16 v[84:87], v[144:147], v[68:71], v[84:87]
    v_mfma_f32_16x16x32_bf16 v[88:91], v[148:151], v[68:71], v[88:91]
wo_kj:
    s_mul_i32 s40, s32, 5120
    s_add_u32 s40, s40, 40960
    v_add_u32 v5, s40, v2
    s_cmp_eq_u32 s33, 0
    s_cbranch_scc1 wo_fin
    s_nop 3
    ds_write_b128 v5, v[72:75] offset:0
    ds_write_b128 v5, v[76:79] offset:1024
    ds_write_b128 v5, v[80:83] offset:2048
    ds_write_b128 v5, v[84:87] offset:3072
    ds_write_b128 v5, v[88:91] offset:4096
    s_waitcnt lgkmcnt(0)
    s_barrier
    s_setprio 0
    s_branch gu_loader
wo_fin:
    s_nop 3
    s_barrier
    ds_read_b128 v[92:95], v5 offset:0
    ds_read_b128 v[96:99], v5 offset:1024
    ds_read_b128 v[100:103], v5 offset:2048
    ds_read_b128 v[104:107], v5 offset:3072
    ds_read_b128 v[108:111], v5 offset:4096
    s_waitcnt lgkmcnt(4)
    v_pk_add_f32 v[72:73], v[72:73], v[92:93]
    v_pk_add_f32 v[74:75], v[74:75], v[94:95]
    s_waitcnt lgkmcnt(3)
    v_pk_add_f32 v[76:77], v[76:77], v[96:97]
    v_pk_add_f32 v[78:79], v[78:79], v[98:99]
    s_waitcnt lgkmcnt(2)
    v_pk_add_f32 v[80:81], v[80:81], v[100:101]
    v_pk_add_f32 v[82:83], v[82:83], v[102:103]
    s_waitcnt lgkmcnt(1)
    v_pk_add_f32 v[84:85], v[84:85], v[104:105]
    v_pk_add_f32 v[86:87], v[86:87], v[106:107]
    s_waitcnt lgkmcnt(0)
    v_pk_add_f32 v[88:89], v[88:89], v[108:109]
    v_pk_add_f32 v[90:91], v[90:91], v[110:111]
    v_cvt_pk_bf16_f32 v8, v72, v73
    v_cvt_pk_bf16_f32 v9, v74, v75
    v_cvt_pk_bf16_f32 v10, v76, v77
    v_cvt_pk_bf16_f32 v11, v78, v79
    v_cvt_pk_bf16_f32 v12, v80, v81
    v_cvt_pk_bf16_f32 v13, v82, v83
    v_cvt_pk_bf16_f32 v14, v84, v85
    v_cvt_pk_bf16_f32 v15, v86, v87
    v_cvt_pk_bf16_f32 v16, v88, v89
    v_cvt_pk_bf16_f32 v17, v90, v91
    buffer_store_dwordx4 v[8:11], v24, s[4:7], s76 offen sc1
    buffer_store_dwordx4 v[12:15], v24, s[4:7], s76 offen offset:2048 sc1
    buffer_store_dwordx2 v[16:17], v25, s[4:7], s76 offen sc1
    v_mov_b32 v34, 0x3f803f80
    v_dot2_f32_bf16 v33, v8, v8, 0
    v_dot2_f32_bf16 v32, v8, v34, 0
    v_dot2_f32_bf16 v33, v9, v9, v33
    v_dot2_f32_bf16 v32, v9, v34, v32
    v_dot2_f32_bf16 v33, v10, v10, v33
    v_dot2_f32_bf16 v32, v10, v34, v32
    v_dot2_f32_bf16 v33, v11, v11, v33
    v_dot2_f32_bf16 v32, v11, v34, v32
    v_dot2_f32_bf16 v33, v12, v12, v33
    v_dot2_f32_bf16 v32, v12, v34, v32
    v_dot2_f32_bf16 v33, v13, v13, v33
    v_dot2_f32_bf16 v32, v13, v34, v32
    v_dot2_f32_bf16 v33, v14, v14, v33
    v_dot2_f32_bf16 v32, v14, v34, v32
    v_dot2_f32_bf16 v33, v15, v15, v33
    v_dot2_f32_bf16 v32, v15, v34, v32
    v_dot2_f32_bf16 v33, v16, v16, v33
    v_dot2_f32_bf16 v32, v16, v34, v32
    v_dot2_f32_bf16 v33, v17, v17, v33
    v_dot2_f32_bf16 v32, v17, v34, v32
    s_lshl_b32 s34, s34, 3
    s_add_u32 s34, s34, s71
    s_lshl_b32 s34, s34, 8
    v_permlane32_swap_b32 v32, v33
    v_add_f32 v32, v32, v33
    v_mov_b32 v33, v32
    s_lshl_b32 s37, s35, 6
    s_add_u32 s34, s34, s37
    v_permlane16_swap_b32 v32, v33
    v_add_f32 v32, v32, v33
    s_add_u32 s34, s34, 26214400
    v_lshrrev_b32 v5, 5, v1
    v_lshlrev_b32 v5, 7, v5
    v_lshl_add_u32 v5, v3, 2, v5
    buffer_store_dword v32, v5, s[4:7], s34 offen sc1
    s_and_b32 s20, s2, 7
    s_lshr_b32 s21, s2, 3
    s_lshr_b32 s22, s20, 1
    s_lshl_b32 s30, s22, 2
    s_lshr_b32 s22, s21, 3
    s_add_u32 s30, s30, s22
    s_and_b32 s22, s20, 1
    s_lshl_b32 s31, s22, 3
    s_and_b32 s22, s21, 7
    s_add_u32 s31, s31, s22
    s_and_b32 s32, s3, 1
    s_lshr_b32 s33, s3, 1
    v_and_b32 v3, 15, v1
    v_lshrrev_b32 v4, 4, v1
    v_lshlrev_b32 v6, 4, v3
    v_lshl_add_u32 v7, v4, 9, v6
    s_lshl_b32 s34, s32, 12
    s_add_u32 s34, s34, 12288
    v_add_u32 v26, s34, v7
    v_and_b32 v7, 1, v4
    v_lshl_add_u32 v6, v7, 9, v6
    v_lshrrev_b32 v7, 1, v4
    v_lshl_add_u32 v240, v7, 8, v6
    v_mul_u32_u24 v7, 6144, v7
    s_mul_i32 s34, s33, 3072
    v_add3_u32 v27, v6, v7, s34
    v_mov_b32 v24, v26
    v_mov_b32 v25, v27
    s_lshl_b32 s34, s32, 10
    s_add_u32 s34, s34, 143360
    v_lshl_add_u32 v241, v3, 4, s34
    s_mul_i32 s34, s33, 384
    s_add_u32 s34, s34, 145408
    v_lshl_add_u32 v242, v3, 2, s34
    s_mov_b32 s52, 0xffff
    s_mov_b32 s53, 0
    v_mov_b32 v108, 0
    v_mov_b32 v109, 0
    v_mov_b32 v110, 0
    v_mov_b32 v111, 0
    v_mov_b32 v112, 0
    v_mov_b32 v113, 0
    v_mov_b32 v114, 0
    v_mov_b32 v115, 0
    v_mov_b32 v116, 0
    v_mov_b32 v117, 0
    v_mov_b32 v118, 0
    v_mov_b32 v119, 0
    v_mov_b32 v120, 0
    v_mov_b32 v121, 0
    v_mov_b32 v122, 0
    v_mov_b32 v123, 0
    v_mov_b32 v124, 0
    v_mov_b32 v125, 0
    v_mov_b32 v126, 0
    v_mov_b32 v127, 0
    v_mov_b32 v128, 0
    v_mov_b32 v129, 0
    v_mov_b32 v130, 0
    v_mov_b32 v131, 0
    v_mov_b32 v132, 0
    v_mov_b32 v133, 0
    v_mov_b32 v134, 0
    v_mov_b32 v135, 0
    v_mov_b32 v136, 0
    v_mov_b32 v137, 0
    v_mov_b32 v138, 0
    v_mov_b32 v139, 0
    v_mov_b32 v140, 0
    v_mov_b32 v141, 0
    v_mov_b32 v142, 0
    v_mov_b32 v143, 0
    v_mov_b32 v144, 0
    v_mov_b32 v145, 0
    v_mov_b32 v146, 0
    v_mov_b32 v147, 0
    v_mov_b32 v148, 0
    v_mov_b32 v149, 0
    v_mov_b32 v150, 0
    v_mov_b32 v151, 0
    v_mov_b32 v152, 0
    v_mov_b32 v153, 0
    v_mov_b32 v154, 0
    v_mov_b32 v155, 0
    v_mov_b32 v156, 0
    v_mov_b32 v157, 0
    v_mov_b32 v158, 0
    v_mov_b32 v159, 0
    v_mov_b32 v160, 0
    v_mov_b32 v161, 0
    v_mov_b32 v162, 0
    v_mov_b32 v163, 0
    v_mov_b32 v164, 0
    v_mov_b32 v165, 0
    v_mov_b32 v166, 0
    v_mov_b32 v167, 0
    v_mov_b32 v168, 0
    v_mov_b32 v169, 0
    v_mov_b32 v170, 0
    v_mov_b32 v171, 0
    v_mov_b32 v172, 0
    v_mov_b32 v173, 0
    v_mov_b32 v174, 0
    v_mov_b32 v175, 0
    v_mov_b32 v176, 0
    v_mov_b32 v177, 0
    v_mov_b32 v178, 0
    v_mov_b32 v179, 0
    v_mov_b32 v180, 0
    v_mov_b32 v181, 0
    v_mov_b32 v182, 0
    v_mov_b32 v183, 0
    v_mov_b32 v184, 0
    v_mov_b32 v185, 0
    v_mov_b32 v186, 0
    v_mov_b32 v187, 0
    v_mov_b32 v188, 0
    v_mov_b32 v189, 0
    v_mov_b32 v190, 0
    v_mov_b32 v191, 0
    v_mov_b32 v192, 0
    v_mov_b32 v193, 0
    v_mov_b32 v194, 0
    v_mov_b32 v195, 0
    v_mov_b32 v196, 0
    v_mov_b32 v197, 0
    v_mov_b32 v198, 0
    v_mov_b32 v199, 0
    v_mov_b32 v200, 0
    v_mov_b32 v201, 0
    v_mov_b32 v202, 0
    v_mov_b32 v203, 0
    s_lshl_b32 s35, s30, 2
    s_lshl_b32 s36, s32, 1
    s_add_u32 s35, s35, s36
    s_mul_i32 s36, s31, 6
    s_mul_i32 s37, s33, 3
    s_add_u32 s36, s36, s37
    s_mul_i32 s38, s35, 98304
    s_lshl_b32 s39, s36, 10
    s_add_u32 s38, s38, s39
    s_add_u32 s50, s38, 13107200
    s_add_u32 s51, s50, 98304
    s_mov_b32 s37, 0
    s_mov_b32 s48, 9
    s_lshr_b32 s21, s70, 1
    s_add_u32 s21, s21, 112
    s_add_u32 s22, s30, 112
    s_lshl_b32 s24, s21, 7
    s_add_u32 s24, s24, 26738688
    v_mul_u32_u24 v5, 128, v1
    v_mov_b32 v6, 1
    s_waitcnt vmcnt(0)
    s_barrier
    s_cmp_lg_u32 s3, 0
    s_cbranch_scc1 L_sw_59
    s_mov_b64 exec, 0x1
    buffer_atomic_add v6, v5, s[4:7], s24 offen sc1
    s_mov_b64 exec, -1
    s_lshl_b32 s20, s22, 7
    s_add_u32 s20, s20, 26738688
    v_lshlrev_b32 v5, 7, v1
    s_mov_b64 exec, 0x1
    s_mov_b32 s88, 1048576
L_spin_60:
    buffer_load_dword v6, v5, s[4:7], s20 offen sc1
    s_waitcnt vmcnt(0)
    v_cmp_ne_u32 vcc, 16, v6
    s_sub_u32 s88, s88, 1
    s_cbranch_scc1 L_spun_61
    s_nop 2
    s_cbranch_vccnz L_spin_60
L_spun_61:
    s_mov_b64 exec, -1
L_sw_59:
    s_barrier
    s_barrier
    ds_read_b128 v[60:63], v25 offset:0
    ds_read_b128 v[28:31], v24 offset:0
    ds_read_b128 v[32:35], v24 offset:256
    ds_read_b128 v[36:39], v24 offset:2048
    ds_read_b128 v[40:43], v24 offset:2304
    ds_read_b128 v[64:67], v25 offset:256
    ds_read_b128 v[68:71], v25 offset:1024
    ds_read_b128 v[72:75], v25 offset:1280
    ds_read_b128 v[76:79], v25 offset:2048
    ds_read_b128 v[80:83], v25 offset:2304
.p2align 3
gu_loop:
    s_waitcnt lgkmcnt(4)
    v_mfma_f32_16x16x32_bf16 v[108:111], v[60:63], v[28:31], v[108:111]
    s_add_u32 s37, s37, 20480
    v_mfma_f32_16x16x32_bf16 v[112:115], v[60:63], v[32:35], v[112:115]
    s_cmp_eq_u32 s37, 143360
    v_mfma_f32_16x16x32_bf16 v[116:119], v[60:63], v[36:39], v[116:119]
    s_cselect_b32 s37, 0, s37
    v_mfma_f32_16x16x32_bf16 v[120:123], v[60:63], v[40:43], v[120:123]
    v_add_u32 v24, s37, v26
    v_mfma_f32_16x16x32_bf16 v[124:127], v[64:67], v[28:31], v[124:127]
    v_add_u32 v25, s37, v27
    s_waitcnt lgkmcnt(0)
    s_barrier
    v_mfma_f32_16x16x32_bf16 v[128:131], v[64:67], v[32:35], v[128:131]
    ds_read_b128 v[84:87], v25 offset:0
    v_mfma_f32_16x16x32_bf16 v[132:135], v[64:67], v[36:39], v[132:135]
    ds_read_b128 v[44:47], v24 offset:0
    v_mfma_f32_16x16x32_bf16 v[136:139], v[64:67], v[40:43], v[136:139]
    ds_read_b128 v[48:51], v24 offset:256
    v_mfma_f32_16x16x32_bf16 v[140:143], v[68:71], v[28:31], v[140:143]
    ds_read_b128 v[52:55], v24 offset:2048
    v_mfma_f32_16x16x32_bf16 v[144:147], v[68:71], v[32:35], v[144:147]
    ds_read_b128 v[56:59], v24 offset:2304
    v_mfma_f32_16x16x32_bf16 v[148:151], v[68:71], v[36:39], v[148:151]
    ds_read_b128 v[88:91], v25 offset:256
    v_mfma_f32_16x16x32_bf16 v[152:155], v[68:71], v[40:43], v[152:155]
    ds_read_b128 v[92:95], v25 offset:1024
    v_mfma_f32_16x16x32_bf16 v[156:159], v[72:75], v[28:31], v[156:159]
    ds_read_b128 v[96:99], v25 offset:1280
    v_mfma_f32_16x16x32_bf16 v[160:163], v[72:75], v[32:35], v[160:163]
    ds_read_b128 v[100:103], v25 offset:2048
    v_mfma_f32_16x16x32_bf16 v[164:167], v[72:75], v[36:39], v[164:167]
    ds_read_b128 v[104:107], v25 offset:2304
    v_mfma_f32_16x16x32_bf16 v[168:171], v[72:75], v[40:43], v[168:171]
    v_mfma_f32_16x16x32_bf16 v[172:175], v[76:79], v[28:31], v[172:175]
    v_mfma_f32_16x16x32_bf16 v[176:179], v[76:79], v[32:35], v[176:179]
    v_mfma_f32_16x16x32_bf16 v[180:183], v[76:79], v[36:39], v[180:183]
    v_mfma_f32_16x16x32_bf16 v[184:187], v[76:79], v[40:43], v[184:187]
    v_mfma_f32_16x16x32_bf16 v[188:191], v[80:83], v[28:31], v[188:191]
    v_mfma_f32_16x16x32_bf16 v[192:195], v[80:83], v[32:35], v[192:195]
    v_mfma_f32_16x16x32_bf16 v[196:199], v[80:83], v[36:39], v[196:199]
    v_mfma_f32_16x16x32_bf16 v[200:203], v[80:83], v[40:43], v[200:203]
    s_waitcnt lgkmcnt(4)
    v_mfma_f32_16x16x32_bf16 v[108:111], v[84:87], v[44:47], v[108:111]
    s_add_u32 s37, s37, 20480
    v_mfma_f32_16x16x32_bf16 v[112:115], v[84:87], v[48:51], v[112:115]
    s_cmp_eq_u32 s37, 143360
    v_mfma_f32_16x16x32_bf16 v[116:119], v[84:87], v[52:55], v[116:119]
    s_cselect_b32 s37, 0, s37
    v_mfma_f32_16x16x32_bf16 v[120:123], v[84:87], v[56:59], v[120:123]
    v_add_u32 v24, s37, v26
    v_mfma_f32_16x16x32_bf16 v[124:127], v[88:91], v[44:47], v[124:127]
    v_add_u32 v25, s37, v27
    s_waitcnt lgkmcnt(0)
    s_barrier
    v_mfma_f32_16x16x32_bf16 v[128:131], v[88:91], v[48:51], v[128:131]
    ds_read_b128 v[60:63], v25 offset:0
    v_mfma_f32_16x16x32_bf16 v[132:135], v[88:91], v[52:55], v[132:135]
    ds_read_b128 v[28:31], v24 offset:0
    v_mfma_f32_16x16x32_bf16 v[136:139], v[88:91], v[56:59], v[136:139]
    ds_read_b128 v[32:35], v24 offset:256
    v_mfma_f32_16x16x32_bf16 v[140:143], v[92:95], v[44:47], v[140:143]
    ds_read_b128 v[36:39], v24 offset:2048
    v_mfma_f32_16x16x32_bf16 v[144:147], v[92:95], v[48:51], v[144:147]
    ds_read_b128 v[40:43], v24 offset:2304
    v_mfma_f32_16x16x32_bf16 v[148:151], v[92:95], v[52:55], v[148:151]
    ds_read_b128 v[64:67], v25 offset:256
    v_mfma_f32_16x16x32_bf16 v[152:155], v[92:95], v[56:59], v[152:155]
    ds_read_b128 v[68:71], v25 offset:1024
    v_mfma_f32_16x16x32_bf16 v[156:159], v[96:99], v[44:47], v[156:159]
    ds_read_b128 v[72:75], v25 offset:1280
    v_mfma_f32_16x16x32_bf16 v[160:163], v[96:99], v[48:51], v[160:163]
    ds_read_b128 v[76:79], v25 offset:2048
    v_mfma_f32_16x16x32_bf16 v[164:167], v[96:99], v[52:55], v[164:167]
    ds_read_b128 v[80:83], v25 offset:2304
    v_mfma_f32_16x16x32_bf16 v[168:171], v[96:99], v[56:59], v[168:171]
    s_sub_u32 s48, s48, 1
    v_mfma_f32_16x16x32_bf16 v[172:175], v[100:103], v[44:47], v[172:175]
    s_cmp_lg_u32 s48, 0
    v_mfma_f32_16x16x32_bf16 v[176:179], v[100:103], v[48:51], v[176:179]
    v_mfma_f32_16x16x32_bf16 v[180:183], v[100:103], v[52:55], v[180:183]
    v_mfma_f32_16x16x32_bf16 v[184:187], v[100:103], v[56:59], v[184:187]
    v_mfma_f32_16x16x32_bf16 v[188:191], v[104:107], v[44:47], v[188:191]
    v_mfma_f32_16x16x32_bf16 v[192:195], v[104:107], v[48:51], v[192:195]
    v_mfma_f32_16x16x32_bf16 v[196:199], v[104:107], v[52:55], v[196:199]
    v_mfma_f32_16x16x32_bf16 v[200:203], v[104:107], v[56:59], v[200:203]
    s_cbranch_scc1 gu_loop
gu_tail:
    s_waitcnt lgkmcnt(4)
    v_mfma_f32_16x16x32_bf16 v[108:111], v[60:63], v[28:31], v[108:111]
    s_add_u32 s37, s37, 20480
    v_mfma_f32_16x16x32_bf16 v[112:115], v[60:63], v[32:35], v[112:115]
    s_cmp_eq_u32 s37, 143360
    v_mfma_f32_16x16x32_bf16 v[116:119], v[60:63], v[36:39], v[116:119]
    s_cselect_b32 s37, 0, s37
    v_mfma_f32_16x16x32_bf16 v[120:123], v[60:63], v[40:43], v[120:123]
    v_add_u32 v24, s37, v26
    v_mfma_f32_16x16x32_bf16 v[124:127], v[64:67], v[28:31], v[124:127]
    v_add_u32 v25, s37, v27
    s_waitcnt lgkmcnt(0)
    s_barrier
    v_mfma_f32_16x16x32_bf16 v[128:131], v[64:67], v[32:35], v[128:131]
    ds_read_b128 v[84:87], v25 offset:0
    v_mfma_f32_16x16x32_bf16 v[132:135], v[64:67], v[36:39], v[132:135]
    ds_read_b128 v[44:47], v24 offset:0
    v_mfma_f32_16x16x32_bf16 v[136:139], v[64:67], v[40:43], v[136:139]
    ds_read_b128 v[48:51], v24 offset:256
    v_mfma_f32_16x16x32_bf16 v[140:143], v[68:71], v[28:31], v[140:143]
    ds_read_b128 v[52:55], v24 offset:2048
    v_mfma_f32_16x16x32_bf16 v[144:147], v[68:71], v[32:35], v[144:147]
    ds_read_b128 v[56:59], v24 offset:2304
    v_mfma_f32_16x16x32_bf16 v[148:151], v[68:71], v[36:39], v[148:151]
    ds_read_b128 v[88:91], v25 offset:256
    v_mfma_f32_16x16x32_bf16 v[152:155], v[68:71], v[40:43], v[152:155]
    ds_read_b128 v[92:95], v25 offset:1024
    v_mfma_f32_16x16x32_bf16 v[156:159], v[72:75], v[28:31], v[156:159]
    ds_read_b128 v[96:99], v25 offset:1280
    v_mfma_f32_16x16x32_bf16 v[160:163], v[72:75], v[32:35], v[160:163]
    ds_read_b128 v[100:103], v25 offset:2048
    v_mfma_f32_16x16x32_bf16 v[164:167], v[72:75], v[36:39], v[164:167]
    ds_read_b128 v[104:107], v25 offset:2304
    v_mfma_f32_16x16x32_bf16 v[168:171], v[72:75], v[40:43], v[168:171]
    v_mfma_f32_16x16x32_bf16 v[172:175], v[76:79], v[28:31], v[172:175]
    v_mfma_f32_16x16x32_bf16 v[176:179], v[76:79], v[32:35], v[176:179]
    v_mfma_f32_16x16x32_bf16 v[180:183], v[76:79], v[36:39], v[180:183]
    v_mfma_f32_16x16x32_bf16 v[184:187], v[76:79], v[40:43], v[184:187]
    v_mfma_f32_16x16x32_bf16 v[188:191], v[80:83], v[28:31], v[188:191]
    v_mfma_f32_16x16x32_bf16 v[192:195], v[80:83], v[32:35], v[192:195]
    v_mfma_f32_16x16x32_bf16 v[196:199], v[80:83], v[36:39], v[196:199]
    v_mfma_f32_16x16x32_bf16 v[200:203], v[80:83], v[40:43], v[200:203]
    s_waitcnt lgkmcnt(4)
    v_mfma_f32_16x16x32_bf16 v[108:111], v[84:87], v[44:47], v[108:111]
    v_mfma_f32_16x16x32_bf16 v[112:115], v[84:87], v[48:51], v[112:115]
    v_mfma_f32_16x16x32_bf16 v[116:119], v[84:87], v[52:55], v[116:119]
    v_mfma_f32_16x16x32_bf16 v[120:123], v[84:87], v[56:59], v[120:123]
    v_mfma_f32_16x16x32_bf16 v[124:127], v[88:91], v[44:47], v[124:127]
    s_waitcnt lgkmcnt(0)
    s_barrier
    v_mfma_f32_16x16x32_bf16 v[128:131], v[88:91], v[48:51], v[128:131]
    ds_read_b128 v[204:207], v241 offset:0
    ds_read_b128 v[208:211], v241 offset:256
    ds_read_b128 v[212:215], v241 offset:512
    v_mfma_f32_16x16x32_bf16 v[132:135], v[88:91], v[52:55], v[132:135]
    ds_read_b128 v[216:219], v241 offset:768
    ds_read_b32 v60, v242 offset:0
    ds_read_b32 v61, v242 offset:64
    v_mfma_f32_16x16x32_bf16 v[136:139], v[88:91], v[56:59], v[136:139]
    ds_read_b32 v62, v242 offset:128
    ds_read_b32 v63, v242 offset:192
    ds_read_b32 v64, v242 offset:256
    v_mfma_f32_16x16x32_bf16 v[140:143], v[92:95], v[44:47], v[140:143]
    ds_read_b32 v65, v242 offset:320
    v_mfma_f32_16x16x32_bf16 v[144:147], v[92:95], v[48:51], v[144:147]
    s_waitcnt lgkmcnt(0)
    s_barrier
    v_mfma_f32_16x16x32_bf16 v[148:151], v[92:95], v[52:55], v[148:151]
    v_sub_f32 v28, 0, v204
    v_cndmask_b32_e64 v28, 0, v28, s[52:53]
    v_and_b32 v29, 0xffff0000, v28
    v_sub_f32 v28, v28, v29
    v_mfma_f32_16x16x32_bf16 v[152:155], v[92:95], v[56:59], v[152:155]
    v_cvt_pk_bf16_f32 v220, v29, v29
    v_cvt_pk_bf16_f32 v221, v28, v28
    v_sub_f32 v28, 0, v208
    v_mfma_f32_16x16x32_bf16 v[156:159], v[96:99], v[44:47], v[156:159]
    v_cndmask_b32_e64 v28, 0, v28, s[52:53]
    v_and_b32 v29, 0xffff0000, v28
    v_sub_f32 v28, v28, v29
    v_cvt_pk_bf16_f32 v222, v29, v29
    v_mfma_f32_16x16x32_bf16 v[160:163], v[96:99], v[48:51], v[160:163]
    v_cvt_pk_bf16_f32 v223, v28, v28
    v_sub_f32 v28, 0, v212
    v_cndmask_b32_e64 v28, 0, v28, s[52:53]
    v_mfma_f32_16x16x32_bf16 v[164:167], v[96:99], v[52:55], v[164:167]
    v_and_b32 v29, 0xffff0000, v28
    v_sub_f32 v28, v28, v29
    v_cvt_pk_bf16_f32 v224, v29, v29
    v_cvt_pk_bf16_f32 v225, v28, v28
    v_mfma_f32_16x16x32_bf16 v[168:171], v[96:99], v[56:59], v[168:171]
    v_sub_f32 v28, 0, v216
    v_cndmask_b32_e64 v28, 0, v28, s[52:53]
    v_and_b32 v29, 0xffff0000, v28
    v_mfma_f32_16x16x32_bf16 v[172:175], v[100:103], v[44:47], v[172:175]
    v_sub_f32 v28, v28, v29
    v_cvt_pk_bf16_f32 v226, v29, v29
    v_cvt_pk_bf16_f32 v227, v28, v28
    v_mfma_f32_16x16x32_bf16 v[176:179], v[100:103], v[48:51], v[176:179]
    v_and_b32 v29, 0xffff0000, v60
    v_sub_f32 v28, v60, v29
    v_cvt_pk_bf16_f32 v228, v29, v28
    v_mov_b32 v229, v228
    v_mfma_f32_16x16x32_bf16 v[180:183], v[100:103], v[52:55], v[180:183]
    v_and_b32 v29, 0xffff0000, v61
    v_sub_f32 v28, v61, v29
    v_cvt_pk_bf16_f32 v230, v29, v28
    v_mfma_f32_16x16x32_bf16 v[184:187], v[100:103], v[56:59], v[184:187]
    v_mov_b32 v231, v230
    v_and_b32 v29, 0xffff0000, v62
    v_sub_f32 v28, v62, v29
    v_cvt_pk_bf16_f32 v232, v29, v28
    v_mfma_f32_16x16x32_bf16 v[188:191], v[104:107], v[44:47], v[188:191]
    v_mov_b32 v233, v232
    v_and_b32 v29, 0xffff0000, v63
    v_sub_f32 v28, v63, v29
    v_mfma_f32_16x16x32_bf16 v[192:195], v[104:107], v[48:51], v[192:195]
    v_cvt_pk_bf16_f32 v234, v29, v28
    v_mov_b32 v235, v234
    v_and_b32 v29, 0xffff0000, v64
    v_sub_f32 v28, v64, v29
    v_mfma_f32_16x16x32_bf16 v[196:199], v[104:107], v[52:55], v[196:199]
    v_cvt_pk_bf16_f32 v236, v29, v28
    v_mov_b32 v237, v236
    v_and_b32 v29, 0xffff0000, v65
    v_mfma_f32_16x16x32_bf16 v[200:203], v[104:107], v[56:59], v[200:203]
    v_sub_f32 v28, v65, v29
    v_cvt_pk_bf16_f32 v238, v29, v28
    v_mov_b32 v239, v238
    s_nop 0
    v_mfma_f32_16x16x16bf16_1k v[108:111], v[228:229], v[220:221], v[108:111]
    v_mfma_f32_16x16x16bf16_1k v[124:127], v[230:231], v[220:221], v[124:127]
    v_mfma_f32_16x16x16bf16_1k v[112:115], v[228:229], v[222:223], v[112:115]
    v_mfma_f32_16x16x16bf16_1k v[128:131], v[230:231], v[222:223], v[128:131]
    v_mfma_f32_16x16x16bf16_1k v[140:143], v[232:233], v[220:221], v[140:143]
    v_mfma_f32_16x16x16bf16_1k v[156:159], v[234:235], v[220:221], v[156:159]
    v_mfma_f32_16x16x16bf16_1k v[144:147], v[232:233], v[222:223], v[144:147]
    v_mfma_f32_16x16x16bf16_1k v[160:163], v[234:235], v[222:223], v[160:163]
    s_nop 3
    v_pk_mul_f32 v[28:29], v[108:109], v[204:205] op_sel:[0,1] op_sel_hi:[1,1]
    v_pk_mul_f32 v[30:31], v[110:111], v[204:205] op_sel:[0,1] op_sel_hi:[1,1]
    v_pk_mul_f32 v[32:33], v[112:113], v[208:209] op_sel:[0,1] op_sel_hi:[1,1]
    v_pk_mul_f32 v[34:35], v[114:115], v[208:209] op_sel:[0,1] op_sel_hi:[1,1]
    v_mfma_f32_16x16x16bf16_1k v[172:175], v[236:237], v[220:221], v[172:175]
    v_exp_f32 v28, v28
    v_exp_f32 v29, v29
    v_exp_f32 v30, v30
    v_exp_f32 v31, v31
    v_mfma_f32_16x16x16bf16_1k v[188:191], v[238:239], v[220:221], v[188:191]
    v_exp_f32 v32, v32
    v_exp_f32 v33, v33
    v_exp_f32 v34, v34
    v_exp_f32 v35, v35
    v_pk_mul_f32 v[108:109], v[108:109], v[124:125]
    v_pk_mul_f32 v[110:111], v[110:111], v[126:127]
    v_pk_mul_f32 v[112:113], v[112:113], v[128:129]
    v_pk_mul_f32 v[114:115], v[114:115], v[130:131]
    v_pk_fma_f32 v[28:29], v[28:29], v[206:207], v[206:207] op_sel_hi:[1,0,0]
    v_pk_fma_f32 v[30:31], v[30:31], v[206:207], v[206:207] op_sel_hi:[1,0,0]
    v_pk_fma_f32 v[32:33], v[32:33], v[210:211], v[210:211] op_sel_hi:[1,0,0]
    v_pk_fma_f32 v[34:35], v[34:35], v[210:211], v[210:211] op_sel_hi:[1,0,0]
    v_mfma_f32_16x16x16bf16_1k v[176:179], v[236:237], v[222:223], v[176:179]
    v_rcp_f32 v28, v28
    v_rcp_f32 v29, v29
    v_rcp_f32 v30, v30
    v_rcp_f32 v31, v31
    v_mfma_f32_16x16x16bf16_1k v[192:195], v[238:239], v[222:223], v[192:195]
    v_rcp_f32 v32, v32
    v_rcp_f32 v33, v33
    v_rcp_f32 v34, v34
    v_rcp_f32 v35, v35
    v_pk_mul_f32 v[108:109], v[108:109], v[28:29]
    v_pk_mul_f32 v[110:111], v[110:111], v[30:31]
    v_pk_mul_f32 v[112:113], v[112:113], v[32:33]
    v_pk_mul_f32 v[114:115], v[114:115], v[34:35]
    v_cvt_pk_bf16_f32 v68, v108, v109
    v_cvt_pk_bf16_f32 v69, v110, v111
    v_cvt_pk_bf16_f32 v70, v112, v113
    v_cvt_pk_bf16_f32 v71, v114, v115
    v_pk_mul_f32 v[36:37], v[140:141], v[204:205] op_sel:[0,1] op_sel_hi:[1,1]
    v_pk_mul_f32 v[38:39], v[142:143], v[204:205] op_sel:[0,1] op_sel_hi:[1,1]
    v_pk_mul_f32 v[40:41], v[144:145], v[208:209] op_sel:[0,1] op_sel_hi:[1,1]
    v_pk_mul_f32 v[42:43], v[146:147], v[208:209] op_sel:[0,1] op_sel_hi:[1,1]
    v_permlane32_swap_b32 v68, v70
    v_permlane32_swap_b32 v69, v71
    buffer_store_dwordx4 v[68:71], v240, s[4:7], s50 offen offset:0 sc1
    v_mfma_f32_16x16x16bf16_1k v[116:119], v[228:229], v[224:225], v[116:119]
    v_exp_f32 v36, v36
    v_exp_f32 v37, v37
    v_exp_f32 v38, v38
    v_exp_f32 v39, v39
    v_mfma_f32_16x16x16bf16_1k v[132:135], v[230:231], v[224:225], v[132:135]
    v_exp_f32 v40, v40
    v_exp_f32 v41, v41
    v_exp_f32 v42, v42
    v_exp_f32 v43, v43
    v_pk_mul_f32 v[140:141], v[140:141], v[156:157]
    v_pk_mul_f32 v[142:143], v[142:143], v[158:159]
    v_pk_mul_f32 v[144:145], v[144:145], v[160:161]
    v_pk_mul_f32 v[146:147], v[146:147], v[162:163]
    v_pk_fma_f32 v[36:37], v[36:37], v[206:207], v[206:207] op_sel_hi:[1,0,0]
    v_pk_fma_f32 v[38:39], v[38:39], v[206:207], v[206:207] op_sel_hi:[1,0,0]
    v_pk_fma_f32 v[40:41], v[40:41], v[210:211], v[210:211] op_sel_hi:[1,0,0]
    v_pk_fma_f32 v[42:43], v[42:43], v[210:211], v[210:211] op_sel_hi:[1,0,0]
    v_mfma_f32_16x16x16bf16_1k v[120:123], v[228:229], v[226:227], v[120:123]
    v_rcp_f32 v36, v36
    v_rcp_f32 v37, v37
    v_rcp_f32 v38, v38
    v_rcp_f32 v39, v39
    v_mfma_f32_16x16x16bf16_1k v[136:139], v[230:231], v[226:227], v[136:139]
    v_rcp_f32 v40, v40
    v_rcp_f32 v41, v41
    v_rcp_f32 v42, v42
    v_rcp_f32 v43, v43
    v_pk_mul_f32 v[140:141], v[140:141], v[36:37]
    v_pk_mul_f32 v[142:143], v[142:143], v[38:39]
    v_pk_mul_f32 v[144:145], v[144:145], v[40:41]
    v_pk_mul_f32 v[146:147], v[146:147], v[42:43]
    v_cvt_pk_bf16_f32 v72, v140, v141
    v_cvt_pk_bf16_f32 v73, v142, v143
    v_cvt_pk_bf16_f32 v74, v144, v145
    v_cvt_pk_bf16_f32 v75, v146, v147
    v_pk_mul_f32 v[28:29], v[172:173], v[204:205] op_sel:[0,1] op_sel_hi:[1,1]
    v_pk_mul_f32 v[30:31], v[174:175], v[204:205] op_sel:[0,1] op_sel_hi:[1,1]
    v_pk_mul_f32 v[32:33], v[176:177], v[208:209] op_sel:[0,1] op_sel_hi:[1,1]
    v_pk_mul_f32 v[34:35], v[178:179], v[208:209] op_sel:[0,1] op_sel_hi:[1,1]
    v_permlane32_swap_b32 v72, v74
    v_permlane32_swap_b32 v73, v75
    buffer_store_dwordx4 v[72:75], v240, s[4:7], s50 offen offset:1024 sc1
    v_mfma_f32_16x16x16bf16_1k v[148:151], v[232:233], v[224:225], v[148:151]
    v_exp_f32 v28, v28
    v_exp_f32 v29, v29
    v_exp_f32 v30, v30
    v_exp_f32 v31, v31
    v_mfma_f32_16x16x16bf16_1k v[164:167], v[234:235], v[224:225], v[164:167]
    v_exp_f32 v32, v32
    v_exp_f32 v33, v33
    v_exp_f32 v34, v34
    v_exp_f32 v35, v35
    v_pk_mul_f32 v[172:173], v[172:173], v[188:189]
    v_pk_mul_f32 v[174:175], v[174:175], v[190:191]
    v_pk_mul_f32 v[176:177], v[176:177], v[192:193]
    v_pk_mul_f32 v[178:179], v[178:179], v[194:195]
    v_pk_fma_f32 v[28:29], v[28:29], v[206:207], v[206:207] op_sel_hi:[1,0,0]
    v_pk_fma_f32 v[30:31], v[30:31], v[206:207], v[206:207] op_sel_hi:[1,0,0]
    v_pk_fma_f32 v[32:33], v[32:33], v[210:211], v[210:211] op_sel_hi:[1,0,0]
    v_pk_fma_f32 v[34:35], v[34:35], v[210:211], v[210:211] op_sel_hi:[1,0,0]
    v_mfma_f32_16x16x16bf16_1k v[152:155], v[232:233], v[226:227], v[152:155]
    v_rcp_f32 v28, v28
    v_rcp_f32 v29, v29
    v_rcp_f32 v30, v30
    v_rcp_f32 v31, v31
    v_mfma_f32_16x16x16bf16_1k v[168:171], v[234:235], v[226:227], v[168:171]
    v_rcp_f32 v32, v32
    v_rcp_f32 v33, v33
    v_rcp_f32 v34, v34
    v_rcp_f32 v35, v35
    v_pk_mul_f32 v[172:173], v[172:173], v[28:29]
    v_pk_mul_f32 v[174:175], v[174:175], v[30:31]
    v_pk_mul_f32 v[176:177], v[176:177], v[32:33]
    v_pk_mul_f32 v[178:179], v[178:179], v[34:35]
    v_cvt_pk_bf16_f32 v76, v172, v173
    v_cvt_pk_bf16_f32 v77, v174, v175
    v_cvt_pk_bf16_f32 v78, v176, v177
    v_cvt_pk_bf16_f32 v79, v178, v179
    v_pk_mul_f32 v[36:37], v[116:117], v[212:213] op_sel:[0,1] op_sel_hi:[1,1]
    v_pk_mul_f32 v[38:39], v[118:119], v[212:213] op_sel:[0,1] op_sel_hi:[1,1]
    v_pk_mul_f32 v[40:41], v[120:121], v[216:217] op_sel:[0,1] op_sel_hi:[1,1]
    v_pk_mul_f32 v[42:43], v[122:123], v[216:217] op_sel:[0,1] op_sel_hi:[1,1]
    v_permlane32_swap_b32 v76, v78
    v_permlane32_swap_b32 v77, v79
    buffer_store_dwordx4 v[76:79], v240, s[4:7], s50 offen offset:2048 sc1
    v_mfma_f32_16x16x16bf16_1k v[180:183], v[236:237], v[224:225], v[180:183]
    v_exp_f32 v36, v36
    v_exp_f32 v37, v37
    v_exp_f32 v38, v38
    v_exp_f32 v39, v39
    v_mfma_f32_16x16x16bf16_1k v[196:199], v[238:239], v[224:225], v[196:199]
    v_exp_f32 v40, v40
    v_exp_f32 v41, v41
    v_exp_f32 v42, v42
    v_exp_f32 v43, v43
    v_pk_mul_f32 v[116:117], v[116:117], v[132:133]
    v_pk_mul_f32 v[118:119], v[118:119], v[134:135]
    v_pk_mul_f32 v[120:121], v[120:121], v[136:137]
    v_pk_mul_f32 v[122:123], v[122:123], v[138:139]
    v_pk_fma_f32 v[36:37], v[36:37], v[214:215], v[214:215] op_sel_hi:[1,0,0]
    v_pk_fma_f32 v[38:39], v[38:39], v[214:215], v[214:215] op_sel_hi:[1,0,0]
    v_pk_fma_f32 v[40:41], v[40:41], v[218:219], v[218:219] op_sel_hi:[1,0,0]
    v_pk_fma_f32 v[42:43], v[42:43], v[218:219], v[218:219] op_sel_hi:[1,0,0]
    v_mfma_f32_16x16x16bf16_1k v[184:187], v[236:237], v[226:227], v[184:187]
    v_rcp_f32 v36, v36
    v_rcp_f32 v37, v37
    v_rcp_f32 v38, v38
    v_rcp_f32 v39, v39
    v_mfma_f32_16x16x16bf16_1k v[200:203], v[238:239], v[226:227], v[200:203]
    v_rcp_f32 v40, v40
    v_rcp_f32 v41, v41
    v_rcp_f32 v42, v42
    v_rcp_f32 v43, v43
    v_pk_mul_f32 v[116:117], v[116:117], v[36:37]
    v_pk_mul_f32 v[118:119], v[118:119], v[38:39]
    v_pk_mul_f32 v[120:121], v[120:121], v[40:41]
    v_pk_mul_f32 v[122:123], v[122:123], v[42:43]
    v_cvt_pk_bf16_f32 v80, v116, v117
    v_cvt_pk_bf16_f32 v81, v118, v119
    v_cvt_pk_bf16_f32 v82, v120, v121
    v_cvt_pk_bf16_f32 v83, v122, v123
    v_pk_mul_f32 v[28:29], v[148:149], v[212:213] op_sel:[0,1] op_sel_hi:[1,1]
    v_pk_mul_f32 v[30:31], v[150:151], v[212:213] op_sel:[0,1] op_sel_hi:[1,1]
    v_pk_mul_f32 v[32:33], v[152:153], v[216:217] op_sel:[0,1] op_sel_hi:[1,1]
    v_pk_mul_f32 v[34:35], v[154:155], v[216:217] op_sel:[0,1] op_sel_hi:[1,1]
    v_permlane32_swap_b32 v80, v82
    v_permlane32_swap_b32 v81, v83
    buffer_store_dwordx4 v[80:83], v240, s[4:7], s51 offen offset:0 sc1
    v_exp_f32 v28, v28
    v_exp_f32 v29, v29
    v_exp_f32 v30, v30
    v_exp_f32 v31, v31
    v_exp_f32 v32, v32
    v_exp_f32 v33, v33
    v_exp_f32 v34, v34
    v_exp_f32 v35, v35
    v_pk_mul_f32 v[148:149], v[148:149], v[164:165]
    v_pk_mul_f32 v[150:151], v[150:151], v[166:167]
    v_pk_mul_f32 v[152:153], v[152:153], v[168:169]
    v_pk_mul_f32 v[154:155], v[154:155], v[170:171]
    v_pk_fma_f32 v[28:29], v[28:29], v[214:215], v[214:215] op_sel_hi:[1,0,0]
    v_pk_fma_f32 v[30:31], v[30:31], v[214:215], v[214:215] op_sel_hi:[1,0,0]
    v_pk_fma_f32 v[32:33], v[32:33], v[218:219], v[218:219] op_sel_hi:[1,0,0]
    v_pk_fma_f32 v[34:35], v[34:35], v[218:219], v[218:219] op_sel_hi:[1,0,0]
    v_rcp_f32 v28, v28
    v_rcp_f32 v29, v29
    v_rcp_f32 v30, v30
    v_rcp_f32 v31, v31
    v_rcp_f32 v32, v32
    v_rcp_f32 v33, v33
    v_rcp_f32 v34, v34
    v_rcp_f32 v35, v35
    v_pk_mul_f32 v[148:149], v[148:149], v[28:29]
    v_pk_mul_f32 v[150:151], v[150:151], v[30:31]
    v_pk_mul_f32 v[152:153], v[152:153], v[32:33]
    v_pk_mul_f32 v[154:155], v[154:155], v[34:35]
    v_cvt_pk_bf16_f32 v68, v148, v149
    v_cvt_pk_bf16_f32 v69, v150, v151
    v_cvt_pk_bf16_f32 v70, v152, v153
    v_cvt_pk_bf16_f32 v71, v154, v155
    v_pk_mul_f32 v[36:37], v[180:181], v[212:213] op_sel:[0,1] op_sel_hi:[1,1]
    v_pk_mul_f32 v[38:39], v[182:183], v[212:213] op_sel:[0,1] op_sel_hi:[1,1]
    v_pk_mul_f32 v[40:41], v[184:185], v[216:217] op_sel:[0,1] op_sel_hi:[1,1]
    v_pk_mul_f32 v[42:43], v[186:187], v[216:217] op_sel:[0,1] op_sel_hi:[1,1]
    v_permlane32_swap_b32 v68, v70
    v_permlane32_swap_b32 v69, v71
    buffer_store_dwordx4 v[68:71], v240, s[4:7], s51 offen offset:1024 sc1
    v_exp_f32 v36, v36
    v_exp_f32 v37, v37
    v_exp_f32 v38, v38
    v_exp_f32 v39, v39
    v_exp_f32 v40, v40
    v_exp_f32 v41, v41
    v_exp_f32 v42, v42
    v_exp_f32 v43, v43
    v_pk_mul_f32 v[180:181], v[180:181], v[196:197]
    v_pk_mul_f32 v[182:183], v[182:183], v[198:199]
    v_pk_mul_f32 v[184:185], v[184:185], v[200:201]
    v_pk_mul_f32 v[186:187], v[186:187], v[202:203]
    v_pk_fma_f32 v[36:37], v[36:37], v[214:215], v[214:215] op_sel_hi:[1,0,0]
    v_pk_fma_f32 v[38:39], v[38:39], v[214:215], v[214:215] op_sel_hi:[1,0,0]
    v_pk_fma_f32 v[40:41], v[40:41], v[218:219], v[218:219] op_sel_hi:[1,0,0]
    v_pk_fma_f32 v[42:43], v[42:43], v[218:219], v[218:219] op_sel_hi:[1,0,0]
    v_rcp_f32 v36, v36
    v_rcp_f32 v37, v37
    v_rcp_f32 v38, v38
    v_rcp_f32 v39, v39
    v_rcp_f32 v40, v40
    v_rcp_f32 v41, v41
    v_rcp_f32 v42, v42
    v_rcp_f32 v43, v43
    v_pk_mul_f32 v[180:181], v[180:181], v[36:37]
    v_pk_mul_f32 v[182:183], v[182:183], v[38:39]
    v_pk_mul_f32 v[184:185], v[184:185], v[40:41]
    v_pk_mul_f32 v[186:187], v[186:187], v[42:43]
    v_cvt_pk_bf16_f32 v72, v180, v181
    v_cvt_pk_bf16_f32 v73, v182, v183
    v_cvt_pk_bf16_f32 v74, v184, v185
    v_cvt_pk_bf16_f32 v75, v186, v187
    s_nop 1
    v_permlane32_swap_b32 v72, v74
    v_permlane32_swap_b32 v73, v75
    buffer_store_dwordx4 v[72:75], v240, s[4:7], s51 offen offset:2048 sc1
    s_barrier
    s_branch L_down
gu_loader:
    s_and_b32 s20, s2, 7
    s_lshr_b32 s21, s2, 3
    s_lshr_b32 s22, s20, 1
    s_lshl_b32 s30, s22, 2
    s_lshr_b32 s22, s21, 3
    s_add_u32 s30, s30, s22
    s_and_b32 s22, s20, 1
    s_lshl_b32 s31, s22, 3
    s_and_b32 s22, s21, 7
    s_add_u32 s31, s31, s22
    s_sub_u32 s32, s3, 4
    s_lshl_b32 s33, s30, 2
    s_add_u32 s33, s33, s32
    s_mul_i32 s40, s33, 40960
    s_add_u32 s40, s40, 10485760
    s_mul_i32 s34, s31, 245760
    s_mul_i32 s35, s32, 3072
    s_add_u32 s34, s34, s35
    s_add_u32 s34, s34, 20250624
    s_lshl_b32 s36, s32, 11
    s_add_u32 s36, s36, 12288
    s_min_u32 s41, s32, 2
    s_lshl_b32 s41, s41, 8
    s_mul_i32 s42, s31, 768
    s_add_u32 s42, s42, s41
    s_add_u32 s42, s42, 26148864
    v_lshlrev_b32 v3, 2, v1
    buffer_load_dword v44, v3, s[4:7], s42 offen sc1
    s_add_u32 s42, s42, 12288
    buffer_load_dword v45, v3, s[4:7], s42 offen sc1
    s_add_u32 s42, s42, 12288
    buffer_load_dword v46, v3, s[4:7], s42 offen sc1
    s_add_u32 s42, s42, 12288
    buffer_load_dword v47, v3, s[4:7], s42 offen sc1
    s_add_u32 s42, s42, 12288
    buffer_load_dword v48, v3, s[4:7], s42 offen sc1
    s_add_u32 s42, s42, 12288
    s_add_u32 s38, s35, 0
    s_mov_b32 m0, s38
    s_add_u32 s39, s34, 0
    buffer_load_dwordx4 v2, s[4:7], s39 offen offset:0 sc1 lds
    buffer_load_dwordx4 v2, s[4:7], s39 offen offset:1024 sc1 lds
    buffer_load_dwordx4 v2, s[4:7], s39 offen offset:2048 sc1 lds
    s_add_u32 s38, s35, 20480
    s_mov_b32 m0, s38
    s_add_u32 s39, s34, 12288
    buffer_load_dwordx4 v2, s[4:7], s39 offen offset:0 sc1 lds
    buffer_load_dwordx4 v2, s[4:7], s39 offen offset:1024 sc1 lds
    buffer_load_dwordx4 v2, s[4:7], s39 offen offset:2048 sc1 lds
    s_add_u32 s38, s35, 61440
    s_mov_b32 m0, s38
    s_add_u32 s39, s34, 36864
    buffer_load_dwordx4 v2, s[4:7], s39 offen offset:0 sc1 lds
    buffer_load_dwordx4 v2, s[4:7], s39 offen offset:1024 sc1 lds
    buffer_load_dwordx4 v2, s[4:7], s39 offen offset:2048 sc1 lds
    s_barrier
    s_add_u32 s38, s35, 40960
    s_mov_b32 m0, s38
    s_add_u32 s39, s34, 24576
    buffer_load_dwordx4 v2, s[4:7], s39 offen offset:0 sc1 lds
    buffer_load_dwordx4 v2, s[4:7], s39 offen offset:1024 sc1 lds
    buffer_load_dwordx4 v2, s[4:7], s39 offen offset:2048 sc1 lds
    s_add_u32 s38, s35, 81920
    s_mov_b32 m0, s38
    s_add_u32 s39, s34, 49152
    buffer_load_dwordx4 v2, s[4:7], s39 offen offset:0 sc1 lds
    buffer_load_dwordx4 v2, s[4:7], s39 offen offset:1024 sc1 lds
    buffer_load_dwordx4 v2, s[4:7], s39 offen offset:2048 sc1 lds
    s_add_u32 s38, s35, 102400
    s_mov_b32 m0, s38
    s_add_u32 s39, s34, 61440
    buffer_load_dwordx4 v2, s[4:7], s39 offen offset:0 sc1 lds
    buffer_load_dwordx4 v2, s[4:7], s39 offen offset:1024 sc1 lds
    buffer_load_dwordx4 v2, s[4:7], s39 offen offset:2048 sc1 lds
    s_add_u32 s38, s35, 122880
    s_mov_b32 m0, s38
    s_add_u32 s39, s34, 73728
    buffer_load_dwordx4 v2, s[4:7], s39 offen offset:0 sc1 lds
    buffer_load_dwordx4 v2, s[4:7], s39 offen offset:1024 sc1 lds
    buffer_load_dwordx4 v2, s[4:7], s39 offen offset:2048 sc1 lds
    s_lshl_b32 s42, s33, 11
    s_add_u32 s42, s42, 26214400
    s_barrier
    s_add_u32 s38, s36, 0
    s_mov_b32 m0, s38
    s_add_u32 s39, s40, 0
    buffer_load_dwordx4 v2, s[4:7], s39 offen offset:0 sc1 lds
    buffer_load_dwordx4 v2, s[4:7], s39 offen offset:1024 sc1 lds
    s_add_u32 s38, s36, 20480
    s_mov_b32 m0, s38
    s_add_u32 s39, s40, 2048
    buffer_load_dwordx4 v2, s[4:7], s39 offen offset:0 sc1 lds
    buffer_load_dwordx4 v2, s[4:7], s39 offen offset:1024 sc1 lds
    s_add_u32 s38, s36, 40960
    s_mov_b32 m0, s38
    s_add_u32 s39, s40, 4096
    buffer_load_dwordx4 v2, s[4:7], s39 offen offset:0 sc1 lds
    buffer_load_dwordx4 v2, s[4:7], s39 offen offset:1024 sc1 lds
    s_add_u32 s38, s36, 61440
    s_mov_b32 m0, s38
    s_add_u32 s39, s40, 6144
    buffer_load_dwordx4 v2, s[4:7], s39 offen offset:0 sc1 lds
    buffer_load_dwordx4 v2, s[4:7], s39 offen offset:1024 sc1 lds
    s_add_u32 s38, s36, 81920
    s_mov_b32 m0, s38
    s_add_u32 s39, s40, 8192
    buffer_load_dwordx4 v2, s[4:7], s39 offen offset:0 sc1 lds
    buffer_load_dwordx4 v2, s[4:7], s39 offen offset:1024 sc1 lds
    s_add_u32 s38, s36, 102400
    s_mov_b32 m0, s38
    s_add_u32 s39, s40, 10240
    buffer_load_dwordx4 v2, s[4:7], s39 offen offset:0 sc1 lds
    buffer_load_dwordx4 v2, s[4:7], s39 offen offset:1024 sc1 lds
    s_add_u32 s38, s36, 122880
    s_mov_b32 m0, s38
    s_add_u32 s39, s40, 12288
    buffer_load_dwordx4 v2, s[4:7], s39 offen offset:0 sc1 lds
    buffer_load_dwordx4 v2, s[4:7], s39 offen offset:1024 sc1 lds
    s_mul_i32 s44, s71, 48
    s_mul_i32 s45, s32, 12
    s_add_u32 s44, s44, s45
    s_mul_i32 s44, s44, 5120
    s_add_u32 s44, s44, 24182784
    s_mul_i32 s45, s32, 5120
    s_waitcnt vmcnt(12)
    s_barrier
    buffer_load_dword v36, v3, s[4:7], s42 offen offset:0 sc1
    buffer_load_dword v37, v3, s[4:7], s42 offen offset:256 sc1
    s_waitcnt vmcnt(12)
    s_barrier
    buffer_load_dword v38, v3, s[4:7], s42 offen offset:512 sc1
    buffer_load_dword v39, v3, s[4:7], s42 offen offset:768 sc1
    s_add_u32 s38, s35, 0
    s_mov_b32 m0, s38
    s_add_u32 s39, s34, 86016
    buffer_load_dwordx4 v2, s[4:7], s39 offen offset:0 sc1 lds
    buffer_load_dwordx4 v2, s[4:7], s39 offen offset:1024 sc1 lds
    buffer_load_dwordx4 v2, s[4:7], s39 offen offset:2048 sc1 lds
    s_add_u32 s38, s36, 0
    s_mov_b32 m0, s38
    s_add_u32 s39, s40, 14336
    buffer_load_dwordx4 v2, s[4:7], s39 offen offset:0 sc1 lds
    buffer_load_dwordx4 v2, s[4:7], s39 offen offset:1024 sc1 lds
    s_waitcnt vmcnt(17)
    s_barrier
    buffer_load_dword v40, v3, s[4:7], s42 offen offset:1024 sc1
    buffer_load_dword v41, v3, s[4:7], s42 offen offset:1280 sc1
    s_add_u32 s38, s35, 20480
    s_mov_b32 m0, s38
    s_add_u32 s39, s34, 98304
    buffer_load_dwordx4 v2, s[4:7], s39 offen offset:0 sc1 lds
    buffer_load_dwordx4 v2, s[4:7], s39 offen offset:1024 sc1 lds
    buffer_load_dwordx4 v2, s[4:7], s39 offen offset:2048 sc1 lds
    s_add_u32 s38, s36, 20480
    s_mov_b32 m0, s38
    s_add_u32 s39, s40, 16384
    buffer_load_dwordx4 v2, s[4:7], s39 offen offset:0 sc1 lds
    buffer_load_dwordx4 v2, s[4:7], s39 offen offset:1024 sc1 lds
    s_waitcnt vmcnt(22)
    s_barrier
    buffer_load_dword v42, v3, s[4:7], s42 offen offset:1536 sc1
    buffer_load_dword v43, v3, s[4:7], s42 offen offset:1792 sc1
    s_add_u32 s38, s35, 40960
    s_mov_b32 m0, s38
    s_add_u32 s39, s34, 110592
    buffer_load_dwordx4 v2, s[4:7], s39 offen offset:0 sc1 lds
    buffer_load_dwordx4 v2, s[4:7], s39 offen offset:1024 sc1 lds
    buffer_load_dwordx4 v2, s[4:7], s39 offen offset:2048 sc1 lds
    s_add_u32 s38, s36, 40960
    s_mov_b32 m0, s38
    s_add_u32 s39, s40, 18432
    buffer_load_dwordx4 v2, s[4:7], s39 offen offset:0 sc1 lds
    buffer_load_dwordx4 v2, s[4:7], s39 offen offset:1024 sc1 lds
    s_waitcnt vmcnt(27)
    s_barrier
    s_add_u32 s38, s35, 61440
    s_mov_b32 m0, s38
    s_add_u32 s39, s34, 122880
    buffer_load_dwordx4 v2, s[4:7], s39 offen offset:0 sc1 lds
    buffer_load_dwordx4 v2, s[4:7], s39 offen offset:1024 sc1 lds
    buffer_load_dwordx4 v2, s[4:7], s39 offen offset:2048 sc1 lds
    s_add_u32 s38, s36, 61440
    s_mov_b32 m0, s38
    s_add_u32 s39, s40, 20480
    buffer_load_dwordx4 v2, s[4:7], s39 offen offset:0 sc1 lds
    buffer_load_dwordx4 v2, s[4:7], s39 offen offset:1024 sc1 lds
    s_waitcnt vmcnt(30)
    s_barrier
    s_add_u32 s38, s35, 81920
    s_mov_b32 m0, s38
    s_add_u32 s39, s34, 135168
    buffer_load_dwordx4 v2, s[4:7], s39 offen offset:0 sc1 lds
    buffer_load_dwordx4 v2, s[4:7], s39 offen offset:1024 sc1 lds
    buffer_load_dwordx4 v2, s[4:7], s39 offen offset:2048 sc1 lds
    s_add_u32 s38, s36, 81920
    s_mov_b32 m0, s38
    s_add_u32 s39, s40, 22528
    buffer_load_dwordx4 v2, s[4:7], s39 offen offset:0 sc1 lds
    buffer_load_dwordx4 v2, s[4:7], s39 offen offset:1024 sc1 lds
    s_waitcnt vmcnt(33)
    s_barrier
    s_add_u32 s38, s35, 102400
    s_mov_b32 m0, s38
    s_add_u32 s39, s34, 147456
    buffer_load_dwordx4 v2, s[4:7], s39 offen offset:0 sc1 lds
    buffer_load_dwordx4 v2, s[4:7], s39 offen offset:1024 sc1 lds
    buffer_load_dwordx4 v2, s[4:7], s39 offen offset:2048 sc1 lds
    s_add_u32 s38, s36, 102400
    s_mov_b32 m0, s38
    s_add_u32 s39, s40, 24576
    buffer_load_dwordx4 v2, s[4:7], s39 offen offset:0 sc1 lds
    buffer_load_dwordx4 v2, s[4:7], s39 offen offset:1024 sc1 lds
    s_waitcnt vmcnt(29)
    s_barrier
    s_add_u32 s38, s35, 122880
    s_mov_b32 m0, s38
    s_add_u32 s39, s34, 159744
    buffer_load_dwordx4 v2, s[4:7], s39 offen offset:0 sc1 lds
    buffer_load_dwordx4 v2, s[4:7], s39 offen offset:1024 sc1 lds
    buffer_load_dwordx4 v2, s[4:7], s39 offen offset:2048 sc1 lds
    s_add_u32 s38, s36, 122880
    s_mov_b32 m0, s38
    s_add_u32 s39, s40, 26624
    buffer_load_dwordx4 v2, s[4:7], s39 offen offset:0 sc1 lds
    buffer_load_dwordx4 v2, s[4:7], s39 offen offset:1024 sc1 lds
    s_waitcnt vmcnt(25)
    v_add_f32 v36, v36, v37
    v_add_f32 v36, v36, v38
    v_add_f32 v36, v36, v39
    v_add_f32 v36, v36, v40
    s_waitcnt vmcnt(27)
    s_barrier
    s_add_u32 s38, s35, 0
    s_mov_b32 m0, s38
    s_add_u32 s39, s34, 172032
    buffer_load_dwordx4 v2, s[4:7], s39 offen offset:0 sc1 lds
    buffer_load_dwordx4 v2, s[4:7], s39 offen offset:1024 sc1 lds
    buffer_load_dwordx4 v2, s[4:7], s39 offen offset:2048 sc1 lds
    s_add_u32 s38, s36, 0
    s_mov_b32 m0, s38
    s_add_u32 s39, s40, 28672
    buffer_load_dwordx4 v2, s[4:7], s39 offen offset:0 sc1 lds
    buffer_load_dwordx4 v2, s[4:7], s39 offen offset:1024 sc1 lds
    v_add_f32 v36, v36, v41
    v_add_f32 v36, v36, v42
    v_add_f32 v36, v36, v43
    v_add_f32 v44, v44, v45
    s_waitcnt vmcnt(25)
    s_barrier
    s_add_u32 s38, s35, 20480
    s_mov_b32 m0, s38
    s_add_u32 s39, s34, 184320
    buffer_load_dwordx4 v2, s[4:7], s39 offen offset:0 sc1 lds
    buffer_load_dwordx4 v2, s[4:7], s39 offen offset:1024 sc1 lds
    buffer_load_dwordx4 v2, s[4:7], s39 offen offset:2048 sc1 lds
    s_add_u32 s38, s36, 20480
    s_mov_b32 m0, s38
    s_add_u32 s39, s40, 30720
    buffer_load_dwordx4 v2, s[4:7], s39 offen offset:0 sc1 lds
    buffer_load_dwordx4 v2, s[4:7], s39 offen offset:1024 sc1 lds
    v_add_f32 v44, v44, v46
    v_add_f32 v44, v44, v47
    v_add_f32 v44, v44, v48
    v_mov_b32 v37, v36
    s_waitcnt vmcnt(25)
    s_barrier
    s_add_u32 s38, s35, 40960
    s_mov_b32 m0, s38
    s_add_u32 s39, s34, 196608
    buffer_load_dwordx4 v2, s[4:7], s39 offen offset:0 sc1 lds
    buffer_load_dwordx4 v2, s[4:7], s39 offen offset:1024 sc1 lds
    buffer_load_dwordx4 v2, s[4:7], s39 offen offset:2048 sc1 lds
    s_add_u32 s38, s36, 40960
    s_mov_b32 m0, s38
    s_add_u32 s39, s40, 32768
    buffer_load_dwordx4 v2, s[4:7], s39 offen offset:0 sc1 lds
    buffer_load_dwordx4 v2, s[4:7], s39 offen offset:1024 sc1 lds
    s_nop 1
    v_permlane32_swap_b32 v36, v37
    v_mul_f32 v40, 0x3acccccd, v36
    v_mul_f32 v38, v40, v40
    s_waitcnt vmcnt(25)
    s_barrier
    s_add_u32 s38, s35, 61440
    s_mov_b32 m0, s38
    s_add_u32 s39, s34, 208896
    buffer_load_dwordx4 v2, s[4:7], s39 offen offset:0 sc1 lds
    buffer_load_dwordx4 v2, s[4:7], s39 offen offset:1024 sc1 lds
    buffer_load_dwordx4 v2, s[4:7], s39 offen offset:2048 sc1 lds
    s_add_u32 s38, s36, 61440
    s_mov_b32 m0, s38
    s_add_u32 s39, s40, 34816
    buffer_load_dwordx4 v2, s[4:7], s39 offen offset:0 sc1 lds
    buffer_load_dwordx4 v2, s[4:7], s39 offen offset:1024 sc1 lds
    v_mul_f32 v42, 0x3acccccd, v37
    v_sub_f32 v42, v42, v38
    v_max_f32 v42, 0, v42
    v_add_f32 v42, 0x3727c5ac, v42
    s_waitcnt vmcnt(25)
    s_barrier
    s_add_u32 s38, s35, 81920
    s_mov_b32 m0, s38
    s_add_u32 s39, s34, 221184
    buffer_load_dwordx4 v2, s[4:7], s39 offen offset:0 sc1 lds
    buffer_load_dwordx4 v2, s[4:7], s39 offen offset:1024 sc1 lds
    buffer_load_dwordx4 v2, s[4:7], s39 offen offset:2048 sc1 lds
    s_add_u32 s38, s36, 81920
    s_mov_b32 m0, s38
    s_add_u32 s39, s40, 36864
    buffer_load_dwordx4 v2, s[4:7], s39 offen offset:0 sc1 lds
    buffer_load_dwordx4 v2, s[4:7], s39 offen offset:1024 sc1 lds
    v_rsq_f32 v41, v42
    v_and_b32 v4, 31, v1
    v_mul_f32 v41, 0xbfb8aa3b, v41
    s_lshl_b32 s42, s32, 9
    s_waitcnt vmcnt(25)
    s_barrier
    s_add_u32 s38, s35, 102400
    s_mov_b32 m0, s38
    s_add_u32 s39, s34, 233472
    buffer_load_dwordx4 v2, s[4:7], s39 offen offset:0 sc1 lds
    buffer_load_dwordx4 v2, s[4:7], s39 offen offset:1024 sc1 lds
    buffer_load_dwordx4 v2, s[4:7], s39 offen offset:2048 sc1 lds
    s_add_u32 s38, s36, 102400
    s_mov_b32 m0, s38
    s_add_u32 s39, s40, 38912
    buffer_load_dwordx4 v2, s[4:7], s39 offen offset:0 sc1 lds
    buffer_load_dwordx4 v2, s[4:7], s39 offen offset:1024 sc1 lds
    s_add_u32 s42, s42, 143360
    v_lshl_add_u32 v5, v4, 4, s42
    ds_write_b128 v5, v[40:43]
    s_add_u32 s42, s41, 145408
    s_cmp_lg_u32 s3, 7
    s_cbranch_scc1 L_cw_62
    s_cmp_ge_u32 s2, 16
    s_cbranch_scc1 L_cw_62
    v_lshlrev_b32 v6, 7, v1
    v_add_u32 v6, gu_tail - sequential_preLN__softmax_full_mha__swiglu_ffn__prompt_kernel + 0, v6
    v_min_u32 v6, gu_loader - sequential_preLN__softmax_full_mha__swiglu_ffn__prompt_kernel - 4, v6
    global_load_dword v7, v6, s[26:27]
    v_lshlrev_b32 v6, 7, v1
    v_add_u32 v6, L_down - sequential_preLN__softmax_full_mha__swiglu_ffn__prompt_kernel + 0, v6
    v_min_u32 v6, L_done - sequential_preLN__softmax_full_mha__swiglu_ffn__prompt_kernel - 4, v6
    global_load_dword v7, v6, s[26:27]
L_cw_62:
    s_waitcnt vmcnt(25)
    s_barrier
    v_add_u32 v5, s42, v3
    ds_write_b32 v5, v44
    s_waitcnt lgkmcnt(0)
    s_add_u32 s38, s45, 122880
    s_mov_b32 m0, s38
    s_add_u32 s39, s77, 10
    s_cmp_ge_u32 s39, 12
    s_cselect_b32 s46, 12, 0
    s_sub_u32 s39, s39, s46
    s_mul_i32 s39, s39, 5120
    s_add_u32 s39, s39, s44
    buffer_load_dwordx4 v2, s[4:7], s39 offen offset:0 sc1 lds
    buffer_load_dwordx4 v2, s[4:7], s39 offen offset:1024 sc1 lds
    buffer_load_dwordx4 v2, s[4:7], s39 offen offset:2048 sc1 lds
    buffer_load_dwordx4 v2, s[4:7], s39 offen offset:3072 sc1 lds
    s_add_u32 s38, s38, 4096
    s_mov_b32 m0, s38
    s_add_u32 s39, s39, 4096
    buffer_load_dwordx4 v2, s[4:7], s39 offen sc1 lds
    s_waitcnt vmcnt(25)
    s_barrier
    s_add_u32 s38, s45, 0
    s_mov_b32 m0, s38
    s_add_u32 s39, s77, 4
    s_cmp_ge_u32 s39, 12
    s_cselect_b32 s46, 12, 0
    s_sub_u32 s39, s39, s46
    s_mul_i32 s39, s39, 5120
    s_add_u32 s39, s39, s44
    buffer_load_dwordx4 v2, s[4:7], s39 offen offset:0 sc1 lds
    buffer_load_dwordx4 v2, s[4:7], s39 offen offset:1024 sc1 lds
    buffer_load_dwordx4 v2, s[4:7], s39 offen offset:2048 sc1 lds
    buffer_load_dwordx4 v2, s[4:7], s39 offen offset:3072 sc1 lds
    s_add_u32 s38, s38, 4096
    s_mov_b32 m0, s38
    s_add_u32 s39, s39, 4096
    buffer_load_dwordx4 v2, s[4:7], s39 offen sc1 lds
    s_waitcnt vmcnt(25)
    s_barrier
    s_add_u32 s38, s45, 20480
    s_mov_b32 m0, s38
    s_add_u32 s39, s77, 5
    s_cmp_ge_u32 s39, 12
    s_cselect_b32 s46, 12, 0
    s_sub_u32 s39, s39, s46
    s_mul_i32 s39, s39, 5120
    s_add_u32 s39, s39, s44
    buffer_load_dwordx4 v2, s[4:7], s39 offen offset:0 sc1 lds
    buffer_load_dwordx4 v2, s[4:7], s39 offen offset:1024 sc1 lds
    buffer_load_dwordx4 v2, s[4:7], s39 offen offset:2048 sc1 lds
    buffer_load_dwordx4 v2, s[4:7], s39 offen offset:3072 sc1 lds
    s_add_u32 s38, s38, 4096
    s_mov_b32 m0, s38
    s_add_u32 s39, s39, 4096
    buffer_load_dwordx4 v2, s[4:7], s39 offen sc1 lds
    s_waitcnt vmcnt(25)
    s_barrier
    s_add_u32 s38, s45, 40960
    s_mov_b32 m0, s38
    s_add_u32 s39, s77, 6
    s_cmp_ge_u32 s39, 12
    s_cselect_b32 s46, 12, 0
    s_sub_u32 s39, s39, s46
    s_mul_i32 s39, s39, 5120
    s_add_u32 s39, s39, s44
    buffer_load_dwordx4 v2, s[4:7], s39 offen offset:0 sc1 lds
    buffer_load_dwordx4 v2, s[4:7], s39 offen offset:1024 sc1 lds
    buffer_load_dwordx4 v2, s[4:7], s39 offen offset:2048 sc1 lds
    buffer_load_dwordx4 v2, s[4:7], s39 offen offset:3072 sc1 lds
    s_add_u32 s38, s38, 4096
    s_mov_b32 m0, s38
    s_add_u32 s39, s39, 4096
    buffer_load_dwordx4 v2, s[4:7], s39 offen sc1 lds
    s_waitcnt vmcnt(25)
    s_barrier
    s_add_u32 s38, s45, 61440
    s_mov_b32 m0, s38
    s_add_u32 s39, s77, 7
    s_cmp_ge_u32 s39, 12
    s_cselect_b32 s46, 12, 0
    s_sub_u32 s39, s39, s46
    s_mul_i32 s39, s39, 5120
    s_add_u32 s39, s39, s44
    buffer_load_dwordx4 v2, s[4:7], s39 offen offset:0 sc1 lds
    buffer_load_dwordx4 v2, s[4:7], s39 offen offset:1024 sc1 lds
    buffer_load_dwordx4 v2, s[4:7], s39 offen offset:2048 sc1 lds
    buffer_load_dwordx4 v2, s[4:7], s39 offen offset:3072 sc1 lds
    s_add_u32 s38, s38, 4096
    s_mov_b32 m0, s38
    s_add_u32 s39, s39, 4096
    buffer_load_dwordx4 v2, s[4:7], s39 offen sc1 lds
    s_waitcnt vmcnt(25)
    s_barrier
    s_add_u32 s38, s45, 81920
    s_mov_b32 m0, s38
    s_add_u32 s39, s77, 8
    s_cmp_ge_u32 s39, 12
    s_cselect_b32 s46, 12, 0
    s_sub_u32 s39, s39, s46
    s_mul_i32 s39, s39, 5120
    s_add_u32 s39, s39, s44
    buffer_load_dwordx4 v2, s[4:7], s39 offen offset:0 sc1 lds
    buffer_load_dwordx4 v2, s[4:7], s39 offen offset:1024 sc1 lds
    buffer_load_dwordx4 v2, s[4:7], s39 offen offset:2048 sc1 lds
    buffer_load_dwordx4 v2, s[4:7], s39 offen offset:3072 sc1 lds
    s_add_u32 s38, s38, 4096
    s_mov_b32 m0, s38
    s_add_u32 s39, s39, 4096
    buffer_load_dwordx4 v2, s[4:7], s39 offen sc1 lds
    s_barrier
    s_add_u32 s38, s45, 102400
    s_mov_b32 m0, s38
    s_add_u32 s39, s77, 9
    s_cmp_ge_u32 s39, 12
    s_cselect_b32 s46, 12, 0
    s_sub_u32 s39, s39, s46
    s_mul_i32 s39, s39, 5120
    s_add_u32 s39, s39, s44
    buffer_load_dwordx4 v2, s[4:7], s39 offen offset:0 sc1 lds
    buffer_load_dwordx4 v2, s[4:7], s39 offen offset:1024 sc1 lds
    buffer_load_dwordx4 v2, s[4:7], s39 offen offset:2048 sc1 lds
    buffer_load_dwordx4 v2, s[4:7], s39 offen offset:3072 sc1 lds
    s_add_u32 s38, s38, 4096
    s_mov_b32 m0, s38
    s_add_u32 s39, s39, 4096
    buffer_load_dwordx4 v2, s[4:7], s39 offen sc1 lds
    s_barrier
    s_add_u32 s38, s45, 143360
    s_mov_b32 m0, s38
    s_add_u32 s39, s77, 11
    s_cmp_ge_u32 s39, 12
    s_cselect_b32 s46, 12, 0
    s_sub_u32 s39, s39, s46
    s_mul_i32 s39, s39, 5120
    s_add_u32 s39, s39, s44
    buffer_load_dwordx4 v2, s[4:7], s39 offen offset:0 sc1 lds
    buffer_load_dwordx4 v2, s[4:7], s39 offen offset:1024 sc1 lds
    buffer_load_dwordx4 v2, s[4:7], s39 offen offset:2048 sc1 lds
    buffer_load_dwordx4 v2, s[4:7], s39 offen offset:3072 sc1 lds
    s_add_u32 s38, s38, 4096
    s_mov_b32 m0, s38
    s_add_u32 s39, s39, 4096
    buffer_load_dwordx4 v2, s[4:7], s39 offen sc1 lds
    s_setprio 0
    s_barrier
L_down:
    s_and_b32 s32, s3, 1
    s_lshr_b32 s33, s3, 2
    s_lshl_b32 s33, s33, 1
    s_add_u32 s33, s33, s32
    s_bfe_u32 s34, s3, 0x10001
    s_mul_i32 s40, s71, 48
    s_mul_i32 s41, s33, 12
    s_add_u32 s40, s40, s41
    s_mul_i32 s40, s40, 5120
    s_add_u32 s40, s40, 24182784
    s_cmp_lt_u32 s3, 4
    s_cbranch_scc1 L_dn_63
    buffer_load_dwordx4 v[68:71], v2, s[4:7], s40 offen offset:0 sc1
    buffer_load_dwordx4 v[72:75], v2, s[4:7], s40 offen offset:1024 sc1
    buffer_load_dwordx4 v[76:79], v2, s[4:7], s40 offen offset:2048 sc1
    buffer_load_dwordx4 v[80:83], v2, s[4:7], s40 offen offset:3072 sc1
    s_add_u32 s40, s40, 4096
    buffer_load_dwordx4 v[84:87], v2, s[4:7], s40 offen offset:0 sc1
    buffer_load_dwordx4 v[88:91], v2, s[4:7], s40 offen offset:1024 sc1
    buffer_load_dwordx4 v[92:95], v2, s[4:7], s40 offen offset:2048 sc1
    buffer_load_dwordx4 v[96:99], v2, s[4:7], s40 offen offset:3072 sc1
    s_add_u32 s40, s40, 4096
    buffer_load_dwordx4 v[100:103], v2, s[4:7], s40 offen offset:0 sc1
    buffer_load_dwordx4 v[104:107], v2, s[4:7], s40 offen offset:1024 sc1
    buffer_load_dwordx4 v[108:111], v2, s[4:7], s40 offen offset:2048 sc1
    buffer_load_dwordx4 v[112:115], v2, s[4:7], s40 offen offset:3072 sc1
    s_add_u32 s40, s40, 4096
    buffer_load_dwordx4 v[116:119], v2, s[4:7], s40 offen offset:0 sc1
    buffer_load_dwordx4 v[120:123], v2, s[4:7], s40 offen offset:1024 sc1
    buffer_load_dwordx4 v[124:127], v2, s[4:7], s40 offen offset:2048 sc1
    buffer_load_dwordx4 v[128:131], v2, s[4:7], s40 offen offset:3072 sc1
    s_add_u32 s40, s40, 4096
    buffer_load_dwordx4 v[132:135], v2, s[4:7], s40 offen offset:0 sc1
    buffer_load_dwordx4 v[136:139], v2, s[4:7], s40 offen offset:1024 sc1
    buffer_load_dwordx4 v[140:143], v2, s[4:7], s40 offen offset:2048 sc1
    buffer_load_dwordx4 v[144:147], v2, s[4:7], s40 offen offset:3072 sc1
    s_add_u32 s40, s40, 4096
L_dn_63:
    s_lshl_b32 s42, s70, 1
    s_add_u32 s42, s42, s34
    s_mul_i32 s42, s42, 98304
    s_lshl_b32 s41, s41, 11
    s_add_u32 s42, s42, s41
    s_add_u32 s42, s42, 13107200
    v_and_b32 v3, 15, v1
    v_lshrrev_b32 v4, 4, v1
    v_lshlrev_b32 v5, 9, v4
    v_lshl_add_u32 v24, v3, 4, v5
    s_lshl_b32 s46, s77, 11
    s_mul_i32 s43, s33, 5120
    v_add_u32 v25, s43, v2
    v_add_u32 v26, 61440, v25
    v_add_u32 v27, 122880, v25
    s_load_dwordx2 s[8:9], s[0:1], 56
    s_waitcnt lgkmcnt(0)
    s_and_b32 s9, s9, 0xffff
    s_mov_b32 s10, 0x280000
    s_mov_b32 s11, 0x20000
    s_add_u32 s21, s30, 128
    s_lshr_b32 s22, s70, 1
    s_add_u32 s22, s22, 128
    s_lshl_b32 s24, s21, 7
    s_add_u32 s24, s24, 26738688
    v_mul_u32_u24 v5, 128, v1
    v_mov_b32 v6, 1
    s_cmp_ge_u32 s3, 4
    s_cbranch_scc1 L_dn_64
    s_waitcnt vmcnt(0)
    s_mov_b64 exec, 0x1
    buffer_atomic_add v6, v5, s[4:7], s24 offen sc1
    s_mov_b64 exec, -1
    buffer_load_dwordx4 v[68:71], v2, s[4:7], s40 offen offset:0 sc1
    buffer_load_dwordx4 v[72:75], v2, s[4:7], s40 offen offset:1024 sc1
    buffer_load_dwordx4 v[76:79], v2, s[4:7], s40 offen offset:2048 sc1
    buffer_load_dwordx4 v[80:83], v2, s[4:7], s40 offen offset:3072 sc1
    s_add_u32 s40, s40, 4096
    buffer_load_dwordx4 v[84:87], v2, s[4:7], s40 offen offset:0 sc1
    buffer_load_dwordx4 v[88:91], v2, s[4:7], s40 offen offset:1024 sc1
    buffer_load_dwordx4 v[92:95], v2, s[4:7], s40 offen offset:2048 sc1
    buffer_load_dwordx4 v[96:99], v2, s[4:7], s40 offen offset:3072 sc1
    s_add_u32 s40, s40, 4096
    buffer_load_dwordx4 v[100:103], v2, s[4:7], s40 offen offset:0 sc1
    buffer_load_dwordx4 v[104:107], v2, s[4:7], s40 offen offset:1024 sc1
    buffer_load_dwordx4 v[108:111], v2, s[4:7], s40 offen offset:2048 sc1
    buffer_load_dwordx4 v[112:115], v2, s[4:7], s40 offen offset:3072 sc1
    s_add_u32 s40, s40, 4096
    buffer_load_dwordx4 v[116:119], v2, s[4:7], s40 offen offset:0 sc1
    buffer_load_dwordx4 v[120:123], v2, s[4:7], s40 offen offset:1024 sc1
    buffer_load_dwordx4 v[124:127], v2, s[4:7], s40 offen offset:2048 sc1
    buffer_load_dwordx4 v[128:131], v2, s[4:7], s40 offen offset:3072 sc1
    s_add_u32 s40, s40, 4096
    buffer_load_dwordx4 v[132:135], v2, s[4:7], s40 offen offset:0 sc1
    buffer_load_dwordx4 v[136:139], v2, s[4:7], s40 offen offset:1024 sc1
    buffer_load_dwordx4 v[140:143], v2, s[4:7], s40 offen offset:2048 sc1
    buffer_load_dwordx4 v[144:147], v2, s[4:7], s40 offen offset:3072 sc1
    s_add_u32 s40, s40, 4096
    s_branch L_dn_65
L_dn_64:
    s_waitcnt vmcnt(20)
L_dn_65:
    s_cmp_lg_u32 s3, 0
    s_cbranch_scc1 L_sw_66
    s_lshl_b32 s20, s22, 7
    s_add_u32 s20, s20, 26738688
    v_lshlrev_b32 v5, 7, v1
    s_mov_b64 exec, 0x1
    s_mov_b32 s88, 1048576
L_spin_67:
    buffer_load_dword v6, v5, s[4:7], s20 offen sc1
    s_waitcnt vmcnt(0)
    v_cmp_ne_u32 vcc, 64, v6
    s_sub_u32 s88, s88, 1
    s_cbranch_scc1 L_spun_68
    s_nop 2
    s_cbranch_vccnz L_spin_67
L_spun_68:
    s_mov_b64 exec, -1
L_sw_66:
    s_barrier
    s_add_u32 s41, s42, s46
    buffer_load_dwordx4 v[148:151], v24, s[4:7], s41 offen offset:0 sc1
    buffer_load_dwordx4 v[152:155], v24, s[4:7], s41 offen offset:256 sc1
    s_add_u32 s46, s46, 2048
    s_cmp_eq_u32 s46, 24576
    s_cselect_b32 s46, 0, s46
    s_add_u32 s41, s42, s46
    buffer_load_dwordx4 v[156:159], v24, s[4:7], s41 offen offset:0 sc1
    buffer_load_dwordx4 v[160:163], v24, s[4:7], s41 offen offset:256 sc1
    s_add_u32 s46, s46, 2048
    s_cmp_eq_u32 s46, 24576
    s_cselect_b32 s46, 0, s46
    s_add_u32 s41, s42, s46
    buffer_load_dwordx4 v[164:167], v24, s[4:7], s41 offen offset:0 sc1
    buffer_load_dwordx4 v[168:171], v24, s[4:7], s41 offen offset:256 sc1
    s_add_u32 s46, s46, 2048
    s_cmp_eq_u32 s46, 24576
    s_cselect_b32 s46, 0, s46
    s_add_u32 s41, s42, s46
    buffer_load_dwordx4 v[172:175], v24, s[4:7], s41 offen offset:0 sc1
    buffer_load_dwordx4 v[176:179], v24, s[4:7], s41 offen offset:256 sc1
    s_add_u32 s46, s46, 2048
    s_cmp_eq_u32 s46, 24576
    s_cselect_b32 s46, 0, s46
    s_add_u32 s41, s42, s46
    buffer_load_dwordx4 v[180:183], v24, s[4:7], s41 offen offset:0 sc1
    buffer_load_dwordx4 v[184:187], v24, s[4:7], s41 offen offset:256 sc1
    s_add_u32 s46, s46, 2048
    s_cmp_eq_u32 s46, 24576
    s_cselect_b32 s46, 0, s46
.p2align 3
    s_nop 0
    s_waitcnt vmcnt(8)
    v_mfma_f32_16x16x32_bf16 v[28:31], v[68:71], v[148:151], 0
    v_mfma_f32_16x16x32_bf16 v[48:51], v[68:71], v[152:155], 0
    v_mfma_f32_16x16x32_bf16 v[32:35], v[72:75], v[148:151], 0
    v_mfma_f32_16x16x32_bf16 v[52:55], v[72:75], v[152:155], 0
    v_mfma_f32_16x16x32_bf16 v[36:39], v[76:79], v[148:151], 0
    v_mfma_f32_16x16x32_bf16 v[56:59], v[76:79], v[152:155], 0
    v_mfma_f32_16x16x32_bf16 v[40:43], v[80:83], v[148:151], 0
    v_mfma_f32_16x16x32_bf16 v[60:63], v[80:83], v[152:155], 0
    v_mfma_f32_16x16x32_bf16 v[44:47], v[84:87], v[148:151], 0
    v_mfma_f32_16x16x32_bf16 v[64:67], v[84:87], v[152:155], 0
    s_waitcnt vmcnt(6)
    v_mfma_f32_16x16x32_bf16 v[28:31], v[88:91], v[156:159], v[28:31]
    ds_read_b128 v[68:71], v25 offset:0
    v_mfma_f32_16x16x32_bf16 v[48:51], v[88:91], v[160:163], v[48:51]
    v_mfma_f32_16x16x32_bf16 v[32:35], v[92:95], v[156:159], v[32:35]
    ds_read_b128 v[72:75], v25 offset:1024
    v_mfma_f32_16x16x32_bf16 v[52:55], v[92:95], v[160:163], v[52:55]
    v_mfma_f32_16x16x32_bf16 v[36:39], v[96:99], v[156:159], v[36:39]
    ds_read_b128 v[76:79], v25 offset:2048
    v_mfma_f32_16x16x32_bf16 v[56:59], v[96:99], v[160:163], v[56:59]
    v_mfma_f32_16x16x32_bf16 v[40:43], v[100:103], v[156:159], v[40:43]
    ds_read_b128 v[80:83], v25 offset:3072
    v_mfma_f32_16x16x32_bf16 v[60:63], v[100:103], v[160:163], v[60:63]
    v_mfma_f32_16x16x32_bf16 v[44:47], v[104:107], v[156:159], v[44:47]
    ds_read_b128 v[84:87], v25 offset:4096
    v_mfma_f32_16x16x32_bf16 v[64:67], v[104:107], v[160:163], v[64:67]
    s_waitcnt vmcnt(4)
    v_mfma_f32_16x16x32_bf16 v[28:31], v[108:111], v[164:167], v[28:31]
    ds_read_b128 v[88:91], v25 offset:20480
    v_mfma_f32_16x16x32_bf16 v[48:51], v[108:111], v[168:171], v[48:51]
    v_mfma_f32_16x16x32_bf16 v[32:35], v[112:115], v[164:167], v[32:35]
    ds_read_b128 v[92:95], v25 offset:21504
    v_mfma_f32_16x16x32_bf16 v[52:55], v[112:115], v[168:171], v[52:55]
    v_mfma_f32_16x16x32_bf16 v[36:39], v[116:119], v[164:167], v[36:39]
    ds_read_b128 v[96:99], v25 offset:22528
    v_mfma_f32_16x16x32_bf16 v[56:59], v[116:119], v[168:171], v[56:59]
    v_mfma_f32_16x16x32_bf16 v[40:43], v[120:123], v[164:167], v[40:43]
    ds_read_b128 v[100:103], v25 offset:23552
    v_mfma_f32_16x16x32_bf16 v[60:63], v[120:123], v[168:171], v[60:63]
    v_mfma_f32_16x16x32_bf16 v[44:47], v[124:127], v[164:167], v[44:47]
    ds_read_b128 v[104:107], v25 offset:24576
    v_mfma_f32_16x16x32_bf16 v[64:67], v[124:127], v[168:171], v[64:67]
    s_waitcnt vmcnt(2)
    v_mfma_f32_16x16x32_bf16 v[28:31], v[128:131], v[172:175], v[28:31]
    ds_read_b128 v[108:111], v25 offset:40960
    v_mfma_f32_16x16x32_bf16 v[48:51], v[128:131], v[176:179], v[48:51]
    v_mfma_f32_16x16x32_bf16 v[32:35], v[132:135], v[172:175], v[32:35]
    ds_read_b128 v[112:115], v25 offset:41984
    v_mfma_f32_16x16x32_bf16 v[52:55], v[132:135], v[176:179], v[52:55]
    v_mfma_f32_16x16x32_bf16 v[36:39], v[136:139], v[172:175], v[36:39]
    ds_read_b128 v[116:119], v25 offset:43008
    v_mfma_f32_16x16x32_bf16 v[56:59], v[136:139], v[176:179], v[56:59]
    v_mfma_f32_16x16x32_bf16 v[40:43], v[140:143], v[172:175], v[40:43]
    ds_read_b128 v[120:123], v25 offset:44032
    v_mfma_f32_16x16x32_bf16 v[60:63], v[140:143], v[176:179], v[60:63]
    v_mfma_f32_16x16x32_bf16 v[44:47], v[144:147], v[172:175], v[44:47]
    ds_read_b128 v[124:127], v25 offset:45056
    v_mfma_f32_16x16x32_bf16 v[64:67], v[144:147], v[176:179], v[64:67]
    s_waitcnt vmcnt(0) lgkmcnt(10)
    v_mfma_f32_16x16x32_bf16 v[28:31], v[68:71], v[180:183], v[28:31]
    ds_read_b128 v[128:131], v26 offset:0
    v_mfma_f32_16x16x32_bf16 v[48:51], v[68:71], v[184:187], v[48:51]
    v_mfma_f32_16x16x32_bf16 v[32:35], v[72:75], v[180:183], v[32:35]
    ds_read_b128 v[132:135], v26 offset:1024
    v_mfma_f32_16x16x32_bf16 v[52:55], v[72:75], v[184:187], v[52:55]
    v_mfma_f32_16x16x32_bf16 v[36:39], v[76:79], v[180:183], v[36:39]
    ds_read_b128 v[136:139], v26 offset:2048
    v_mfma_f32_16x16x32_bf16 v[56:59], v[76:79], v[184:187], v[56:59]
    v_mfma_f32_16x16x32_bf16 v[40:43], v[80:83], v[180:183], v[40:43]
    ds_read_b128 v[140:143], v26 offset:3072
    v_mfma_f32_16x16x32_bf16 v[60:63], v[80:83], v[184:187], v[60:63]
    v_mfma_f32_16x16x32_bf16 v[44:47], v[84:87], v[180:183], v[44:47]
    ds_read_b128 v[144:147], v26 offset:4096
    v_mfma_f32_16x16x32_bf16 v[64:67], v[84:87], v[184:187], v[64:67]
    s_add_u32 s41, s42, s46
    buffer_load_dwordx4 v[188:191], v24, s[4:7], s41 offen offset:0 sc1
    buffer_load_dwordx4 v[192:195], v24, s[4:7], s41 offen offset:256 sc1
    s_add_u32 s46, s46, 2048
    s_cmp_eq_u32 s46, 24576
    s_cselect_b32 s46, 0, s46
    s_add_u32 s41, s42, s46
    buffer_load_dwordx4 v[196:199], v24, s[4:7], s41 offen offset:0 sc1
    buffer_load_dwordx4 v[200:203], v24, s[4:7], s41 offen offset:256 sc1
    s_add_u32 s46, s46, 2048
    s_cmp_eq_u32 s46, 24576
    s_cselect_b32 s46, 0, s46
    s_add_u32 s41, s42, s46
    buffer_load_dwordx4 v[204:207], v24, s[4:7], s41 offen offset:0 sc1
    buffer_load_dwordx4 v[208:211], v24, s[4:7], s41 offen offset:256 sc1
    s_add_u32 s46, s46, 2048
    s_cmp_eq_u32 s46, 24576
    s_cselect_b32 s46, 0, s46
    s_add_u32 s41, s42, s46
    buffer_load_dwordx4 v[212:215], v24, s[4:7], s41 offen offset:0 sc1
    buffer_load_dwordx4 v[216:219], v24, s[4:7], s41 offen offset:256 sc1
    s_add_u32 s46, s46, 2048
    s_cmp_eq_u32 s46, 24576
    s_cselect_b32 s46, 0, s46
    s_add_u32 s41, s42, s46
    buffer_load_dwordx4 v[220:223], v24, s[4:7], s41 offen offset:0 sc1
    buffer_load_dwordx4 v[224:227], v24, s[4:7], s41 offen offset:256 sc1
    s_add_u32 s46, s46, 2048
    s_cmp_eq_u32 s46, 24576
    s_cselect_b32 s46, 0, s46
    s_add_u32 s41, s42, s46
    buffer_load_dwordx4 v[228:231], v24, s[4:7], s41 offen offset:0 sc1
    buffer_load_dwordx4 v[232:235], v24, s[4:7], s41 offen offset:256 sc1
    s_add_u32 s46, s46, 2048
    s_cmp_eq_u32 s46, 24576
    s_cselect_b32 s46, 0, s46
    s_add_u32 s41, s42, s46
    buffer_load_dwordx4 v[236:239], v24, s[4:7], s41 offen offset:0 sc1
    buffer_load_dwordx4 v[240:243], v24, s[4:7], s41 offen offset:256 sc1
    s_add_u32 s46, s46, 2048
    s_cmp_eq_u32 s46, 24576
    s_cselect_b32 s46, 0, s46
    s_mul_i32 s35, s3, 3072
    s_add_u32 s35, s35, 61440
    v_mul_u32_u24 v5, 160, v3
    v_add_u32 v5, s35, v5
    v_lshl_add_u32 v244, v4, 4, v5
    v_lshl_add_u32 v245, v4, 3, v5
    v_add_u32 v246, s35, v2
    v_add_u32 v5, 0, v1
    v_mul_u32_u24 v6, 6554, v5
    v_lshrrev_b32 v6, 16, v6
    v_mul_u32_u24 v6, 1120, v6
    v_lshl_add_u32 v247, v5, 4, v6
    v_add_u32 v5, 64, v1
    v_mul_u32_u24 v6, 6554, v5
    v_lshrrev_b32 v6, 16, v6
    v_mul_u32_u24 v6, 1120, v6
    v_lshl_add_u32 v248, v5, 4, v6
    v_add_u32 v5, 128, v1
    v_mul_u32_u24 v6, 6554, v5
    v_lshrrev_b32 v6, 16, v6
    v_mul_u32_u24 v6, 1120, v6
    v_lshl_add_u32 v249, v5, 4, v6
    s_cmp_ge_u32 s3, 4
    s_cbranch_scc1 L_dn_70
    s_cmp_eq_u32 s32, 0
    s_cbranch_scc1 L_dn_69
    v_lshlrev_b32 v6, 16, v8
    v_and_b32 v7, 0xffff0000, v8
    v_pk_add_f32 v[48:49], v[48:49], v[6:7]
    v_lshlrev_b32 v6, 16, v9
    v_and_b32 v7, 0xffff0000, v9
    v_pk_add_f32 v[50:51], v[50:51], v[6:7]
    v_lshlrev_b32 v6, 16, v10
    v_and_b32 v7, 0xffff0000, v10
    v_pk_add_f32 v[52:53], v[52:53], v[6:7]
    v_lshlrev_b32 v6, 16, v11
    v_and_b32 v7, 0xffff0000, v11
    v_pk_add_f32 v[54:55], v[54:55], v[6:7]
    v_lshlrev_b32 v6, 16, v12
    v_and_b32 v7, 0xffff0000, v12
    v_pk_add_f32 v[56:57], v[56:57], v[6:7]
    v_lshlrev_b32 v6, 16, v13
    v_and_b32 v7, 0xffff0000, v13
    v_pk_add_f32 v[58:59], v[58:59], v[6:7]
    v_lshlrev_b32 v6, 16, v14
    v_and_b32 v7, 0xffff0000, v14
    v_pk_add_f32 v[60:61], v[60:61], v[6:7]
    v_lshlrev_b32 v6, 16, v15
    v_and_b32 v7, 0xffff0000, v15
    v_pk_add_f32 v[62:63], v[62:63], v[6:7]
    v_lshlrev_b32 v6, 16, v16
    v_and_b32 v7, 0xffff0000, v16
    v_pk_add_f32 v[64:65], v[64:65], v[6:7]
    v_lshlrev_b32 v6, 16, v17
    v_and_b32 v7, 0xffff0000, v17
    v_pk_add_f32 v[66:67], v[66:67], v[6:7]
    s_branch L_dn_70
L_dn_69:
    v_lshlrev_b32 v6, 16, v8
    v_and_b32 v7, 0xffff0000, v8
    v_pk_add_f32 v[28:29], v[28:29], v[6:7]
    v_lshlrev_b32 v6, 16, v9
    v_and_b32 v7, 0xffff0000, v9
    v_pk_add_f32 v[30:31], v[30:31], v[6:7]
    v_lshlrev_b32 v6, 16, v10
    v_and_b32 v7, 0xffff0000, v10
    v_pk_add_f32 v[32:33], v[32:33], v[6:7]
    v_lshlrev_b32 v6, 16, v11
    v_and_b32 v7, 0xffff0000, v11
    v_pk_add_f32 v[34:35], v[34:35], v[6:7]
    v_lshlrev_b32 v6, 16, v12
    v_and_b32 v7, 0xffff0000, v12
    v_pk_add_f32 v[36:37], v[36:37], v[6:7]
    v_lshlrev_b32 v6, 16, v13
    v_and_b32 v7, 0xffff0000, v13
    v_pk_add_f32 v[38:39], v[38:39], v[6:7]
    v_lshlrev_b32 v6, 16, v14
    v_and_b32 v7, 0xffff0000, v14
    v_pk_add_f32 v[40:41], v[40:41], v[6:7]
    v_lshlrev_b32 v6, 16, v15
    v_and_b32 v7, 0xffff0000, v15
    v_pk_add_f32 v[42:43], v[42:43], v[6:7]
    v_lshlrev_b32 v6, 16, v16
    v_and_b32 v7, 0xffff0000, v16
    v_pk_add_f32 v[44:45], v[44:45], v[6:7]
    v_lshlrev_b32 v6, 16, v17
    v_and_b32 v7, 0xffff0000, v17
    v_pk_add_f32 v[46:47], v[46:47], v[6:7]
L_dn_70:
    s_xor_b32 s35, s3, 1
    s_mul_i32 s35, s35, 15360
    s_lshl_b32 s36, s34, 1
    s_mul_i32 s36, s36, 15360
    s_sub_u32 s37, s33, 1
    s_mul_i32 s37, s37, 5120
    s_add_u32 s36, s36, s37
    s_cmp_lt_u32 s3, 4
    s_cselect_b32 s35, s35, s36
    v_add_u32 v16, s35, v2
    s_mul_i32 s35, s3, 15360
    v_add_u32 v17, s35, v2
    s_waitcnt vmcnt(12) lgkmcnt(10)
    v_mfma_f32_16x16x32_bf16 v[28:31], v[88:91], v[188:191], v[28:31]
    ds_read_b128 v[68:71], v26 offset:20480
    v_mfma_f32_16x16x32_bf16 v[48:51], v[88:91], v[192:195], v[48:51]
    v_mfma_f32_16x16x32_bf16 v[32:35], v[92:95], v[188:191], v[32:35]
    ds_read_b128 v[72:75], v26 offset:21504
    v_mfma_f32_16x16x32_bf16 v[52:55], v[92:95], v[192:195], v[52:55]
    v_mfma_f32_16x16x32_bf16 v[36:39], v[96:99], v[188:191], v[36:39]
    ds_read_b128 v[76:79], v26 offset:22528
    v_mfma_f32_16x16x32_bf16 v[56:59], v[96:99], v[192:195], v[56:59]
    v_mfma_f32_16x16x32_bf16 v[40:43], v[100:103], v[188:191], v[40:43]
    ds_read_b128 v[80:83], v26 offset:23552
    v_mfma_f32_16x16x32_bf16 v[60:63], v[100:103], v[192:195], v[60:63]
    v_mfma_f32_16x16x32_bf16 v[44:47], v[104:107], v[188:191], v[44:47]
    ds_read_b128 v[84:87], v26 offset:24576
    v_mfma_f32_16x16x32_bf16 v[64:67], v[104:107], v[192:195], v[64:67]
    s_waitcnt vmcnt(10) lgkmcnt(10)
    v_mfma_f32_16x16x32_bf16 v[28:31], v[108:111], v[196:199], v[28:31]
    ds_read_b128 v[88:91], v26 offset:40960
    v_mfma_f32_16x16x32_bf16 v[48:51], v[108:111], v[200:203], v[48:51]
    v_mfma_f32_16x16x32_bf16 v[32:35], v[112:115], v[196:199], v[32:35]
    ds_read_b128 v[92:95], v26 offset:41984
    v_mfma_f32_16x16x32_bf16 v[52:55], v[112:115], v[200:203], v[52:55]
    v_mfma_f32_16x16x32_bf16 v[36:39], v[116:119], v[196:199], v[36:39]
    ds_read_b128 v[96:99], v26 offset:43008
    v_mfma_f32_16x16x32_bf16 v[56:59], v[116:119], v[200:203], v[56:59]
    v_mfma_f32_16x16x32_bf16 v[40:43], v[120:123], v[196:199], v[40:43]
    ds_read_b128 v[100:103], v26 offset:44032
    v_mfma_f32_16x16x32_bf16 v[60:63], v[120:123], v[200:203], v[60:63]
    v_mfma_f32_16x16x32_bf16 v[44:47], v[124:127], v[196:199], v[44:47]
    ds_read_b128 v[104:107], v26 offset:45056
    v_mfma_f32_16x16x32_bf16 v[64:67], v[124:127], v[200:203], v[64:67]
    s_waitcnt vmcnt(8) lgkmcnt(10)
    v_mfma_f32_16x16x32_bf16 v[28:31], v[128:131], v[204:207], v[28:31]
    ds_read_b128 v[108:111], v27 offset:0
    v_mfma_f32_16x16x32_bf16 v[48:51], v[128:131], v[208:211], v[48:51]
    v_mfma_f32_16x16x32_bf16 v[32:35], v[132:135], v[204:207], v[32:35]
    ds_read_b128 v[112:115], v27 offset:1024
    v_mfma_f32_16x16x32_bf16 v[52:55], v[132:135], v[208:211], v[52:55]
    v_mfma_f32_16x16x32_bf16 v[36:39], v[136:139], v[204:207], v[36:39]
    ds_read_b128 v[116:119], v27 offset:2048
    v_mfma_f32_16x16x32_bf16 v[56:59], v[136:139], v[208:211], v[56:59]
    v_mfma_f32_16x16x32_bf16 v[40:43], v[140:143], v[204:207], v[40:43]
    ds_read_b128 v[120:123], v27 offset:3072
    v_mfma_f32_16x16x32_bf16 v[60:63], v[140:143], v[208:211], v[60:63]
    v_mfma_f32_16x16x32_bf16 v[44:47], v[144:147], v[204:207], v[44:47]
    ds_read_b128 v[124:127], v27 offset:4096
    v_mfma_f32_16x16x32_bf16 v[64:67], v[144:147], v[208:211], v[64:67]
    s_waitcnt vmcnt(6) lgkmcnt(10)
    v_mfma_f32_16x16x32_bf16 v[28:31], v[68:71], v[212:215], v[28:31]
    ds_read_b128 v[128:131], v27 offset:20480
    v_mfma_f32_16x16x32_bf16 v[48:51], v[68:71], v[216:219], v[48:51]
    v_mfma_f32_16x16x32_bf16 v[32:35], v[72:75], v[212:215], v[32:35]
    ds_read_b128 v[132:135], v27 offset:21504
    v_mfma_f32_16x16x32_bf16 v[52:55], v[72:75], v[216:219], v[52:55]
    v_mfma_f32_16x16x32_bf16 v[36:39], v[76:79], v[212:215], v[36:39]
    ds_read_b128 v[136:139], v27 offset:22528
    v_mfma_f32_16x16x32_bf16 v[56:59], v[76:79], v[216:219], v[56:59]
    v_mfma_f32_16x16x32_bf16 v[40:43], v[80:83], v[212:215], v[40:43]
    ds_read_b128 v[140:143], v27 offset:23552
    v_mfma_f32_16x16x32_bf16 v[60:63], v[80:83], v[216:219], v[60:63]
    v_mfma_f32_16x16x32_bf16 v[44:47], v[84:87], v[212:215], v[44:47]
    ds_read_b128 v[144:147], v27 offset:24576
    v_mfma_f32_16x16x32_bf16 v[64:67], v[84:87], v[216:219], v[64:67]
    s_waitcnt vmcnt(4) lgkmcnt(10)
    v_mfma_f32_16x16x32_bf16 v[28:31], v[88:91], v[220:223], v[28:31]
    v_mfma_f32_16x16x32_bf16 v[48:51], v[88:91], v[224:227], v[48:51]
    v_mfma_f32_16x16x32_bf16 v[32:35], v[92:95], v[220:223], v[32:35]
    v_mfma_f32_16x16x32_bf16 v[52:55], v[92:95], v[224:227], v[52:55]
    v_mfma_f32_16x16x32_bf16 v[36:39], v[96:99], v[220:223], v[36:39]
    v_mfma_f32_16x16x32_bf16 v[56:59], v[96:99], v[224:227], v[56:59]
    v_mfma_f32_16x16x32_bf16 v[40:43], v[100:103], v[220:223], v[40:43]
    v_mfma_f32_16x16x32_bf16 v[60:63], v[100:103], v[224:227], v[60:63]
    v_mfma_f32_16x16x32_bf16 v[44:47], v[104:107], v[220:223], v[44:47]
    v_mfma_f32_16x16x32_bf16 v[64:67], v[104:107], v[224:227], v[64:67]
    s_cmp_lt_u32 s3, 4
    s_cbranch_scc1 L_pr_71
    s_setprio 1
L_pr_71:
    s_barrier
    s_waitcnt vmcnt(2) lgkmcnt(5)
    v_mfma_f32_16x16x32_bf16 v[28:31], v[108:111], v[228:231], v[28:31]
    v_mfma_f32_16x16x32_bf16 v[48:51], v[108:111], v[232:235], v[48:51]
    v_mfma_f32_16x16x32_bf16 v[32:35], v[112:115], v[228:231], v[32:35]
    v_mfma_f32_16x16x32_bf16 v[52:55], v[112:115], v[232:235], v[52:55]
    v_mfma_f32_16x16x32_bf16 v[36:39], v[116:119], v[228:231], v[36:39]
    v_mfma_f32_16x16x32_bf16 v[56:59], v[116:119], v[232:235], v[56:59]
    v_mfma_f32_16x16x32_bf16 v[40:43], v[120:123], v[228:231], v[40:43]
    v_mfma_f32_16x16x32_bf16 v[60:63], v[120:123], v[232:235], v[60:63]
    v_mfma_f32_16x16x32_bf16 v[44:47], v[124:127], v[228:231], v[44:47]
    v_mfma_f32_16x16x32_bf16 v[64:67], v[124:127], v[232:235], v[64:67]
    s_waitcnt vmcnt(0) lgkmcnt(0)
    v_mfma_f32_16x16x32_bf16 v[28:31], v[128:131], v[236:239], v[28:31]
    v_mfma_f32_16x16x32_bf16 v[48:51], v[128:131], v[240:243], v[48:51]
    v_mfma_f32_16x16x32_bf16 v[32:35], v[132:135], v[236:239], v[32:35]
    v_mfma_f32_16x16x32_bf16 v[52:55], v[132:135], v[240:243], v[52:55]
    v_mfma_f32_16x16x32_bf16 v[36:39], v[136:139], v[236:239], v[36:39]
    v_mfma_f32_16x16x32_bf16 v[56:59], v[136:139], v[240:243], v[56:59]
    v_mfma_f32_16x16x32_bf16 v[40:43], v[140:143], v[236:239], v[40:43]
    v_mfma_f32_16x16x32_bf16 v[60:63], v[140:143], v[240:243], v[60:63]
    v_mfma_f32_16x16x32_bf16 v[44:47], v[144:147], v[236:239], v[44:47]
    v_mfma_f32_16x16x32_bf16 v[64:67], v[144:147], v[240:243], v[64:67]
    s_cmp_ge_u32 s3, 4
    s_cbranch_scc1 dn_far
    s_cmp_eq_u32 s32, 0
    s_cbranch_scc1 dn_k0
    s_nop 3
    ds_write_b128 v16, v[28:31] offset:0
    ds_write_b128 v16, v[32:35] offset:1024
    ds_write_b128 v16, v[36:39] offset:2048
    ds_write_b128 v16, v[40:43] offset:3072
    ds_write_b128 v16, v[44:47] offset:4096
    s_waitcnt lgkmcnt(0)
    s_barrier
    ds_read_b128 v[68:71], v17 offset:0
    ds_read_b128 v[88:91], v17 offset:5120
    ds_read_b128 v[108:111], v17 offset:10240
    ds_read_b128 v[72:75], v17 offset:1024
    ds_read_b128 v[92:95], v17 offset:6144
    ds_read_b128 v[112:115], v17 offset:11264
    ds_read_b128 v[76:79], v17 offset:2048
    ds_read_b128 v[96:99], v17 offset:7168
    ds_read_b128 v[116:119], v17 offset:12288
    ds_read_b128 v[80:83], v17 offset:3072
    ds_read_b128 v[100:103], v17 offset:8192
    ds_read_b128 v[120:123], v17 offset:13312
    ds_read_b128 v[84:87], v17 offset:4096
    ds_read_b128 v[104:107], v17 offset:9216
    ds_read_b128 v[124:127], v17 offset:14336
    s_waitcnt lgkmcnt(12)
    v_pk_add_f32 v[48:49], v[48:49], v[68:69]
    v_pk_add_f32 v[50:51], v[50:51], v[70:71]
    v_pk_add_f32 v[48:49], v[48:49], v[88:89]
    v_pk_add_f32 v[50:51], v[50:51], v[90:91]
    v_pk_add_f32 v[48:49], v[48:49], v[108:109]
    v_pk_add_f32 v[50:51], v[50:51], v[110:111]
    v_cvt_pk_bf16_f32 v8, v48, v49
    v_cvt_pk_bf16_f32 v9, v50, v51
    s_waitcnt lgkmcnt(9)
    v_pk_add_f32 v[52:53], v[52:53], v[72:73]
    v_pk_add_f32 v[54:55], v[54:55], v[74:75]
    v_pk_add_f32 v[52:53], v[52:53], v[92:93]
    v_pk_add_f32 v[54:55], v[54:55], v[94:95]
    v_pk_add_f32 v[52:53], v[52:53], v[112:113]
    v_pk_add_f32 v[54:55], v[54:55], v[114:115]
    v_cvt_pk_bf16_f32 v10, v52, v53
    v_cvt_pk_bf16_f32 v11, v54, v55
    s_waitcnt lgkmcnt(6)
    v_pk_add_f32 v[56:57], v[56:57], v[76:77]
    v_pk_add_f32 v[58:59], v[58:59], v[78:79]
    v_pk_add_f32 v[56:57], v[56:57], v[96:97]
    v_pk_add_f32 v[58:59], v[58:59], v[98:99]
    v_pk_add_f32 v[56:57], v[56:57], v[116:117]
    v_pk_add_f32 v[58:59], v[58:59], v[118:119]
    v_cvt_pk_bf16_f32 v12, v56, v57
    v_cvt_pk_bf16_f32 v13, v58, v59
    s_waitcnt lgkmcnt(3)
    v_pk_add_f32 v[60:61], v[60:61], v[80:81]
    v_pk_add_f32 v[62:63], v[62:63], v[82:83]
    v_pk_add_f32 v[60:61], v[60:61], v[100:101]
    v_pk_add_f32 v[62:63], v[62:63], v[102:103]
    v_pk_add_f32 v[60:61], v[60:61], v[120:121]
    v_pk_add_f32 v[62:63], v[62:63], v[122:123]
    v_cvt_pk_bf16_f32 v14, v60, v61
    v_cvt_pk_bf16_f32 v15, v62, v63
    s_waitcnt lgkmcnt(0)
    v_pk_add_f32 v[64:65], v[64:65], v[84:85]
    v_pk_add_f32 v[66:67], v[66:67], v[86:87]
    v_pk_add_f32 v[64:65], v[64:65], v[104:105]
    v_pk_add_f32 v[66:67], v[66:67], v[106:107]
    v_pk_add_f32 v[64:65], v[64:65], v[124:125]
    v_pk_add_f32 v[66:67], v[66:67], v[126:127]
    v_cvt_pk_bf16_f32 v16, v64, v65
    v_cvt_pk_bf16_f32 v17, v66, v67
    s_branch dn_st
dn_k0:
    s_nop 3
    ds_write_b128 v16, v[48:51] offset:0
    ds_write_b128 v16, v[52:55] offset:1024
    ds_write_b128 v16, v[56:59] offset:2048
    ds_write_b128 v16, v[60:63] offset:3072
    ds_write_b128 v16, v[64:67] offset:4096
    s_waitcnt lgkmcnt(0)
    s_barrier
    ds_read_b128 v[68:71], v17 offset:0
    ds_read_b128 v[88:91], v17 offset:5120
    ds_read_b128 v[108:111], v17 offset:10240
    ds_read_b128 v[72:75], v17 offset:1024
    ds_read_b128 v[92:95], v17 offset:6144
    ds_read_b128 v[112:115], v17 offset:11264
    ds_read_b128 v[76:79], v17 offset:2048
    ds_read_b128 v[96:99], v17 offset:7168
    ds_read_b128 v[116:119], v17 offset:12288
    ds_read_b128 v[80:83], v17 offset:3072
    ds_read_b128 v[100:103], v17 offset:8192
    ds_read_b128 v[120:123], v17 offset:13312
    ds_read_b128 v[84:87], v17 offset:4096
    ds_read_b128 v[104:107], v17 offset:9216
    ds_read_b128 v[124:127], v17 offset:14336
    s_waitcnt lgkmcnt(12)
    v_pk_add_f32 v[28:29], v[28:29], v[68:69]
    v_pk_add_f32 v[30:31], v[30:31], v[70:71]
    v_pk_add_f32 v[28:29], v[28:29], v[88:89]
    v_pk_add_f32 v[30:31], v[30:31], v[90:91]
    v_pk_add_f32 v[28:29], v[28:29], v[108:109]
    v_pk_add_f32 v[30:31], v[30:31], v[110:111]
    v_cvt_pk_bf16_f32 v8, v28, v29
    v_cvt_pk_bf16_f32 v9, v30, v31
    s_waitcnt lgkmcnt(9)
    v_pk_add_f32 v[32:33], v[32:33], v[72:73]
    v_pk_add_f32 v[34:35], v[34:35], v[74:75]
    v_pk_add_f32 v[32:33], v[32:33], v[92:93]
    v_pk_add_f32 v[34:35], v[34:35], v[94:95]
    v_pk_add_f32 v[32:33], v[32:33], v[112:113]
    v_pk_add_f32 v[34:35], v[34:35], v[114:115]
    v_cvt_pk_bf16_f32 v10, v32, v33
    v_cvt_pk_bf16_f32 v11, v34, v35
    s_waitcnt lgkmcnt(6)
    v_pk_add_f32 v[36:37], v[36:37], v[76:77]
    v_pk_add_f32 v[38:39], v[38:39], v[78:79]
    v_pk_add_f32 v[36:37], v[36:37], v[96:97]
    v_pk_add_f32 v[38:39], v[38:39], v[98:99]
    v_pk_add_f32 v[36:37], v[36:37], v[116:117]
    v_pk_add_f32 v[38:39], v[38:39], v[118:119]
    v_cvt_pk_bf16_f32 v12, v36, v37
    v_cvt_pk_bf16_f32 v13, v38, v39
    s_waitcnt lgkmcnt(3)
    v_pk_add_f32 v[40:41], v[40:41], v[80:81]
    v_pk_add_f32 v[42:43], v[42:43], v[82:83]
    v_pk_add_f32 v[40:41], v[40:41], v[100:101]
    v_pk_add_f32 v[42:43], v[42:43], v[102:103]
    v_pk_add_f32 v[40:41], v[40:41], v[120:121]
    v_pk_add_f32 v[42:43], v[42:43], v[122:123]
    v_cvt_pk_bf16_f32 v14, v40, v41
    v_cvt_pk_bf16_f32 v15, v42, v43
    s_waitcnt lgkmcnt(0)
    v_pk_add_f32 v[44:45], v[44:45], v[84:85]
    v_pk_add_f32 v[46:47], v[46:47], v[86:87]
    v_pk_add_f32 v[44:45], v[44:45], v[104:105]
    v_pk_add_f32 v[46:47], v[46:47], v[106:107]
    v_pk_add_f32 v[44:45], v[44:45], v[124:125]
    v_pk_add_f32 v[46:47], v[46:47], v[126:127]
    v_cvt_pk_bf16_f32 v16, v44, v45
    v_cvt_pk_bf16_f32 v17, v46, v47
dn_st:
    ds_write_b128 v244, v[8:11]
    ds_write_b128 v244, v[12:15] offset:64
    ds_write_b64 v245, v[16:17] offset:128
    ds_read_b128 v[68:71], v246 offset:0
    ds_read_b128 v[72:75], v246 offset:1024
    ds_read_b128 v[76:79], v246 offset:2048
    s_waitcnt lgkmcnt(2)
    buffer_store_dwordx4 v[68:71], v247, s[8:11], s74 offen nt
    s_waitcnt lgkmcnt(1)
    buffer_store_dwordx4 v[72:75], v248, s[8:11], s74 offen nt
    s_waitcnt lgkmcnt(0)
    s_mov_b64 exec, s[90:91]
    buffer_store_dwordx4 v[76:79], v249, s[8:11], s74 offen nt
    s_mov_b64 exec, -1
    s_endpgm
dn_far:
    s_nop 4
    v_mov_b32 v5, v16
    ds_write_b128 v5, v[28:31] offset:0
    ds_write_b128 v5, v[32:35] offset:1024
    ds_write_b128 v5, v[36:39] offset:2048
    ds_write_b128 v5, v[40:43] offset:3072
    ds_write_b128 v5, v[44:47] offset:4096
    ds_write_b128 v5, v[48:51] offset:15360
    ds_write_b128 v5, v[52:55] offset:16384
    ds_write_b128 v5, v[56:59] offset:17408
    ds_write_b128 v5, v[60:63] offset:18432
    ds_write_b128 v5, v[64:67] offset:19456
    s_waitcnt lgkmcnt(0)
    s_barrier
L_done:
    s_endpgm
L_ool:
L_ool_14:
    s_add_u32 m0, s60, 0
    s_nop 0
    buffer_load_dwordx4 v220, s[8:11], 0 offen lds
    s_add_u32 m0, s60, 1024
    s_nop 0
    buffer_load_dwordx4 v221, s[8:11], 0 offen lds
    s_add_u32 m0, s60, 2048
    s_nop 0
    buffer_load_dwordx4 v222, s[12:15], 0 offen lds
    s_add_u32 m0, s60, 3072
    s_nop 0
    buffer_load_dwordx4 v223, s[12:15], 0 offen lds
    s_add_u32 m0, s60, 4096
    s_nop 0
    buffer_load_dwordx4 v224, s[12:15], 0 offen lds
    s_branch L_ool_14_r
L_ool_15:
    s_add_u32 m0, s60, 0
    s_nop 0
    buffer_load_dwordx4 v220, s[8:11], 0 offen lds
    s_add_u32 m0, s60, 1024
    s_nop 0
    buffer_load_dwordx4 v221, s[8:11], 0 offen lds
    s_add_u32 m0, s60, 2048
    s_nop 0
    buffer_load_dwordx4 v222, s[12:15], 0 offen lds
    s_add_u32 m0, s60, 3072
    s_nop 0
    buffer_load_dwordx4 v223, s[12:15], 0 offen lds
    s_add_u32 m0, s60, 4096
    s_nop 0
    buffer_load_dwordx4 v224, s[12:15], 0 offen lds
    s_branch L_ool_15_r
L_ool_16:
    s_add_u32 m0, s60, 0
    s_nop 0
    buffer_load_dwordx4 v220, s[8:11], 0 offen lds
    s_add_u32 m0, s60, 1024
    s_nop 0
    buffer_load_dwordx4 v221, s[8:11], 0 offen lds
    s_add_u32 m0, s60, 2048
    s_nop 0
    buffer_load_dwordx4 v222, s[12:15], 0 offen lds
    s_add_u32 m0, s60, 3072
    s_nop 0
    buffer_load_dwordx4 v223, s[12:15], 0 offen lds
    s_add_u32 m0, s60, 4096
    s_nop 0
    buffer_load_dwordx4 v224, s[12:15], 0 offen lds
    s_branch L_ool_16_r
L_ool_17:
    s_add_u32 m0, s60, 0
    s_nop 0
    buffer_load_dwordx4 v220, s[8:11], 0 offen lds
    s_add_u32 m0, s60, 1024
    s_nop 0
    buffer_load_dwordx4 v221, s[8:11], 0 offen lds
    s_add_u32 m0, s60, 2048
    s_nop 0
    buffer_load_dwordx4 v222, s[12:15], 0 offen lds
    s_add_u32 m0, s60, 3072
    s_nop 0
    buffer_load_dwordx4 v223, s[12:15], 0 offen lds
    s_add_u32 m0, s60, 4096
    s_nop 0
    buffer_load_dwordx4 v224, s[12:15], 0 offen lds
    s_branch L_ool_17_r
L_ool_18:
    s_add_u32 m0, s60, 0
    s_nop 0
    buffer_load_dwordx4 v220, s[8:11], 0 offen lds
    s_add_u32 m0, s60, 1024
    s_nop 0
    buffer_load_dwordx4 v221, s[8:11], 0 offen lds
    s_add_u32 m0, s60, 2048
    s_nop 0
    buffer_load_dwordx4 v222, s[12:15], 0 offen lds
    s_add_u32 m0, s60, 3072
    s_nop 0
    buffer_load_dwordx4 v223, s[12:15], 0 offen lds
    s_add_u32 m0, s60, 4096
    s_nop 0
    buffer_load_dwordx4 v224, s[12:15], 0 offen lds
    s_branch L_ool_18_r
L_ool_21:
    s_add_u32 m0, s60, 0
    s_nop 0
    buffer_load_dwordx4 v220, s[8:11], 0 offen lds
    s_add_u32 m0, s60, 1024
    s_nop 0
    buffer_load_dwordx4 v221, s[8:11], 0 offen lds
    s_add_u32 m0, s60, 2048
    s_nop 0
    buffer_load_dwordx4 v222, s[12:15], 0 offen lds
    s_add_u32 m0, s60, 3072
    s_nop 0
    buffer_load_dwordx4 v223, s[12:15], 0 offen lds
    s_add_u32 m0, s60, 4096
    s_nop 0
    buffer_load_dwordx4 v224, s[12:15], 0 offen lds
    s_branch L_ool_21_r
L_ool_22:
    s_add_u32 m0, s60, 0
    s_nop 0
    buffer_load_dwordx4 v220, s[8:11], 0 offen lds
    s_add_u32 m0, s60, 1024
    s_nop 0
    buffer_load_dwordx4 v221, s[8:11], 0 offen lds
    s_add_u32 m0, s60, 2048
    s_nop 0
    buffer_load_dwordx4 v222, s[12:15], 0 offen lds
    s_add_u32 m0, s60, 3072
    s_nop 0
    buffer_load_dwordx4 v223, s[12:15], 0 offen lds
    s_add_u32 m0, s60, 4096
    s_nop 0
    buffer_load_dwordx4 v224, s[12:15], 0 offen lds
    s_branch L_ool_22_r
L_ool_23:
    s_add_u32 m0, s60, 0
    s_nop 0
    buffer_load_dwordx4 v220, s[8:11], 0 offen lds
    s_add_u32 m0, s60, 1024
    s_nop 0
    buffer_load_dwordx4 v221, s[8:11], 0 offen lds
    s_add_u32 m0, s60, 2048
    s_nop 0
    buffer_load_dwordx4 v222, s[12:15], 0 offen lds
    s_add_u32 m0, s60, 3072
    s_nop 0
    buffer_load_dwordx4 v223, s[12:15], 0 offen lds
    s_add_u32 m0, s60, 4096
    s_nop 0
    buffer_load_dwordx4 v224, s[12:15], 0 offen lds
    s_branch L_ool_23_r
L_ool_24:
    v_lshlrev_b32 v176, 2, v0
    v_add_u32 v177, 102400, v176
    ds_read_b32 v168, v177 offset:0
    ds_read_b32 v169, v177 offset:512
    ds_read_b32 v170, v177 offset:1024
    ds_read_b32 v171, v177 offset:1536
    ds_read_b32 v172, v177 offset:2048
    ds_read_b32 v173, v177 offset:2560
    ds_read_b32 v174, v177 offset:3072
    ds_read_b32 v175, v177 offset:3584
    s_branch L_ool_24_r
L_ool_25:
    s_mul_i32 s58, s62, 12288
    s_lshl_b32 s59, s61, 9
    s_add_u32 s58, s58, s59
    s_add_u32 s58, s58, 26148864
    v_lshlrev_b32 v176, 2, v0
    v_add_f32 v168, v168, v169
    v_add_f32 v168, v168, v170
    v_add_f32 v168, v168, v171
    v_add_f32 v168, v168, v172
    v_add_f32 v168, v168, v173
    v_add_f32 v168, v168, v174
    v_add_f32 v168, v168, v175
    buffer_store_dword v168, v176, s[4:7], s58 offen sc1
    s_branch L_ool_25_r
L_ool_26:
    s_and_b32 s20, s2, 7
    s_lshl_b32 s20, s20, 7
    s_add_u32 s20, s20, 26746880
    v_mov_b32 v168, 0
    v_mov_b32 v169, 1
    s_mov_b64 exec, 1
    buffer_atomic_add v169, v168, s[4:7], s20 offen sc1
    s_mov_b64 exec, -1
    s_branch L_ool_26_r
L_ool_27:
    s_load_dwordx2 s[8:9], s[0:1], 0
    s_waitcnt lgkmcnt(0)
    s_and_b32 s9, s9, 0xffff
    s_mov_b32 s10, 0x280000
    s_mov_b32 s11, 0x20000
    buffer_load_dwordx4 v[184:187], v154, s[8:11], s74 offen
    buffer_load_dwordx4 v[188:191], v154, s[8:11], s74 offen offset:64
    buffer_load_dwordx2 v[192:193], v155, s[8:11], s74 offen offset:128
    s_branch L_ool_27_r
L_ool_28:
    s_load_dwordx2 s[8:9], s[0:1], 0
    s_waitcnt lgkmcnt(0)
    s_and_b32 s9, s9, 0xffff
    s_mov_b32 s10, 0x280000
    s_mov_b32 s11, 0x20000
    buffer_load_dwordx4 v[184:187], v154, s[8:11], s74 offen
    buffer_load_dwordx4 v[188:191], v154, s[8:11], s74 offen offset:64
    buffer_load_dwordx2 v[192:193], v155, s[8:11], s74 offen offset:128
    s_branch L_ool_28_r
L_ool_29:
    s_load_dwordx2 s[8:9], s[0:1], 0
    s_waitcnt lgkmcnt(0)
    s_and_b32 s9, s9, 0xffff
    s_mov_b32 s10, 0x280000
    s_mov_b32 s11, 0x20000
    buffer_load_dwordx4 v[184:187], v154, s[8:11], s74 offen
    buffer_load_dwordx4 v[188:191], v154, s[8:11], s74 offen offset:64
    buffer_load_dwordx2 v[192:193], v155, s[8:11], s74 offen offset:128
    s_branch L_ool_29_r
L_ool_30:
    s_load_dwordx2 s[8:9], s[0:1], 0
    s_waitcnt lgkmcnt(0)
    s_and_b32 s9, s9, 0xffff
    s_mov_b32 s10, 0x280000
    s_mov_b32 s11, 0x20000
    buffer_load_dwordx4 v[184:187], v154, s[8:11], s74 offen
    buffer_load_dwordx4 v[188:191], v154, s[8:11], s74 offen offset:64
    buffer_load_dwordx2 v[192:193], v155, s[8:11], s74 offen offset:128
    s_branch L_ool_30_r
L_ool_31:
    s_cmp_ge_u32 s2, 16
    s_cbranch_scc1 L_cw_32
    v_lshlrev_b32 v3, 7, v1
    v_add_u32 v3, L_att48 - sequential_preLN__softmax_full_mha__swiglu_ffn__prompt_kernel + 0, v3
    v_min_u32 v3, att_st - sequential_preLN__softmax_full_mha__swiglu_ffn__prompt_kernel - 4, v3
    global_load_dword v182, v3, s[26:27]
L_cw_32:
    s_branch L_ool_31_r
L_ool_33:
    s_mov_b64 exec, 0xff
    buffer_load_dword v148, v147, s[4:7], 0 offen sc1
    s_mov_b64 exec, -1
    s_branch L_ool_33_r
L_ool_34:
    s_mov_b64 exec, 0xff
    v_cmp_ne_u32 vcc, 32, v148
    s_nop 4
    s_cbranch_vccz L_spun_36
    s_mov_b32 s88, 1048576
L_spin_35:
    buffer_load_dword v148, v147, s[4:7], 0 offen sc1
    s_waitcnt vmcnt(0)
    v_cmp_ne_u32 vcc, 32, v148
    s_sub_u32 s88, s88, 1
    s_cbranch_scc1 L_spun_36
    s_nop 2
    s_cbranch_vccnz L_spin_35
L_spun_36:
    s_mov_b64 exec, -1
    s_branch L_ool_34_r
L_ool_37:
    buffer_load_dword v183, v152, s[4:7], s54 offen
    s_branch L_ool_37_r
L_ool_38:
    buffer_load_dword v183, v152, s[4:7], s54 offen
    s_branch L_ool_38_r
L_ool_39:
    buffer_load_dword v183, v152, s[4:7], s54 offen
    s_branch L_ool_39_r
L_ool_40:
    buffer_load_dword v183, v152, s[4:7], s54 offen
    s_branch L_ool_40_r
L_ool_41:
    buffer_load_dword v183, v152, s[4:7], s54 offen
    s_branch L_ool_41_r
L_ool_42:
    buffer_load_dword v183, v152, s[4:7], s54 offen
    s_branch L_ool_42_r
L_ool_43:
    buffer_load_dword v183, v152, s[4:7], s54 offen
    s_branch L_ool_43_r
L_ool_44:
    buffer_load_dword v183, v152, s[4:7], s54 offen
    s_branch L_ool_44_r
L_ool_45:
    buffer_load_dword v183, v153, s[4:7], s55 offen
    s_branch L_ool_45_r
L_ool_46:
    buffer_load_dword v183, v153, s[4:7], s55 offen
    s_branch L_ool_46_r
L_ool_47:
    buffer_load_dword v183, v153, s[4:7], s55 offen
    s_branch L_ool_47_r
L_ool_48:
    buffer_load_dword v183, v153, s[4:7], s55 offen
    s_branch L_ool_48_r
L_ool_49:
    buffer_load_dword v183, v153, s[4:7], s55 offen
    s_branch L_ool_49_r
L_ool_50:
    buffer_load_dword v183, v153, s[4:7], s55 offen
    s_branch L_ool_50_r
L_ool_51:
    s_cmp_ge_u32 s2, 16
    s_cbranch_scc1 L_cw_52
    v_lshlrev_b32 v3, 7, v1
    v_add_u32 v3, att_x0 - sequential_preLN__softmax_full_mha__swiglu_ffn__prompt_kernel + 0, v3
    v_min_u32 v3, L_down - sequential_preLN__softmax_full_mha__swiglu_ffn__prompt_kernel - 4, v3
    global_load_dword v182, v3, s[26:27]
    v_lshlrev_b32 v3, 7, v1
    v_add_u32 v3, att_x0 - sequential_preLN__softmax_full_mha__swiglu_ffn__prompt_kernel + 8192, v3
    v_min_u32 v3, L_down - sequential_preLN__softmax_full_mha__swiglu_ffn__prompt_kernel - 4, v3
    global_load_dword v182, v3, s[26:27]
L_cw_52:
    s_branch L_ool_51_r
L_ool_53:
    buffer_load_dword v183, v153, s[4:7], s55 offen
    s_branch L_ool_53_r
L_ool_54:
    buffer_load_dword v183, v153, s[4:7], s55 offen
    s_branch L_ool_54_r
att_slow1:
    v_mov_b32 v24, v28
    v_mov_b32 v25, v29
    v_mov_b32 v26, v30
    v_mov_b32 v27, v31
    v_mov_b32 v32, v34
    v_mov_b32 v33, v35
att_slow0:
    v_and_b32 v3, 31, v1
    v_lshrrev_b32 v4, 5, v1
    v_lshlrev_b32 v5, 3, v1
    v_mul_u32_u24 v7, 320, v4
    v_lshl_add_u32 v7, v3, 4, v7
    v_cndmask_b32_e64 v32, 0, v32, s[90:91]
    v_mov_b32 v162, 0xff800000
    v_mov_b32 v84, 0
    v_mov_b32 v85, 0
    v_mov_b32 v86, 0
    v_mov_b32 v87, 0
    v_mov_b32 v88, 0
    v_mov_b32 v89, 0
    v_mov_b32 v90, 0
    v_mov_b32 v91, 0
    v_mov_b32 v92, 0
    v_mov_b32 v93, 0
    v_mov_b32 v94, 0
    v_mov_b32 v95, 0
    v_mov_b32 v96, 0
    v_mov_b32 v97, 0
    v_mov_b32 v98, 0
    v_mov_b32 v99, 0
    s_mov_b32 s45, 0
att_slow_loop:
    buffer_load_dwordx4 v[116:119], v2, s[4:7], s36 offen sc1
    s_mov_b64 exec, s[90:91]
    buffer_load_dwordx2 v[124:125], v5, s[4:7], s36 offen offset:1024 sc1
    s_mov_b64 exec, s[92:93]
    buffer_load_dwordx4 v[128:131], v7, s[4:7], s36 offen offset:1280 sc1
    buffer_load_dwordx4 v[132:135], v7, s[4:7], s36 offen offset:1920 sc1
    s_mov_b64 exec, -1
    s_add_u32 s36, s36, 2560
    s_waitcnt vmcnt(0)
    v_mfma_f32_32x32x16_bf16 v[36:51], v[116:119], v[24:27], 0
    v_mfma_f32_32x32x8bf16_1k v[36:51], v[124:125], v[32:33], v[36:51]
    s_nop 15
    v_max3_f32 v160, v36, v37, v38
    v_max3_f32 v160, v39, v40, v160
    v_max3_f32 v160, v41, v42, v160
    v_max3_f32 v160, v43, v44, v160
    v_max3_f32 v160, v45, v46, v160
    v_max3_f32 v160, v47, v48, v160
    v_max3_f32 v160, v49, v50, v160
    v_max_f32 v160, v51, v160
    v_mov_b32 v161, v160
    s_nop 1
    v_permlane32_swap_b32 v160, v161
    v_max_f32 v160, v160, v161
    v_max_f32 v160, v160, v162
    v_sub_f32 v163, v162, v160
    v_exp_f32 v163, v163
    v_mov_b32 v162, v160
    v_sub_f32 v36, v36, v162
    v_sub_f32 v37, v37, v162
    v_sub_f32 v38, v38, v162
    v_sub_f32 v39, v39, v162
    v_sub_f32 v40, v40, v162
    v_sub_f32 v41, v41, v162
    v_sub_f32 v42, v42, v162
    v_sub_f32 v43, v43, v162
    v_sub_f32 v44, v44, v162
    v_sub_f32 v45, v45, v162
    v_sub_f32 v46, v46, v162
    v_sub_f32 v47, v47, v162
    v_sub_f32 v48, v48, v162
    v_sub_f32 v49, v49, v162
    v_sub_f32 v50, v50, v162
    v_sub_f32 v51, v51, v162
    v_exp_f32 v36, v36
    v_exp_f32 v37, v37
    v_exp_f32 v38, v38
    v_exp_f32 v39, v39
    v_exp_f32 v40, v40
    v_exp_f32 v41, v41
    v_exp_f32 v42, v42
    v_exp_f32 v43, v43
    v_exp_f32 v44, v44
    v_exp_f32 v45, v45
    v_exp_f32 v46, v46
    v_exp_f32 v47, v47
    v_exp_f32 v48, v48
    v_exp_f32 v49, v49
    v_exp_f32 v50, v50
    v_exp_f32 v51, v51
    v_mul_f32 v84, v163, v84
    v_mul_f32 v85, v163, v85
    v_mul_f32 v86, v163, v86
    v_mul_f32 v87, v163, v87
    v_mul_f32 v88, v163, v88
    v_mul_f32 v89, v163, v89
    v_mul_f32 v90, v163, v90
    v_mul_f32 v91, v163, v91
    v_mul_f32 v92, v163, v92
    v_mul_f32 v93, v163, v93
    v_mul_f32 v94, v163, v94
    v_mul_f32 v95, v163, v95
    v_mul_f32 v96, v163, v96
    v_mul_f32 v97, v163, v97
    v_mul_f32 v98, v163, v98
    v_mul_f32 v99, v163, v99
    v_cvt_pk_bf16_f32 v68, v36, v37
    v_cvt_pk_bf16_f32 v69, v38, v39
    v_cvt_pk_bf16_f32 v70, v40, v41
    v_cvt_pk_bf16_f32 v71, v42, v43
    v_cvt_pk_bf16_f32 v72, v44, v45
    v_cvt_pk_bf16_f32 v73, v46, v47
    v_cvt_pk_bf16_f32 v74, v48, v49
    v_cvt_pk_bf16_f32 v75, v50, v51
    s_nop 1
    v_mfma_f32_32x32x16_bf16 v[84:99], v[128:131], v[68:71], v[84:99]
    v_mfma_f32_32x32x16_bf16 v[84:99], v[132:135], v[72:75], v[84:99]
    s_add_u32 s45, s45, 1
    s_nop 15
    s_cmp_lt_u32 s45, 64
    s_cbranch_scc1 att_slow_loop
    v_rcp_f32 v160, v96
    s_nop 0
    s_branch att_fin
L_spare:
    s_cmp_ge_u32 s2, 256
    s_cbranch_scc1 L_done
    s_waitcnt lgkmcnt(0)
    s_and_b32 s5, s5, 0xffff
    s_mov_b32 s6, 0x2000000
    s_mov_b32 s7, 0x20000
    s_and_b32 s9, s9, 0xffff
    s_mov_b32 s10, 0x280000
    s_mov_b32 s11, 0x20000
    s_and_b32 s13, s13, 0xffff
    s_mov_b32 s14, 0x258000
    s_mov_b32 s15, 0x20000
    s_and_b32 s17, s17, 0xffff
    s_mov_b32 s18, 0x100
    s_mov_b32 s19, 0x20000
    s_cmp_lg_u32 s3, 0
    s_cbranch_scc1 L_spare_w
    s_cmp_lg_u32 s2, 255
    s_cbranch_scc1 L_spare_p
    v_lshlrev_b32 v3, 7, v1
    v_mov_b32 v4, 0
    s_mov_b32 s20, 26738688
    buffer_store_dword v4, v3, s[4:7], s20 offen sc1
    s_mov_b32 s20, 26746880
    buffer_store_dword v4, v3, s[4:7], s20 offen sc1
    s_mov_b32 s20, 26755072
    buffer_store_dword v4, v3, s[4:7], s20 offen sc1
    s_waitcnt vmcnt(0)
    v_mov_b32 v5, 1
    s_mov_b64 exec, 1
    buffer_store_dword v5, v4, s[16:19], 0 offen sc1
    s_mov_b64 exec, -1
L_spare_p:
    v_mov_b32 v4, 0
    s_mov_b64 exec, 1
    s_mov_b32 s88, 1048576
L_spin_72:
    buffer_load_dword v5, v4, s[16:19], 0 offen sc1
    s_waitcnt vmcnt(0)
    v_cmp_ne_u32 vcc, 1, v5
    s_sub_u32 s88, s88, 1
    s_cbranch_scc1 L_spun_73
    s_nop 2
    s_cbranch_vccnz L_spin_72
L_spun_73:
    s_mov_b64 exec, -1
L_spare_w:
    s_getpc_b64 s[20:21]
L_pc:
    s_sub_u32 s20, s20, L_pc - sequential_preLN__softmax_full_mha__swiglu_ffn__prompt_kernel
    s_subb_u32 s21, s21, 0
    v_lshlrev_b32 v3, 7, v0
    v_cmp_gt_u32 vcc, L_end - sequential_preLN__softmax_full_mha__swiglu_ffn__prompt_kernel, v3
    s_and_saveexec_b64 s[22:23], vcc
    s_cbranch_execz L_nowarm
    global_load_dword v4, v3, s[20:21]
    s_waitcnt vmcnt(0)
L_nowarm:
    s_mov_b64 exec, -1
    s_branch L_h1
L_end:
.section .rodata,"a"
.p2align 6
.amdhsa_kernel sequential_preLN__softmax_full_mha__swiglu_ffn__prompt_kernel
  .amdhsa_next_free_vgpr 256
  .amdhsa_next_free_sgpr 102
  .amdhsa_accum_offset 256
  .amdhsa_group_segment_fixed_size 0
  .amdhsa_kernarg_size 80
  .amdhsa_user_sgpr_count 2
  .amdhsa_user_sgpr_kernarg_segment_ptr 1
  .amdhsa_system_sgpr_workgroup_id_x 1
  .amdhsa_float_denorm_mode_32 3
.end_amdhsa_kernel
```
